```python
import torch

def _softmax(x, axis=-1):
    return torch.softmax(x, dim=axis)
def _gelu(x):
    return torch.nn.functional.gelu(x, approximate="tanh")
def _silu(x):
    return torch.nn.functional.silu(x)
def _sigmoid(x):
    return torch.sigmoid(x)
def _layernorm(x, axis=-1, eps=1e-5):
    m = x.mean(dim=axis, keepdim=True)
    v = x.var(dim=axis, keepdim=True, unbiased=False)
    return (x - m) / torch.sqrt(v + eps)
def _scatter_add(tgt, idx, src, axis=0):
    return tgt.clone().index_add_(axis, idx, src)
def _segment_sum(src, seg, n):
    out = torch.zeros((n,) + src.shape[1:], dtype=src.dtype)
    return out.index_add_(0, seg, src)
def _pad(x, pw):
    flat = tuple(v for pair in reversed(pw) for v in pair)
    return torch.nn.functional.pad(x, flat)

kernel_name = 'gated_mix__ssm_conv_h3__ssm_conv_s4d__prompt'

def setup_inputs():

    _w = (lambda a: (lambda t: t.to(torch.bfloat16) if t.is_floating_point() else t)(torch.as_tensor(a)))
    def _A_setup():
        B, S, D = 1, 2048, 576
        ks = 4
        return {
            "q": _w((lambda *s: torch.randn(*s, dtype=torch.bfloat16) * 0.05)(B, S, D)),
            "k": _w((lambda *s: torch.randn(*s, dtype=torch.bfloat16) * 0.8)(B, S, D)),
            "v": _w((lambda *s: torch.randn(*s, dtype=torch.bfloat16) * 0.8)(B, S, D)),
            "shift_k": _w((lambda *s: torch.randn(*s, dtype=torch.bfloat16) * 0.8)(D, ks) * 0.5),
            "ssm_k": _w((lambda *s: torch.randn(*s, dtype=torch.bfloat16) * 0.8)(D, S) * (1.0 / S ** 0.5)),
            "ssm_D": _w((lambda *s: torch.randn(*s, dtype=torch.bfloat16) * 0.8)(D)),
        }
    _A_in = _A_setup()

    def _B_setup():
        Bsz, L, D, N = 1, 2048, 576, 128
        return {
            "u": _w((lambda *s: torch.randn(*s, dtype=torch.bfloat16) * 0.05)(Bsz, L, D)),
            "log_A_real": _w((lambda *s: torch.randn(*s, dtype=torch.bfloat16) * 3.2)(D, N) * 0.5),
            "A_imag": _w((lambda *s: torch.randn(*s, dtype=torch.bfloat16) * 0.2)(D, N) * 3.14),
            "C_real": _w((lambda *s: torch.randn(*s, dtype=torch.bfloat16) * 3.2)(D, N) / N ** 0.5),
            "C_imag": _w((lambda *s: torch.randn(*s, dtype=torch.bfloat16) * 3.2)(D, N) / N ** 0.5),
            "log_dt": _w((lambda *s: torch.randn(*s, dtype=torch.bfloat16) * 0.2)(D) * 0.5 - 4.0),
            "D_skip": _w((lambda *s: torch.randn(*s, dtype=torch.bfloat16) * 0.4)(D)),
        }
    _B_in = _B_setup()

    return {
        "A_q": _A_in["q"],
        "A_k": _A_in["k"],
        "A_v": _A_in["v"],
        "A_shift_k": _A_in["shift_k"],
        "A_ssm_k": _A_in["ssm_k"],
        "A_ssm_D": _A_in["ssm_D"],
        "B_u": _B_in["u"],
        "B_log_A_real": _B_in["log_A_real"],
        "B_A_imag": _B_in["A_imag"],
        "B_C_real": _B_in["C_real"],
        "B_C_imag": _B_in["C_imag"],
        "B_log_dt": _B_in["log_dt"],
        "B_D_skip": _B_in["D_skip"],
        "gate_w": _w((lambda *s: torch.randn(*s, dtype=torch.bfloat16) * 0.05)(576) * 16.0),
    }

def reference(A_q, A_k, A_v, A_shift_k, A_ssm_k, A_ssm_D, B_u, B_log_A_real, B_A_imag, B_C_real, B_C_imag, B_log_dt, B_D_skip, gate_w):
    def _A_ref(q, k, v, shift_k, ssm_k, ssm_D):
        B, S, D = q.shape
        ks = shift_k.shape[-1]
        k_pad = _pad(k, ((0, 0), (ks - 1, 0), (0, 0)))
        k_shift = torch.zeros_like(k)
        for t in range(ks):
            k_shift = k_shift + k_pad[:, t:t + S, :] * shift_k[:, ks - 1 - t][None, None, :]
        kv = k_shift * v
        L = 2 * S
        kv_pad = _pad(kv, ((0, 0), (0, S), (0, 0)))
        kf_pad = _pad(ssm_k, ((0, 0), (0, S)))
        kv_f = (lambda x, axes=(-2,-1): torch.fft.rfft2(x.float(), dim=axes))(kv_pad[:, None, :, :], axes=(1, 2))
        kf_f = (lambda x, axes=(-2,-1): torch.fft.rfft2(x.float(), dim=axes))(kf_pad[:, None, :], axes=(1, 2))
        kf_f = (lambda x, *d: x.permute(*d))(kf_f, 1, 2, 0)
        y_f = kv_f * kf_f[None, :, :, :]
        y = (lambda x, s, axes=(-2,-1): torch.fft.irfft2(x, s=s, dim=axes).to(torch.bfloat16))(y_f, (1, L), axes=(1, 2))[:, 0, :S, :]
        y = y + kv * ssm_D[None, None, :]
        return q * y

    def _B_ref(u, log_A_real, A_imag, C_real, C_imag, log_dt, D_skip):
        L = u.shape[1]
        dt = torch.exp(log_dt)
        A = -torch.exp(log_A_real) + 1j * A_imag
        C = (C_real + 1j * C_imag) * dt[:, None]
        pos = (lambda x, dt: x.to(dt))(torch.arange(L), log_dt.dtype)
        P = torch.exp((A * dt[:, None])[:, :, None] * pos[None, None, :])
        K = 2.0 * torch.einsum("dn,dnl->dl", C, P).real
        L2 = 2 * L
        u_t = (lambda x, *d: x.permute(*d))(u, 0, 2, 1)
        Kf = (lambda x, *a, **k: torch.fft.rfft(x.float(), *a, **k))(K, L2)
        Uf = (lambda x, *a, **k: torch.fft.rfft(x.float(), *a, **k))(u_t, L2)
        y = (lambda x, *a, **k: torch.fft.irfft(x, *a, **k).to(torch.bfloat16))(Uf * Kf[None, :, :], L2)[:, :, :L]
        y = (lambda x, *d: x.permute(*d))(y, 0, 2, 1)
        return y + u * D_skip[None, None, :]

    x = A_q
    g = _sigmoid((x * gate_w).sum(-1, keepdims=True))
    a = _A_ref(x, A_k, A_v, A_shift_k, A_ssm_k, A_ssm_D)
    b = _B_ref(x, B_log_A_real, B_A_imag, B_C_real, B_C_imag, B_log_dt, B_D_skip)
    return g * a + (1 - g) * b
```

```asm
; @launch grid=(256,1,1) block=(512,1,1) lds=163520
.amdgcn_target "amdgcn-amd-amdhsa--gfx950"
.text
.globl gated_mix__ssm_conv_h3__ssm_conv_s4d__prompt_kernel
.p2align 12
.p2align 8
.type gated_mix__ssm_conv_h3__ssm_conv_s4d__prompt_kernel,@function
gated_mix__ssm_conv_h3__ssm_conv_s4d__prompt_kernel:
    s_cmp_ge_u32 s2, 256
    s_cbranch_scc1 L_end
    v_lshrrev_b32 v2, 6, v0
    s_load_dwordx2 s[20:21], s[0:1], 128
    v_readfirstlane_b32 s3, v2
    v_and_b32 v1, 63, v0
    s_and_b32 s4, s2, 7
    s_lshr_b32 s5, s2, 3
    s_mov_b32 s22, 8388608
    s_mov_b32 s23, 0x20000
    s_and_b32 s6, s3, 3
    s_cmp_ge_u32 s3, 4
    s_cbranch_scc1 L_data
    s_load_dwordx8 s[40:47], s[0:1], 56
    s_load_dwordx4 s[48:51], s[0:1], 88
    s_getpc_b64 s[54:55]
L_pc:
    s_and_b32 s56, s5, 3
    s_lshl_b32 s56, s56, 2
    s_add_u32 s56, s56, s6
    s_lshl_b32 s57, s56, 8
    s_mul_i32 s56, s56, 1536
    s_lshl_b32 s58, s4, 12
    s_add_u32 s57, s57, s58
    s_add_u32 s57, s57, L_padt0-L_pc-1536
    v_min_u32 v240, 13, v1
    v_cmp_gt_u32 vcc, 12, v240
    v_mov_b32 v241, s57
    v_mov_b32 v242, s56
    v_cndmask_b32 v241, v241, v242, vcc
    v_lshl_add_u32 v240, v240, 7, v241
    v_min_u32 v240, L_end-L_pc, v240
    v_mov_b32 v241, s55
    v_add_co_u32 v240, vcc, s54, v240
    s_nop 1
    v_addc_co_u32 v241, vcc, 0, v241, vcc
    global_load_dword v242, v[240:241], off
    v_lshlrev_b32 v14, 2, v1
    v_min_u32 v14, 28, v14
    v_add_u32 v14, 163456, v14
    v_mov_b32 v15, 0
    ds_write_b32 v14, v15
    s_and_b32 s63, s6, 1
    s_lshl_b32 s64, s5, 1
    s_add_u32 s64, s64, s63
    s_lshl_b32 s65, s4, 6
    s_add_u32 s65, s65, s64
    s_add_u32 s66, s64, 512
    s_cmp_ge_u32 s6, 2
    s_cselect_b32 s67, s65, s66
    s_lshl_b32 s71, s67, 8
    v_lshl_add_u32 v239, v1, 2, s71
    s_lshr_b32 s72, s67, 1
    s_lshl_b32 s72, s72, 2
    s_mul_i32 s56, s6, 8704
    s_add_u32 s56, s56, 38912
    s_cmp_ge_u32 s6, 2
    s_cselect_b32 s69, 0, 6
    s_cselect_b32 s70, 2, 0
    s_cselect_b32 s15, 0, 4
    s_add_u32 s69, s69, s6
    s_add_u32 s70, s70, s6
    s_mul_i32 s69, s69, 4480
    s_mul_i32 s70, s70, 4480
    s_add_u32 s69, s69, 73728
    s_add_u32 s70, s70, 73728
    s_mul_i32 s58, s6, 4352
    s_add_u32 s58, s58, 143488
    v_mov_b32 v14, 0
    v_min_u32 v16, 47, v1
    v_lshlrev_b32 v16, 3, v16
    v_add_u32 v17, s69, v16
    v_add_u32 v18, s70, v16
    ds_write_b64 v17, v[14:15]
    ds_write_b64 v18, v[14:15]
    v_min_u32 v17, 24, v16
    v_add_u32 v18, s58, v17
    ds_write_b64 v18, v[14:15]
    s_lshl_b32 s54, s6, 5
    s_add_u32 s54, s54, 126976
    v_add_u32 v18, s54, v17
    ds_write_b64 v18, v[14:15]
    v_mov_b32 v20, -1
    v_min_u32 v24, 36, v1
    s_lshl_b32 s54, s6, 9
    v_and_b32 v21, 1, v24
    v_lshrrev_b32 v24, 1, v24
    v_lshl_add_u32 v24, v24, 11, s54
    v_lshl_add_u32 v24, v21, 8, v24
    ds_write2_b32 v24, v20, v20 offset0:0 offset1:63
    s_mov_b32 m0, s54
    v_mov_b32 v254, 163456
    v_mov_b32 v255, 1
    v_lshl_add_u32 v243, v1, 3, s56
    v_add_u32 v234, 2176, v243
    v_add_u32 v235, 4352, v243
    v_add_u32 v236, 6528, v243
    v_lshrrev_b32 v20, 4, v1
    v_bfe_u32 v21, v1, 2, 2
    v_and_b32 v22, 3, v1
    v_and_b32 v23, 15, v1
    v_lshlrev_b32 v24, 5, v20
    v_lshl_add_u32 v24, v21, 3, v24
    v_lshl_add_u32 v253, v22, 3, v24
    s_add_u32 s54, s58, 8
    v_add_u32 v253, s54, v253
    v_lshlrev_b32 v25, 5, v22
    v_sub_u32 v25, v25, v24
    s_mul_i32 s54, s6, 4480
    s_add_u32 s54, s54, 74008
    v_add_u32 v251, s54, v25
    s_mul_i32 s55, s4, 248
    s_add_u32 s54, s54, s55
    s_add_u32 s54, s54, 13568
    v_add_u32 v230, s54, v25
    s_lshl_b32 s16, s4, 1
    s_add_u32 s16, s16, 4
    s_mul_i32 s17, s4, 240
    s_sub_u32 s17, 4224, s17
    v_lshl_add_u32 v27, v20, 2, v21
    v_add3_u32 v27, v27, v22, 1
    v_lshrrev_b32 v28, 1, v27
    v_and_b32 v27, 1, v27
    v_lshlrev_b32 v28, 6, v28
    v_lshl_add_u32 v28, v27, 3, v28
    s_lshl_b32 s54, s6, 4
    s_add_u32 s54, s54, 126976
    v_add_u32 v231, s54, v28
    v_lshlrev_b32 v26, 4, v20
    v_add_u32 v26, s56, v26
    v_mov_b32 v31, 544
    v_mad_u32_u24 v244, v23, v31, v26
    v_lshl_add_u32 v27, v21, 1, v22
    v_mad_u32_u24 v245, v27, v31, v26
    v_lshrrev_b32 v28, 1, v21
    v_add_u32 v27, v27, v28
    v_mad_u32_u24 v246, v27, v31, v26
    v_mad_u32_u24 v27, v21, 3, v22
    v_mad_u32_u24 v247, v27, v31, v26
    s_add_u32 s54, s69, 384
    v_lshl_add_u32 v27, v23, 5, s54
    v_lshl_add_u32 v248, v20, 3, v27
    v_lshrrev_b32 v28, 1, v20
    v_and_b32 v29, 1, v20
    v_lshl_add_u32 v249, v28, 9, v27
    v_lshl_add_u32 v249, v29, 4, v249
    v_lshl_add_u32 v250, v20, 9, v27
    s_waitcnt lgkmcnt(0)
    global_load_dword v10, v239, s[40:41]
    global_load_dword v11, v239, s[42:43]
    s_load_dword s75, s[48:49], s72
    global_load_dword v12, v239, s[44:45]
    global_load_dword v13, v239, s[46:47]
    s_load_dword s76, s[50:51], s72
    s_barrier
    s_branch L_matrix
L_data:
    s_load_dwordx2 s[12:13], s[0:1], 8
    s_load_dwordx2 s[8:9], s[0:1], 0
    s_load_dwordx2 s[16:17], s[0:1], 16
    s_load_dwordx2 s[32:33], s[0:1], 24
    s_load_dwordx2 s[36:37], s[0:1], 104
    s_load_dwordx2 s[24:25], s[0:1], 112
    s_load_dwordx2 s[28:29], s[0:1], 32
    s_load_dwordx2 s[52:53], s[0:1], 40
    s_mov_b32 s10, 2359296
    s_mov_b32 s11, 0x20000
    s_mov_b32 s14, 2359296
    s_mov_b32 s15, 0x20000
    s_mov_b32 s18, 2359296
    s_mov_b32 s19, 0x20000
    s_mov_b32 s38, 1152
    s_mov_b32 s39, 0x20000
    v_lshrrev_b32 v211, 5, v1
    v_and_b32 v213, 31, v1
    v_mul_u32_u24 v200, 9216, v211
    v_lshl_add_u32 v200, v213, 2, v200
    s_lshl_b32 s64, s4, 5
    s_add_u32 s78, s64, s5
    s_lshl_b32 s57, s78, 2
    s_add_u32 s57, s57, s6
    s_lshl_b32 s57, s57, 1
    s_mul_i32 s58, s57, 1152
    v_cmp_gt_u32 vcc, 24, v213
    v_lshlrev_b32 v215, 4, v213
    v_mov_b32 v212, 0x40000000
    v_cndmask_b32 v210, v212, v215, vcc
    v_mul_u32_u24 v207, 1152, v211
    v_add_u32 v212, v207, v210
    s_lshl_b32 s61, s5, 2
    s_add_u32 s61, s61, s6
    s_mul_i32 s61, s61, 18432
    s_lshl_b32 s62, s4, 7
    s_add_u32 s61, s61, s62
    s_add_u32 s62, s61, 4608
    s_sub_u32 s63, s61, 3456
    v_add_u32 v204, s63, v200
    s_lshl_b32 s63, s4, 9
    v_add_u32 v214, s63, v215
    v_add_u32 v215, 4096, v215
    s_add_u32 s67, s58, 1024
    v_lshl_add_u32 v207, v213, 2, v207
    v_add_u32 v207, s67, v207
    v_subrev_u32 v218, 1152, v207
    v_subrev_u32 v219, 2304, v207
    v_subrev_u32 v220, 3456, v207
    s_and_b32 s40, s6, 1
    s_lshl_b32 s41, s5, 1
    s_add_u32 s41, s41, s40
    s_lshl_b32 s42, s4, 6
    s_add_u32 s42, s42, s41
    s_add_u32 s43, s41, 512
    s_lshl_b32 s44, s42, 12
    s_lshl_b32 s45, s43, 12
    s_lshr_b32 s46, s42, 1
    s_lshl_b32 s46, s46, 2
    s_lshr_b32 s47, s43, 1
    s_lshl_b32 s47, s47, 2
    s_waitcnt lgkmcnt(0)
    s_load_dword s7, s[20:21], 0
    s_load_dword s51, s[52:53], s47
    s_load_dword s49, s[28:29], s45
    s_load_dword s50, s[52:53], s46
    s_load_dword s48, s[28:29], s44
    buffer_load_dwordx4 v[14:17], v210, s[36:39], 0 offen offset:0
    buffer_load_dwordx4 v[18:21], v210, s[36:39], 0 offen offset:384
    buffer_load_dwordx4 v[22:25], v210, s[36:39], 0 offen offset:768
    global_load_dwordx4 v[70:73], v215, s[32:33]
    global_load_dwordx4 v[46:49], v214, s[32:33]
    s_barrier
    s_setprio 3
    buffer_load_dwordx4 v[2:5], v212, s[8:11], s58 offen offset:0
    buffer_load_dwordx4 v[6:9], v212, s[8:11], s58 offen offset:384
    buffer_load_dwordx4 v[10:13], v212, s[8:11], s58 offen offset:768
    buffer_load_dword v50, v207, s[12:15], 0 offen
    buffer_load_dword v51, v218, s[12:15], 0 offen
    buffer_load_dword v52, v219, s[12:15], 0 offen
    buffer_load_dword v53, v220, s[12:15], 0 offen
    buffer_load_dword v54, v207, s[16:19], 0 offen
    buffer_load_dword v55, v207, s[8:11], 0 offen
    s_setprio 2
    buffer_load_dword v26, v204, s[12:15], 0 offen offset:0
    buffer_load_dword v27, v204, s[12:15], 0 offen offset:1152
    buffer_load_dword v28, v204, s[12:15], 0 offen offset:2304
    buffer_load_dword v29, v200, s[12:15], s61 offen offset:0
    buffer_load_dword v30, v200, s[12:15], s61 offen offset:1152
    buffer_load_dword v31, v200, s[12:15], s61 offen offset:2304
    buffer_load_dword v32, v200, s[12:15], s61 offen offset:3456
    buffer_load_dword v33, v200, s[12:15], s62 offen offset:0
    buffer_load_dword v34, v200, s[12:15], s62 offen offset:1152
    buffer_load_dword v35, v200, s[12:15], s62 offen offset:2304
    buffer_load_dword v36, v200, s[12:15], s62 offen offset:3456
    s_setprio 1
    buffer_load_dword v37, v200, s[16:19], s61 offen offset:0
    buffer_load_dword v38, v200, s[16:19], s61 offen offset:1152
    buffer_load_dword v39, v200, s[16:19], s61 offen offset:2304
    buffer_load_dword v40, v200, s[16:19], s61 offen offset:3456
    buffer_load_dword v41, v200, s[16:19], s62 offen offset:0
    buffer_load_dword v42, v200, s[16:19], s62 offen offset:1152
    buffer_load_dword v43, v200, s[16:19], s62 offen offset:2304
    buffer_load_dword v44, v200, s[16:19], s62 offen offset:3456
    s_setprio 3
    s_mov_b32 s26, 2359296
    s_mov_b32 s27, 0x20000
    s_mov_b32 s30, 2359296
    s_mov_b32 s31, 0x20000
    s_lshr_b32 s54, s6, 1
    s_lshl_b32 s54, s54, 10
    s_add_u32 s44, s44, s54
    s_add_u32 s45, s45, s54
    s_mul_i32 s46, s40, 4480
    s_add_u32 s46, s46, 74112
    s_add_u32 s46, s46, s54
    s_add_u32 s47, s46, 17920
    s_mov_b32 m0, s46
    v_lshlrev_b32 v217, 4, v1
    s_lshl_b32 s54, s6, 5
    s_add_u32 s54, s54, 109568
    v_mul_u32_u24 v201, 272, v213
    v_lshl_add_u32 v201, v211, 4, v201
    v_add_u32 v201, s54, v201
    v_lshrrev_b32 v232, 3, v1
    v_and_b32 v233, 7, v1
    v_mul_u32_u24 v203, 4224, v232
    v_lshl_add_u32 v203, v233, 4, v203
    s_mul_i32 s54, s6, 2176
    s_add_u32 s54, s54, 109568
    v_lshrrev_b32 v232, 4, v1
    v_mul_u32_u24 v202, 272, v232
    v_and_b32 v233, 15, v1
    v_lshl_add_u32 v202, v233, 4, v202
    v_add_u32 v202, s54, v202
    s_lshl_b32 s60, s4, 2
    s_add_u32 s60, s60, s6
    s_mul_i32 s71, s60, 67584
    s_lshl_b32 s72, s5, 7
    s_add_u32 s71, s71, s72
    s_add_u32 s71, s71, 524288
    s_add_u32 s72, s71, 33792
    s_add_u32 s65, s71, 2433024
    s_add_u32 s66, s72, 2433024
    s_mul_i32 s75, 0, 9
    s_add_u32 s75, s75, s4
    s_lshl_b32 s75, s75, 2
    s_add_u32 s75, s75, s6
    s_mul_i32 s75, s75, 512
    s_add_u32 s75, s75, 32768
    v_mov_b32 v206, 0
    v_mul_u32_u24 v237, 4224, v233
    v_lshlrev_b32 v217, 4, v1
    s_lshl_b32 s54, s6, 2
    s_add_u32 s54, s54, 160896
    v_mul_u32_u24 v224, 80, v213
    v_lshl_add_u32 v224, v211, 1, v224
    v_add_u32 v224, s54, v224
    v_lshrrev_b32 v232, 2, v1
    v_and_b32 v233, 3, v1
    v_mul_u32_u24 v225, 80, v232
    v_lshl_add_u32 v225, v233, 4, v225
    v_add_u32 v225, 160896, v225
    v_mul_u32_u24 v226, 16512, v232
    v_lshl_add_u32 v226, v233, 4, v226
    s_cmp_eq_u32 s6, 3
    s_cselect_b32 s54, 0, 0x40000000
    v_or_b32 v226, s54, v226
    v_mov_b32 v244, s54
    s_mul_i32 s76, s78, 16
    s_add_u32 s76, s76, 393216
    s_lshl_b32 s73, s78, 6
    s_add_u32 s73, s73, 5390336
    s_add_u32 s74, s73, 264192
    s_lshl_b32 s56, s6, 8
    s_add_u32 s56, s56, s78
    s_mul_i32 s56, s56, 16
    s_add_u32 s56, s56, 262144
    s_mul_i32 s54, s5, 4
    s_add_u32 s75, s75, s54
    v_mov_b32 v230, 163456
    v_mov_b32 v231, 1
    s_lshl_b32 s77, s57, 2
    s_add_u32 s77, s77, 4096
    s_mov_b32 s34, 0x05040100
    s_mov_b32 s35, 0x07060302
    s_mov_b32 m0, s46
    s_lshr_b32 s54, s5, 3
    s_mul_i32 s70, 0, 9
    s_add_u32 s70, s70, s4
    s_lshl_b32 s70, s70, 2
    s_add_u32 s70, s70, s54
    s_mul_i32 s70, s70, 512
    s_add_u32 s70, s70, 32768
    v_mul_u32_u24 v238, 4, v213
    s_lshr_b32 s54, s6, 1
    s_mul_i32 s54, s54, 576
    s_add_u32 s54, s54, s42
    s_mul_i32 s79, s54, 4224
    s_add_u32 s79, s79, 524288
    s_mul_i32 s54, s4, 124
    s_add_u32 s55, s54, 64
    s_sub_u32 s54, 1920, s54
    s_cmp_ge_u32 s6, 2
    s_cselect_b32 s57, s54, s55
    s_and_b32 s54, s6, 1
    s_lshl_b32 s54, s54, 6
    s_add_u32 s57, s57, s54
    s_lshl_b32 s96, s57, 2
    s_add_u32 s96, s96, 4096
    s_lshl_b32 s97, s6, 8
    s_add_u32 s97, s97, 4096
    s_add_u32 s98, s97, 4096
    v_lshrrev_b32 v250, 1, v1
    v_lshlrev_b32 v250, 3, v250
    v_and_b32 v251, 1, v1
    v_lshlrev_b32 v251, 4, v251
    s_mov_b32 s101, 4096
    v_lshlrev_b32 v210, 3, v1
    s_branch L_dwork
.p2align 12
L_dwork:
    s_waitcnt lgkmcnt(0)
    s_mul_i32 s7, s7, 0x0019660d
    s_add_u32 s7, s7, 0x3c6ef35f
    v_mov_b32 v209, s7
    s_lshl_b32 s40, s40, 4
    s_lshr_b32 s50, s50, s40
    s_lshr_b32 s51, s51, s40
    s_lshl_b32 s48, s48, 16
    s_lshl_b32 s49, s49, 16
    s_lshl_b32 s50, s50, 16
    s_lshl_b32 s51, s51, 16
    v_mov_b32 v227, s48
    v_mov_b32 v228, s49
    v_add_f32 v227, s50, v227
    v_add_f32 v228, s51, v228
    v_cvt_pk_bf16_f32 v227, v227, v228
    s_cmp_lt_u32 s6, 2
    s_cselect_b32 s54, s46, 163488
    s_cselect_b32 s55, s47, 163488
    v_mov_b32 v228, s54
    v_mov_b32 v223, s55
    buffer_load_dwordx4 v217, s[28:31], s44 offen offset:0 lds
    buffer_load_dwordx4 v217, s[28:31], s44 offen offset:2048 lds
    buffer_load_dword v236, v206, s[20:23], s75 offen sc1
    s_lshl_b32 s54, s4, 7
    v_lshl_add_u32 v235, v211, 11, s54
    buffer_load_dword v235, v235, s[28:31], s45 offen
    buffer_load_dword v74, v200, s[8:11], s61 offen offset:0
    buffer_load_dword v75, v200, s[8:11], s61 offen offset:1152
    buffer_load_dword v76, v200, s[8:11], s61 offen offset:2304
    buffer_load_dword v77, v200, s[8:11], s61 offen offset:3456
    buffer_load_dword v78, v200, s[8:11], s62 offen offset:0
    buffer_load_dword v79, v200, s[8:11], s62 offen offset:1152
    buffer_load_dword v80, v200, s[8:11], s62 offen offset:2304
    buffer_load_dword v81, v200, s[8:11], s62 offen offset:3456
    s_waitcnt vmcnt(37)
    v_dot2_f32_bf16 v208, v2, v14, 0
    v_dot2_f32_bf16 v208, v3, v15, v208
    v_dot2_f32_bf16 v208, v4, v16, v208
    v_dot2_f32_bf16 v208, v5, v17, v208
    v_dot2_f32_bf16 v208, v6, v18, v208
    v_dot2_f32_bf16 v208, v7, v19, v208
    v_dot2_f32_bf16 v208, v8, v20, v208
    v_dot2_f32_bf16 v208, v9, v21, v208
    v_dot2_f32_bf16 v208, v10, v22, v208
    v_dot2_f32_bf16 v208, v11, v23, v208
    v_dot2_f32_bf16 v208, v12, v24, v208
    v_dot2_f32_bf16 v208, v13, v25, v208
    s_nop 2
    v_add_f32_dpp v208, v208, v208 row_shr:1 row_mask:0xf bank_mask:0xf bound_ctrl:0
    s_nop 1
    v_add_f32_dpp v208, v208, v208 row_shr:2 row_mask:0xf bank_mask:0xf bound_ctrl:0
    s_nop 1
    v_add_f32_dpp v208, v208, v208 row_shr:4 row_mask:0xf bank_mask:0xf bound_ctrl:0
    s_nop 1
    v_add_f32_dpp v208, v208, v208 row_shr:8 row_mask:0xf bank_mask:0xf bound_ctrl:0
    s_nop 1
    v_add_f32_dpp v208, v208, v208 row_bcast:15 row_mask:0xa bank_mask:0xf
    v_mul_f32 v208, 0xbfb8aa3b, v208
    v_exp_f32 v208, v208
    s_nop 0
    v_add_f32 v208, 1.0, v208
    v_rcp_f32 v208, v208
    s_nop 0
    v_cvt_f16_f32 v208, v208
    s_nop 1
    v_mov_b32_dpp v229, v208 row_bcast:31 row_mask:0xc bank_mask:0xf
    v_and_b32 v229, 0xffff, v229
    v_lshl_or_b32 v208, v208, 16, v229
    s_mov_b32 exec_lo, 0
    s_mov_b32 exec_hi, 0x80000000
    buffer_store_dwordx2 v[208:209], v206, s[20:23], s77 offen sc1
    s_mov_b64 exec, -1
    s_waitcnt vmcnt(32)
    v_lshlrev_b32 v110, 16, v70
    v_lshlrev_b32 v111, 16, v72
    v_and_b32 v112, 0xffff0000, v70
    v_and_b32 v113, 0xffff0000, v72
    v_lshlrev_b32 v114, 16, v71
    v_lshlrev_b32 v115, 16, v73
    v_and_b32 v116, 0xffff0000, v71
    v_and_b32 v117, 0xffff0000, v73
    v_lshlrev_b32 v88, 16, v50
    v_and_b32 v89, 0xffff0000, v50
    v_lshlrev_b32 v90, 16, v51
    v_and_b32 v91, 0xffff0000, v51
    v_lshlrev_b32 v92, 16, v52
    v_and_b32 v93, 0xffff0000, v52
    v_lshlrev_b32 v94, 16, v53
    v_and_b32 v95, 0xffff0000, v53
    v_lshlrev_b32 v96, 16, v54
    v_and_b32 v97, 0xffff0000, v54
    v_pk_mul_f32 v[118:119], v[94:95], v[116:117]
    v_pk_fma_f32 v[118:119], v[92:93], v[114:115], v[118:119]
    v_pk_fma_f32 v[118:119], v[90:91], v[112:113], v[118:119]
    v_pk_fma_f32 v[118:119], v[88:89], v[110:111], v[118:119]
    v_pk_mul_f32 v[118:119], v[118:119], v[96:97]
    v_cvt_pk_bf16_f32 v118, v118, v119
    ds_write_b16 v224, v55 offset:32
    ds_write_b16_d16_hi v224, v55 offset:48
    ds_write_b16 v224, v118
    ds_write_b16_d16_hi v224, v118 offset:16
    s_mov_b64 exec, 1
    ds_add_u32 v230, v231 offset:24
    s_mov_b64 exec, -1
    s_waitcnt vmcnt(21)
.p2align 3
    v_lshlrev_b32_e64 v110, 16, v46
    v_lshlrev_b32_e64 v111, 16, v48
    v_and_b32 v112, 0xffff0000, v46
    v_and_b32 v113, 0xffff0000, v48
    v_lshlrev_b32_e64 v114, 16, v47
    v_lshlrev_b32_e64 v115, 16, v49
    v_and_b32 v116, 0xffff0000, v47
    v_and_b32 v117, 0xffff0000, v49
    v_lshlrev_b32_e64 v88, 16, v26
    v_and_b32 v89, 0xffff0000, v26
    v_lshlrev_b32_e64 v90, 16, v27
    v_and_b32 v91, 0xffff0000, v27
    v_lshlrev_b32_e64 v92, 16, v28
    v_and_b32 v93, 0xffff0000, v28
    v_lshlrev_b32_e64 v94, 16, v29
    v_and_b32 v95, 0xffff0000, v29
    v_lshlrev_b32_e64 v96, 16, v30
    v_and_b32 v97, 0xffff0000, v30
    v_lshlrev_b32_e64 v98, 16, v31
    v_and_b32 v99, 0xffff0000, v31
    v_lshlrev_b32_e64 v100, 16, v32
    v_and_b32 v101, 0xffff0000, v32
    v_lshlrev_b32_e64 v102, 16, v33
    v_and_b32 v103, 0xffff0000, v33
    v_lshlrev_b32_e64 v104, 16, v34
    v_and_b32 v105, 0xffff0000, v34
    v_lshlrev_b32_e64 v106, 16, v35
    v_and_b32 v107, 0xffff0000, v35
    v_lshlrev_b32_e64 v108, 16, v36
    v_and_b32 v109, 0xffff0000, v36
    v_pk_mul_f32 v[118:119], v[88:89], v[116:117]
    v_pk_mul_f32 v[120:121], v[90:91], v[116:117]
    v_pk_mul_f32 v[122:123], v[92:93], v[116:117]
    v_pk_mul_f32 v[124:125], v[94:95], v[116:117]
    v_pk_mul_f32 v[126:127], v[96:97], v[116:117]
    v_pk_mul_f32 v[128:129], v[98:99], v[116:117]
    v_pk_mul_f32 v[130:131], v[100:101], v[116:117]
    v_pk_mul_f32 v[132:133], v[102:103], v[116:117]
    v_pk_fma_f32 v[118:119], v[90:91], v[114:115], v[118:119]
    v_pk_fma_f32 v[120:121], v[92:93], v[114:115], v[120:121]
    v_pk_fma_f32 v[122:123], v[94:95], v[114:115], v[122:123]
    v_pk_fma_f32 v[124:125], v[96:97], v[114:115], v[124:125]
    v_pk_fma_f32 v[126:127], v[98:99], v[114:115], v[126:127]
    v_pk_fma_f32 v[128:129], v[100:101], v[114:115], v[128:129]
    v_pk_fma_f32 v[130:131], v[102:103], v[114:115], v[130:131]
    v_pk_fma_f32 v[132:133], v[104:105], v[114:115], v[132:133]
    v_pk_fma_f32 v[118:119], v[92:93], v[112:113], v[118:119]
    v_pk_fma_f32 v[120:121], v[94:95], v[112:113], v[120:121]
    v_pk_fma_f32 v[122:123], v[96:97], v[112:113], v[122:123]
    v_pk_fma_f32 v[124:125], v[98:99], v[112:113], v[124:125]
    v_pk_fma_f32 v[126:127], v[100:101], v[112:113], v[126:127]
    v_pk_fma_f32 v[128:129], v[102:103], v[112:113], v[128:129]
    v_pk_fma_f32 v[130:131], v[104:105], v[112:113], v[130:131]
    v_pk_fma_f32 v[132:133], v[106:107], v[112:113], v[132:133]
    v_pk_fma_f32 v[118:119], v[94:95], v[110:111], v[118:119]
    v_pk_fma_f32 v[120:121], v[96:97], v[110:111], v[120:121]
    v_pk_fma_f32 v[122:123], v[98:99], v[110:111], v[122:123]
    v_pk_fma_f32 v[124:125], v[100:101], v[110:111], v[124:125]
    v_pk_fma_f32 v[126:127], v[102:103], v[110:111], v[126:127]
    v_pk_fma_f32 v[128:129], v[104:105], v[110:111], v[128:129]
    v_pk_fma_f32 v[130:131], v[106:107], v[110:111], v[130:131]
    v_pk_fma_f32 v[132:133], v[108:109], v[110:111], v[132:133]
    s_cmp_lg_u32 s6, 3
    s_cbranch_scc1 L_noes
    s_mov_b32 s64, 0
L_esync:
    ds_read_b32 v232, v230 offset:24
    s_add_u32 s64, s64, 1
    s_waitcnt lgkmcnt(0)
    v_cmp_ne_u32 vcc, 4, v232
    s_cbranch_vccz L_esyncx
    s_cmp_lt_u32 s64, 262144
    s_cbranch_scc1 L_esync
L_esyncx:
    ds_read_b128 v[160:163], v225
    ds_read_b128 v[164:167], v225 offset:1280
    s_waitcnt lgkmcnt(0)
L_noes:
    buffer_store_dwordx4 v[160:163], v226, s[20:23], s73 offen sc1
    buffer_store_dwordx4 v[164:167], v226, s[20:23], s74 offen sc1
    s_waitcnt vmcnt(15)
.p2align 3
    v_lshlrev_b32_e64 v88, 16, v37
    v_and_b32 v89, 0xffff0000, v37
    v_lshlrev_b32_e64 v90, 16, v38
    v_and_b32 v91, 0xffff0000, v38
    v_lshlrev_b32_e64 v92, 16, v39
    v_and_b32 v93, 0xffff0000, v39
    v_lshlrev_b32_e64 v94, 16, v40
    v_and_b32 v95, 0xffff0000, v40
    v_lshlrev_b32_e64 v96, 16, v41
    v_and_b32 v97, 0xffff0000, v41
    v_lshlrev_b32_e64 v98, 16, v42
    v_and_b32 v99, 0xffff0000, v42
    v_lshlrev_b32_e64 v100, 16, v43
    v_and_b32 v101, 0xffff0000, v43
    v_lshlrev_b32_e64 v102, 16, v44
    v_and_b32 v103, 0xffff0000, v44
    v_pk_mul_f32 v[118:119], v[118:119], v[88:89]
    v_pk_mul_f32 v[120:121], v[120:121], v[90:91]
    v_pk_mul_f32 v[122:123], v[122:123], v[92:93]
    v_pk_mul_f32 v[124:125], v[124:125], v[94:95]
    v_pk_mul_f32 v[126:127], v[126:127], v[96:97]
    v_pk_mul_f32 v[128:129], v[128:129], v[98:99]
    v_pk_mul_f32 v[130:131], v[130:131], v[100:101]
    v_pk_mul_f32 v[132:133], v[132:133], v[102:103]
    v_cvt_pk_bf16_f32 v136, v118, v120
    v_cvt_pk_bf16_f32 v137, v122, v124
    v_cvt_pk_bf16_f32 v138, v126, v128
    v_cvt_pk_bf16_f32 v139, v130, v132
    v_cvt_pk_bf16_f32 v140, v119, v121
    v_cvt_pk_bf16_f32 v141, v123, v125
    v_cvt_pk_bf16_f32 v142, v127, v129
    v_cvt_pk_bf16_f32 v143, v131, v133
    ds_write_b128 v201, v[136:139]
    ds_write_b128 v201, v[140:143] offset:128
    s_waitcnt vmcnt(3)
    v_perm_b32 v136, v75, v74, s34
    v_perm_b32 v137, v77, v76, s34
    v_perm_b32 v138, v79, v78, s34
    v_perm_b32 v139, v81, v80, s34
    v_perm_b32 v140, v75, v74, s35
    v_perm_b32 v141, v77, v76, s35
    v_perm_b32 v142, v79, v78, s35
    v_perm_b32 v143, v81, v80, s35
    ds_write_b128 v201, v[136:139] offset:8704
    ds_write_b128 v201, v[140:143] offset:8832
    s_mov_b64 exec, 1
    ds_add_u32 v230, v231
    s_mov_b64 exec, -1
    s_mov_b32 s64, 0
L_dsync:
    ds_read_b32 v232, v230 offset:0
    s_add_u32 s64, s64, 1
    s_waitcnt lgkmcnt(0)
    v_cmp_ne_u32 vcc, 4, v232
    s_cbranch_vccz L_dsyncx
    s_cmp_lt_u32 s64, 262144
    s_cbranch_scc1 L_dsync
L_dsyncx:
    ds_read_b128 v[144:147], v202
    ds_read_b128 v[148:151], v202 offset:1088
    ds_read_b128 v[152:155], v202 offset:8704
    ds_read_b128 v[156:159], v202 offset:9792
    s_waitcnt vmcnt(0)
    s_mov_b64 exec, 1
    buffer_store_dword v209, v244, s[20:23], s76 offen sc1
    s_mov_b64 exec, -1
    s_waitcnt lgkmcnt(3)
    buffer_store_dwordx4 v[144:147], v203, s[20:23], s71 offen sc1
    s_waitcnt lgkmcnt(2)
    buffer_store_dwordx4 v[148:151], v203, s[20:23], s72 offen sc1
    s_waitcnt lgkmcnt(1)
    buffer_store_dwordx4 v[152:155], v203, s[20:23], s65 offen sc1
    s_waitcnt lgkmcnt(0)
    buffer_store_dwordx4 v[156:159], v203, s[20:23], s66 offen sc1
    s_lshl_b32 s99, s6, 9
    s_add_u32 s99, s99, 4096
    s_mov_b32 m0, s47
    s_nop 0
    buffer_load_dwordx4 v217, s[28:31], s45 offen lds
    buffer_load_dwordx4 v217, s[28:31], s45 offen offset:2048 lds
    v_mov_b32 v30, 0
    v_mov_b32 v31, 0
    v_mov_b32 v38, 0
    v_mov_b32 v39, 0
    v_mov_b32 v46, 0
    v_mov_b32 v47, 0
    s_add_u32 s66, s79, 4224
    s_add_u32 s71, s79, 2433024
    s_add_u32 s72, s79, 2437248
    s_cmp_eq_u32 s6, 0
    s_cselect_b32 s54, 8, 32
    v_add_u32 v249, s54, v230
    v_mul_u32_u24 v248, 16, v1
    s_mul_i32 s68, s6, 1024
    s_add_u32 s68, s68, 393216
    s_mul_i32 s69, s5, 16512
    s_lshl_b32 s51, s6, 12
    s_add_u32 s69, s69, s51
    s_add_u32 s69, s69, 5390336
    s_add_u32 s51, s51, 127104
    v_and_b32 v232, 3, v1
    v_bfe_u32 v243, v1, 2, 1
    v_mul_u32_u24 v243, 252, v243
    v_lshl_add_u32 v243, v232, 9, v243
    s_lshr_b32 s54, s6, 1
    s_lshl_b32 s54, s54, 11
    s_and_b32 s55, s6, 1
    s_lshl_b32 s55, s55, 8
    s_add_u32 s54, s54, s55
    v_add_u32 v242, s54, v243
    v_lshlrev_b32 v225, 2, v1
    v_add_u32 v216, s54, v225
    s_lshl_b32 s54, s6, 11
    v_add_u32 v214, s54, v210
    v_add_u32 v215, s54, v243
    s_lshl_b32 s54, s6, 8
    s_add_u32 s54, s54, 152224
    v_add_u32 v212, s54, v225
    s_lshl_b32 s54, s6, 7
    s_add_u32 s54, s54, 152224
    v_lshl_add_u32 v218, v1, 1, s54
    v_add_u32 v219, s57, v1
    v_and_b32 v220, 7, v219
    v_lshrrev_b32 v219, 3, v219
    v_lshlrev_b32 v220, 1, v220
    v_lshl_add_u32 v219, v219, 6, v220
    v_add_u32 v219, 127136, v219
    v_and_b32 v233, 7, v1
    v_lshrrev_b32 v232, 3, v1
    v_lshlrev_b32 v220, 1, v233
    v_lshl_add_u32 v220, v232, 6, v220
    v_add_u32 v220, 127136, v220
    v_mul_u32_u24 v221, 1152, v1
    s_lshl_b32 s54, s5, 2
    v_add_u32 v221, s54, v221
    s_add_u32 s53, s54, s6
    s_lshl_b32 s43, s4, 2
    s_add_u32 s43, s43, s6
    s_cmp_eq_u32 s55, 0
    s_cselect_b32 s55, 4, 0
    s_cmp_eq_u32 s43, 0
    s_cselect_b32 s55, 0, s55
    s_cmp_eq_u32 s43, 29
    s_cselect_b32 s50, 60, 64
    v_cmp_le_u32 vcc, s55, v1
    v_cmp_gt_u32 s[48:49], s50, v1
    s_nop 0
    s_and_b64 vcc, vcc, s[48:49]
    v_mov_b32 v222, 0x40000000
    v_cndmask_b32 v222, v222, v221, vcc
    s_add_u32 s40, s6, 16
    s_mul_i32 s40, s40, 73728
    s_lshl_b32 s54, s4, 7
    s_add_u32 s40, s40, s54
    s_mul_i32 s52, s53, 9216
    s_add_u32 s52, s52, s54
    s_mul_i32 s41, s57, 1152
    s_add_u32 s41, s41, 1024
    s_mov_b32 s42, 1024
    s_lshl_b32 s32, s4, 3
    s_add_u32 s33, s32, s6
    s_lshl_b32 s33, s33, 5
    s_add_u32 s33, s33, s5
    s_lshl_b32 s33, s33, 10
    s_add_u32 s33, s33, 6291456
    s_lshr_b32 s54, s5, 2
    s_add_u32 s32, s32, s54
    s_lshl_b32 s32, s32, 15
    s_and_b32 s54, s53, 15
    s_lshl_b32 s54, s54, 6
    s_add_u32 s32, s32, s54
    s_add_u32 s32, s32, 6291456
    v_lshlrev_b32 v245, 12, v232
    v_lshl_add_u32 v245, v233, 3, v245
    v_lshlrev_b32 v246, 2, v232
    v_lshl_add_u32 v246, v233, 5, v246
    v_mul_u32_u24 v247, 1152, v232
    v_lshl_add_u32 v247, v233, 4, v247
    v_mov_b32 v89, s7
    v_mov_b32 v91, s7
    s_mov_b32 s64, 0
    s_mov_b64 exec, 1
    s_waitcnt vmcnt(2)
    buffer_store_dword v209, v206, s[20:23], s75 offen
    ds_write_b16 v228, v227
    ds_add_u32 v230, v231 offset:20
    s_mov_b64 exec, -1
    s_waitcnt vmcnt(1)
    s_mov_b64 exec, 1
    ds_write_b16_d16_hi v223, v227
    ds_add_u32 v230, v231 offset:12
    s_mov_b64 exec, -1
    s_cmp_lg_u32 s6, 0
    s_cbranch_scc1 L_follow
L_fpoll:
    buffer_load_dword v232, v238, s[20:23], s70 offen sc1
    s_add_u32 s64, s64, 1
    s_waitcnt vmcnt(0)
    v_cmp_ne_u32 vcc, s7, v232
    s_cbranch_vccz L_fok
    s_sleep 1
    s_cmp_lt_u32 s64, 40
    s_cbranch_scc1 L_fpoll
    s_branch L_fslow
L_fok:
    s_mov_b32 m0, 143520
    s_nop 0
    buffer_load_dwordx4 v217, s[20:23], s79 offen offset:0 sc1 lds
    buffer_load_dwordx4 v217, s[20:23], s79 offen offset:1024 sc1 lds
    s_mov_b32 m0, 147872
    s_nop 0
    buffer_load_dwordx4 v217, s[20:23], s66 offen offset:0 sc1 lds
    buffer_load_dwordx4 v217, s[20:23], s66 offen offset:1024 sc1 lds
    s_mov_b32 m0, 152224
    s_nop 0
    buffer_load_dwordx4 v217, s[20:23], s71 offen offset:0 sc1 lds
    buffer_load_dwordx4 v217, s[20:23], s71 offen offset:1024 sc1 lds
    s_mov_b32 m0, 156576
    s_nop 0
    buffer_load_dwordx4 v217, s[20:23], s72 offen offset:0 sc1 lds
    buffer_load_dwordx4 v217, s[20:23], s72 offen offset:1024 sc1 lds
    ds_write_b32 v230, v231 offset:16
    buffer_load_dword v213, v248, s[20:23], s68 offen sc1
    buffer_load_dwordx2 v[2:3], v210, s[20:23], s99 offen offset:0 sc1
    buffer_load_dwordx2 v[4:5], v210, s[20:23], s99 offen offset:2048 sc1
    buffer_load_dwordx2 v[6:7], v250, s[20:23], s98 offen offset:0 sc1
    buffer_load_dwordx2 v[8:9], v250, s[20:23], s98 offen offset:1024 sc1
    buffer_load_dwordx2 v[10:11], v250, s[20:23], s98 offen offset:2048 sc1
    buffer_load_dwordx2 v[12:13], v250, s[20:23], s98 offen offset:3072 sc1
    buffer_load_dwordx2 v[14:15], v250, s[20:23], s96 offen sc1
    buffer_load_dwordx2 v[16:17], v250, s[20:23], s101 offen sc1
    s_waitcnt vmcnt(9)
    ds_write_b32 v230, v231 offset:4
    s_mov_b32 m0, 143520
    s_nop 0
    buffer_load_dwordx4 v217, s[20:23], s79 offen offset:2048 sc1 lds
    buffer_load_dwordx4 v217, s[20:23], s79 offen offset:3072 sc1 lds
    s_mov_b32 m0, 147872
    s_nop 0
    buffer_load_dwordx4 v217, s[20:23], s66 offen offset:2048 sc1 lds
    buffer_load_dwordx4 v217, s[20:23], s66 offen offset:3072 sc1 lds
    s_mov_b32 m0, 152224
    s_nop 0
    buffer_load_dwordx4 v217, s[20:23], s71 offen offset:2048 sc1 lds
    buffer_load_dwordx4 v217, s[20:23], s71 offen offset:3072 sc1 lds
    s_mov_b32 m0, 156576
    s_nop 0
    buffer_load_dwordx4 v217, s[20:23], s72 offen offset:2048 sc1 lds
    buffer_load_dwordx4 v217, s[20:23], s72 offen offset:3072 sc1 lds
    s_branch L_joined
L_follow:
    s_setprio 0
    s_cmp_lg_u32 s6, 3
    s_cbranch_scc1 L_rett
    s_mov_b64 exec, 0
    s_cmp_eq_u32 s4, 0
    s_cbranch_scc1 L_padt0
    s_cmp_eq_u32 s4, 1
    s_cbranch_scc1 L_padt1
    s_cmp_eq_u32 s4, 2
    s_cbranch_scc1 L_padt2
    s_cmp_eq_u32 s4, 3
    s_cbranch_scc1 L_padt3
    s_cmp_eq_u32 s4, 4
    s_cbranch_scc1 L_padt4
    s_cmp_eq_u32 s4, 5
    s_cbranch_scc1 L_padt5
    s_cmp_eq_u32 s4, 6
    s_cbranch_scc1 L_padt6
    s_cmp_eq_u32 s4, 7
    s_cbranch_scc1 L_padt7
L_rett:
    s_cmp_lg_u32 s6, 2
    s_cbranch_scc1 L_retc
    s_mov_b64 exec, 0
    s_branch L_padc
L_retc:
    s_mov_b64 exec, -1
    s_mov_b32 s64, 0
L_fwait:
    ds_read_b32 v232, v230 offset:16
    s_add_u32 s64, s64, 1
    s_waitcnt lgkmcnt(0)
    v_cmp_ne_u32 vcc, 1, v232
    s_cbranch_vccz L_fgo
    s_sleep 1
    s_cmp_lt_u32 s64, 80
    s_cbranch_scc1 L_fwait
    s_mov_b64 exec, 1
    buffer_store_dword v209, v206, s[20:23], s56 offen sc1
    s_mov_b64 exec, -1
L_fgo:
    buffer_load_dword v213, v248, s[20:23], s68 offen sc1
    buffer_load_dwordx2 v[2:3], v210, s[20:23], s99 offen offset:0 sc1
    buffer_load_dwordx2 v[4:5], v210, s[20:23], s99 offen offset:2048 sc1
    buffer_load_dwordx2 v[6:7], v250, s[20:23], s98 offen offset:0 sc1
    buffer_load_dwordx2 v[8:9], v250, s[20:23], s98 offen offset:1024 sc1
    buffer_load_dwordx2 v[10:11], v250, s[20:23], s98 offen offset:2048 sc1
    buffer_load_dwordx2 v[12:13], v250, s[20:23], s98 offen offset:3072 sc1
    buffer_load_dwordx2 v[14:15], v250, s[20:23], s96 offen sc1
    buffer_load_dwordx2 v[16:17], v250, s[20:23], s101 offen sc1
    s_waitcnt vmcnt(0)
L_joined:
    s_setprio 3
    s_waitcnt vmcnt(8)
    s_mov_b32 s64, 0
L_epoll:
    v_cmp_ne_u32 vcc, s7, v213
    s_cbranch_vccz L_eok
    s_sleep 4
    buffer_load_dword v213, v248, s[20:23], s68 offen sc1
    s_add_u32 s64, s64, 1
    s_cmp_lt_u32 s64, 32768
    s_waitcnt vmcnt(0)
    s_cbranch_scc1 L_epoll
L_eok:
    s_mov_b32 m0, s51
    s_nop 0
    buffer_load_dwordx4 v217, s[20:23], s69 offen offset:0 sc1 lds
    buffer_load_dwordx4 v217, s[20:23], s69 offen offset:1024 sc1 lds
    buffer_load_dwordx4 v217, s[20:23], s69 offen offset:2048 sc1 lds
    buffer_load_dwordx4 v217, s[20:23], s69 offen offset:3072 sc1 lds
    s_mov_b32 s64, 0
L_gchk:
    v_xor_b32 v3, s7, v3
    v_xor_b32 v5, s7, v5
    v_xor_b32 v7, s7, v7
    v_xor_b32 v9, s7, v9
    v_xor_b32 v11, s7, v11
    v_xor_b32 v13, s7, v13
    v_xor_b32 v15, s7, v15
    v_xor_b32 v17, s7, v17
    v_or3_b32 v211, v3, v5, v7
    v_or3_b32 v211, v211, v9, v11
    v_or3_b32 v211, v211, v13, v15
    v_or_b32 v211, v211, v17
    v_cmp_ne_u32 vcc, 0, v211
    s_cbranch_vccz L_gok
    s_sleep 8
    buffer_load_dwordx2 v[2:3], v210, s[20:23], s99 offen offset:0 sc1
    buffer_load_dwordx2 v[4:5], v210, s[20:23], s99 offen offset:2048 sc1
    buffer_load_dwordx2 v[6:7], v250, s[20:23], s98 offen offset:0 sc1
    buffer_load_dwordx2 v[8:9], v250, s[20:23], s98 offen offset:1024 sc1
    buffer_load_dwordx2 v[10:11], v250, s[20:23], s98 offen offset:2048 sc1
    buffer_load_dwordx2 v[12:13], v250, s[20:23], s98 offen offset:3072 sc1
    buffer_load_dwordx2 v[14:15], v250, s[20:23], s96 offen sc1
    buffer_load_dwordx2 v[16:17], v250, s[20:23], s101 offen sc1
    s_add_u32 s64, s64, 1
    s_cmp_lt_u32 s64, 32768
    s_waitcnt vmcnt(0)
    s_cbranch_scc1 L_gchk
L_gok:
    s_setprio 0
    s_waitcnt vmcnt(4)
    ds_write_b32 v249, v231
    v_cvt_f32_f16_sdwa v3, v2 dst_sel:DWORD dst_unused:UNUSED_PAD src0_sel:WORD_1
    v_cvt_f32_f16 v2, v2
    s_mov_b32 s64, 0
    s_branch L_vp0
L_wp0:
    s_sleep 1
L_vp0:
    ds_read_b32 v66, v215 offset:256
    s_add_u32 s64, s64, 1
    s_cmp_ge_u32 s64, 131072
    s_waitcnt lgkmcnt(0)
    s_cbranch_scc1 L_tp0
    v_cmp_eq_u32 vcc, -1, v66
    s_cbranch_vccnz L_wp0
L_tp0:
    ds_read2st64_b64 v[56:59], v214 offset0:0 offset1:1
    ds_read2st64_b64 v[60:63], v214 offset0:2 offset1:3
    ds_read2st64_b32 v[64:65], v212 offset0:0 offset1:17
    s_waitcnt lgkmcnt(0)
L_up0:
    v_lshlrev_b32 v80, 16, v64
    v_and_b32 v81, 0xffff0000, v64
    v_lshlrev_b32 v82, 16, v65
    v_and_b32 v83, 0xffff0000, v65
    v_fma_f32 v80, v80, v56, -v60
    v_fma_f32 v81, v81, v57, -v61
    v_fma_f32 v82, v82, v58, -v62
    v_fma_f32 v83, v83, v59, -v63
    v_fma_f32 v80, v2, v80, v60
    v_fma_f32 v81, v3, v81, v61
    v_fma_f32 v82, v2, v82, v62
    v_fma_f32 v83, v3, v83, v63
    v_cvt_pk_bf16_f32 v88, v80, v82
    v_cvt_pk_bf16_f32 v90, v81, v83
    buffer_store_dwordx4 v[88:91], v217, s[20:23], s33 offen sc1
    s_add_u32 s33, s33, 131072
    v_cvt_f32_f16_sdwa v5, v4 dst_sel:DWORD dst_unused:UNUSED_PAD src0_sel:WORD_1
    v_cvt_f32_f16 v4, v4
    s_mov_b32 s64, 0
    s_branch L_vp1
L_wp1:
    s_sleep 1
L_vp1:
    ds_read_b32 v78, v215 offset:8448
    s_add_u32 s64, s64, 1
    s_cmp_ge_u32 s64, 131072
    s_waitcnt lgkmcnt(0)
    s_cbranch_scc1 L_tp1
    v_cmp_eq_u32 vcc, -1, v78
    s_cbranch_vccnz L_wp1
L_tp1:
    ds_read2st64_b64 v[68:71], v214 offset0:16 offset1:17
    ds_read2st64_b64 v[72:75], v214 offset0:18 offset1:19
    ds_read2st64_b32 v[76:77], v212 offset0:4 offset1:21
    s_waitcnt lgkmcnt(0)
L_up1:
    v_lshlrev_b32 v80, 16, v76
    v_and_b32 v81, 0xffff0000, v76
    v_lshlrev_b32 v82, 16, v77
    v_and_b32 v83, 0xffff0000, v77
    v_fma_f32 v80, v80, v68, -v72
    v_fma_f32 v81, v81, v69, -v73
    v_fma_f32 v82, v82, v70, -v74
    v_fma_f32 v83, v83, v71, -v75
    v_fma_f32 v80, v4, v80, v72
    v_fma_f32 v81, v5, v81, v73
    v_fma_f32 v82, v4, v82, v74
    v_fma_f32 v83, v5, v83, v75
    v_cvt_pk_bf16_f32 v88, v80, v82
    v_cvt_pk_bf16_f32 v90, v81, v83
    buffer_store_dwordx4 v[88:91], v217, s[20:23], s33 offen sc1
    s_add_u32 s33, s33, 131072
    s_waitcnt vmcnt(2)
    s_mov_b64 exec, 1
    ds_add_u32 v230, v231 offset:28
    s_mov_b64 exec, -1
    v_lshrrev_b32 v6, v251, v6
    v_cvt_f32_f16 v6, v6
    s_mov_b32 s64, 0
    s_branch L_vo4
L_wo4:
    s_sleep 1
L_vo4:
    ds_read_b32 v32, v242 offset:16384
    s_add_u32 s64, s64, 1
    s_cmp_ge_u32 s64, 131072
    s_waitcnt lgkmcnt(0)
    s_cbranch_scc1 L_to4
    v_cmp_eq_u32 vcc, -1, v32
    s_cbranch_vccnz L_wo4
L_to4:
    ds_read2st64_b32 v[26:27], v216 offset0:64 offset1:66
    ds_read2st64_b32 v[28:29], v216 offset0:68 offset1:70
    ds_read_u16_d16_hi v30, v218 offset:2048
    ds_read_u16_d16_hi v31, v218 offset:6400
    s_waitcnt lgkmcnt(0)
L_uo4:
    v_fma_f32 v50, v30, v26, -v28
    v_fma_f32 v51, v31, v27, -v29
    v_fma_f32 v50, v6, v50, v28
    v_fma_f32 v51, v6, v51, v29
    v_cvt_pk_bf16_f32 v50, v50, v51
    buffer_store_dword v50, v221, s[24:27], s40 offen
    s_add_u32 s40, s40, 294912
    s_mov_b64 exec, 1
    buffer_store_dword v209, v206, s[20:23], s56 offen sc1
    s_mov_b64 exec, -1
    v_lshrrev_b32 v8, v251, v8
    v_cvt_f32_f16 v8, v8
    s_mov_b32 s64, 0
    s_branch L_vo5
L_wo5:
    s_sleep 1
L_vo5:
    ds_read_b32 v40, v242 offset:20480
    s_add_u32 s64, s64, 1
    s_cmp_ge_u32 s64, 131072
    s_waitcnt lgkmcnt(0)
    s_cbranch_scc1 L_to5
    v_cmp_eq_u32 vcc, -1, v40
    s_cbranch_vccnz L_wo5
L_to5:
    ds_read2st64_b32 v[34:35], v216 offset0:80 offset1:82
    ds_read2st64_b32 v[36:37], v216 offset0:84 offset1:86
    ds_read_u16_d16_hi v38, v218 offset:2560
    ds_read_u16_d16_hi v39, v218 offset:6912
    s_waitcnt lgkmcnt(0)
L_uo5:
    v_fma_f32 v52, v38, v34, -v36
    v_fma_f32 v53, v39, v35, -v37
    v_fma_f32 v52, v8, v52, v36
    v_fma_f32 v53, v8, v53, v37
    v_cvt_pk_bf16_f32 v52, v52, v53
    buffer_store_dword v52, v221, s[24:27], s40 offen
    s_add_u32 s40, s40, 294912
    buffer_load_dwordx2 v[92:93], v245, s[20:23], s32 offen offset:0 sc1
    buffer_load_dwordx2 v[94:95], v245, s[20:23], s32 offen offset:1024 sc1
    buffer_load_dwordx2 v[96:97], v245, s[20:23], s32 offen offset:2048 sc1
    buffer_load_dwordx2 v[98:99], v245, s[20:23], s32 offen offset:3072 sc1
    s_cmp_lg_u32 s43, 2
    s_cbranch_scc1 L_nol0
    v_lshrrev_b32 v16, v251, v16
    v_cvt_f32_f16 v16, v16
    s_mov_b32 s64, 0
    s_branch L_vz
L_wz:
    s_sleep 1
L_vz:
    ds_read_b32 v48, v243 offset:36864
    s_add_u32 s64, s64, 1
    s_cmp_ge_u32 s64, 131072
    s_waitcnt lgkmcnt(0)
    s_cbranch_scc1 L_tz
    v_cmp_eq_u32 vcc, -1, v48
    s_cbranch_vccnz L_wz
L_tz:
    ds_read2st64_b32 v[42:43], v225 offset0:144 offset1:146
    ds_read2st64_b32 v[44:45], v225 offset0:148 offset1:150
    ds_read_u16_d16_hi v46, v220 offset:0
    ds_read_u16_d16_hi v47, v220 offset:16
    s_waitcnt lgkmcnt(0)
L_uz:
    v_fma_f32 v54, v46, v42, -v44
    v_fma_f32 v55, v47, v43, -v45
    v_fma_f32 v54, v16, v54, v44
    v_fma_f32 v55, v16, v55, v45
    v_cvt_pk_bf16_f32 v54, v54, v55
    buffer_store_dword v54, v221, s[24:27], s42 offen
L_nol0:
    v_lshrrev_b32 v14, v251, v14
    v_cvt_f32_f16 v14, v14
    s_mov_b32 s64, 0
    s_branch L_vs
L_ws:
    s_sleep 1
L_vs:
    ds_read_b32 v32, v242 offset:32768
    s_add_u32 s64, s64, 1
    s_cmp_ge_u32 s64, 131072
    s_waitcnt lgkmcnt(0)
    s_cbranch_scc1 L_ts
    v_cmp_eq_u32 vcc, -1, v32
    s_cbranch_vccnz L_ws
L_ts:
    ds_read2st64_b32 v[26:27], v216 offset0:128 offset1:130
    ds_read2st64_b32 v[28:29], v216 offset0:132 offset1:134
    ds_read_u16_d16_hi v30, v219 offset:0
    ds_read_u16_d16_hi v31, v219 offset:16
    s_waitcnt lgkmcnt(0)
L_us:
    v_fma_f32 v50, v30, v26, -v28
    v_fma_f32 v51, v31, v27, -v29
    v_fma_f32 v50, v14, v50, v28
    v_fma_f32 v51, v14, v51, v29
    v_cvt_pk_bf16_f32 v50, v50, v51
    buffer_store_dword v50, v222, s[24:27], s41 offen
    s_lshl_b32 s55, s2, 2
    s_add_u32 s55, s55, s6
    s_cmp_lg_u32 s55, 0
    s_cbranch_scc1 L_noepoch
    s_mov_b64 exec, 1
    buffer_store_dword v209, v206, s[20:23], 0 offen sc1
    s_mov_b64 exec, -1
L_noepoch:
    s_waitcnt vmcnt(1)
    s_mov_b32 s64, 0
L_oxchk:
    v_xor_b32 v93, s7, v93
    v_xor_b32 v95, s7, v95
    v_xor_b32 v97, s7, v97
    v_xor_b32 v99, s7, v99
    v_or3_b32 v93, v93, v95, v97
    v_or_b32 v93, v93, v99
    v_cmp_ne_u32 vcc, 0, v93
    s_cbranch_vccz L_oxok
    s_sleep 4
    buffer_load_dwordx2 v[92:93], v245, s[20:23], s32 offen offset:0 sc1
    buffer_load_dwordx2 v[94:95], v245, s[20:23], s32 offen offset:1024 sc1
    buffer_load_dwordx2 v[96:97], v245, s[20:23], s32 offen offset:2048 sc1
    buffer_load_dwordx2 v[98:99], v245, s[20:23], s32 offen offset:3072 sc1
    s_add_u32 s64, s64, 1
    s_cmp_lt_u32 s64, 32768
    s_waitcnt vmcnt(0)
    s_cbranch_scc1 L_oxchk
L_oxok:
    ds_bpermute_b32 v100, v246, v92
    ds_bpermute_b32 v101, v246, v94
    ds_bpermute_b32 v102, v246, v96
    ds_bpermute_b32 v103, v246, v98
    s_waitcnt lgkmcnt(0)
    buffer_store_dwordx4 v[100:103], v247, s[24:27], s52 offen sc1
    v_lshrrev_b32 v10, v251, v10
    v_cvt_f32_f16 v10, v10
    s_mov_b32 s64, 0
    s_branch L_vo6
L_wo6:
    s_sleep 1
L_vo6:
    ds_read_b32 v40, v242 offset:24576
    s_add_u32 s64, s64, 1
    s_cmp_ge_u32 s64, 131072
    s_waitcnt lgkmcnt(0)
    s_cbranch_scc1 L_to6
    v_cmp_eq_u32 vcc, -1, v40
    s_cbranch_vccnz L_wo6
L_to6:
    ds_read2st64_b32 v[34:35], v216 offset0:96 offset1:98
    ds_read2st64_b32 v[36:37], v216 offset0:100 offset1:102
    ds_read_u16_d16_hi v38, v218 offset:3072
    ds_read_u16_d16_hi v39, v218 offset:7424
    s_waitcnt lgkmcnt(0)
L_uo6:
    v_fma_f32 v52, v38, v34, -v36
    v_fma_f32 v53, v39, v35, -v37
    v_fma_f32 v52, v10, v52, v36
    v_fma_f32 v53, v10, v53, v37
    v_cvt_pk_bf16_f32 v52, v52, v53
    buffer_store_dword v52, v221, s[24:27], s40 offen
    s_add_u32 s40, s40, 294912
    v_lshrrev_b32 v12, v251, v12
    v_cvt_f32_f16 v12, v12
    s_mov_b32 s64, 0
    s_branch L_vo7
L_wo7:
L_vo7:
    ds_read_b32 v32, v242 offset:28672
    ds_read2st64_b32 v[26:27], v216 offset0:112 offset1:114
    ds_read2st64_b32 v[28:29], v216 offset0:116 offset1:118
    ds_read_u16_d16_hi v30, v218 offset:3584
    ds_read_u16_d16_hi v31, v218 offset:7936
    s_add_u32 s64, s64, 1
    s_cmp_ge_u32 s64, 131072
    s_waitcnt lgkmcnt(0)
    s_cbranch_scc1 L_to7
    v_cmp_eq_u32 vcc, -1, v32
    s_cbranch_vccnz L_wo7
L_to7:
L_uo7:
    v_fma_f32 v50, v30, v26, -v28
    v_fma_f32 v51, v31, v27, -v29
    v_fma_f32 v50, v12, v50, v28
    v_fma_f32 v51, v12, v51, v29
    v_cvt_pk_bf16_f32 v50, v50, v51
    buffer_store_dword v50, v221, s[24:27], s40 offen
    s_endpgm
L_fslow:
    s_mov_b64 exec, 1
    buffer_store_dword v209, v206, s[20:23], s56 offen sc1
    s_mov_b64 exec, -1
    s_lshr_b32 s54, s5, 3
    s_lshl_b32 s54, s54, 3
    s_add_u32 s54, s54, s4
    s_mul_i32 s54, s54, 512
    s_add_u32 s54, s54, 262144
    v_mul_u32_u24 v233, 16, v213
    s_mov_b32 s64, 0
L_fslow2:
    buffer_load_dword v232, v233, s[20:23], s54 offen sc1
    s_add_u32 s64, s64, 1
    s_waitcnt vmcnt(0)
    v_cmp_ne_u32 vcc, s7, v232
    s_cbranch_vccz L_fok
    s_sleep 8
    s_cmp_lt_u32 s64, 32768
    s_cbranch_scc1 L_fslow2
    s_branch L_fok
.p2align 12
L_matrix:
    s_setprio 1
    s_lshl_b32 s63, s63, 4
    s_waitcnt lgkmcnt(0)
    s_lshr_b32 s75, s75, s63
    s_lshl_b32 s75, s75, 16
    v_mov_b32 v30, s75
    v_mul_f32 v30, 0x3fb8aa3b, v30
    v_exp_f32 v30, v30
    s_nop 0
    v_cvt_pk_bf16_f32 v30, v30, v30
    v_lshlrev_b32 v30, 16, v30
    v_add_f32 v31, v30, v30
    s_waitcnt vmcnt(2)
    v_lshlrev_b32 v80, 16, v10
    v_and_b32 v81, 0xffff0000, v10
    v_mul_f32 v80, 0x3fb8aa3b, v80
    v_mul_f32 v81, 0x3fb8aa3b, v81
    v_exp_f32 v80, v80
    v_exp_f32 v81, v81
    v_lshlrev_b32 v50, 16, v11
    v_and_b32 v51, 0xffff0000, v11
    v_cvt_pk_bf16_f32 v80, v80, v81
    v_mul_f32 v50, v30, v50
    v_mul_f32 v51, v30, v51
    v_and_b32 v81, 0xffff0000, v80
    v_lshlrev_b32 v80, 16, v80
    v_mul_f32 v50, 0x3e22f983, v50
    v_mul_f32 v51, 0x3e22f983, v51
    v_mul_f32 v48, v30, v80
    v_mul_f32 v49, v30, v81
    v_mul_f32 v48, 0xbfb8aa3b, v48
    v_mul_f32 v49, 0xbfb8aa3b, v49
    v_mul_f32 v80, 0x41800000, v48
    v_mul_f32 v82, 0xc1800000, v50
    v_mul_f32 v81, 0x41800000, v49
    v_mul_f32 v83, 0xc1800000, v51
    v_exp_f32 v80, v80
    v_fract_f32 v82, v82
    v_exp_f32 v81, v81
    v_fract_f32 v83, v83
    v_cos_f32 v72, v82
    v_sin_f32 v74, v82
    v_cos_f32 v73, v83
    v_sin_f32 v75, v83
    v_pk_mul_f32 v[72:73], v[72:73], v[80:81]
    v_pk_mul_f32 v[74:75], v[74:75], v[80:81]
    v_exp_f32 v80, v48
    v_fract_f32 v82, v50
    v_exp_f32 v81, v49
    v_fract_f32 v83, v51
    v_cos_f32 v56, v82
    v_sin_f32 v58, v82
    v_cos_f32 v57, v83
    v_sin_f32 v59, v83
    v_pk_mul_f32 v[56:57], v[56:57], v[80:81]
    v_pk_mul_f32 v[58:59], v[58:59], v[80:81]
    v_mul_f32 v80, 0x43800000, v48
    v_mul_f32 v82, 0x43800000, v50
    v_mul_f32 v81, 0x43800000, v49
    v_mul_f32 v83, 0x43800000, v51
    v_exp_f32 v80, v80
    v_fract_f32 v82, v82
    v_exp_f32 v81, v81
    v_fract_f32 v83, v83
    v_cos_f32 v76, v82
    v_sin_f32 v78, v82
    v_cos_f32 v77, v83
    v_sin_f32 v79, v83
    v_pk_mul_f32 v[76:77], v[76:77], v[80:81]
    v_pk_mul_f32 v[78:79], v[78:79], v[80:81]
    s_waitcnt vmcnt(0)
    v_lshlrev_b32 v52, 16, v12
    v_and_b32 v53, 0xffff0000, v12
    v_lshlrev_b32 v54, 16, v13
    v_and_b32 v55, 0xffff0000, v13
    v_mul_f32 v52, v31, v52
    v_mul_f32 v53, v31, v53
    v_mul_f32 v54, v31, v54
    v_mul_f32 v55, v31, v55
.p2align 3
    v_mov_b32 v32, 0x3f803f80
    v_mov_b32_e64 v33, 0
    v_pk_mul_f32 v[84:85], v[72:73], v[72:73]
    v_pk_mul_f32 v[86:87], v[72:73], v[74:75]
    v_pk_fma_f32 v[84:85], v[74:75], v[74:75], v[84:85] neg_lo:[1,0,0] neg_hi:[1,0,0]
    v_pk_fma_f32 v[86:87], v[74:75], v[72:73], v[86:87]
    v_cvt_pk_bf16_f32 v34, v72, v73
    v_cvt_pk_bf16_f32 v35, v74, v75
    ds_write2_b64 v243, v[32:33], v[34:35] offset0:0 offset1:68
    v_pk_mul_f32 v[88:89], v[84:85], v[72:73]
    v_pk_mul_f32 v[90:91], v[84:85], v[74:75]
    v_pk_fma_f32 v[88:89], v[86:87], v[74:75], v[88:89] neg_lo:[1,0,0] neg_hi:[1,0,0]
    v_pk_fma_f32 v[90:91], v[86:87], v[72:73], v[90:91]
    v_cvt_pk_bf16_f32 v36, v84, v85
    v_cvt_pk_bf16_f32 v37, v86, v87
    v_pk_mul_f32 v[84:85], v[88:89], v[72:73]
    v_pk_mul_f32 v[86:87], v[88:89], v[74:75]
    v_pk_fma_f32 v[84:85], v[90:91], v[74:75], v[84:85] neg_lo:[1,0,0] neg_hi:[1,0,0]
    v_pk_fma_f32 v[86:87], v[90:91], v[72:73], v[86:87]
    v_cvt_pk_bf16_f32 v38, v88, v89
    v_cvt_pk_bf16_f32 v39, v90, v91
    ds_write2_b64 v243, v[36:37], v[38:39] offset0:136 offset1:204
    v_pk_mul_f32 v[88:89], v[84:85], v[72:73]
    v_pk_mul_f32 v[90:91], v[84:85], v[74:75]
    v_pk_fma_f32 v[88:89], v[86:87], v[74:75], v[88:89] neg_lo:[1,0,0] neg_hi:[1,0,0]
    v_pk_fma_f32 v[90:91], v[86:87], v[72:73], v[90:91]
    v_cvt_pk_bf16_f32 v32, v84, v85
    v_cvt_pk_bf16_f32 v33, v86, v87
    v_pk_mul_f32 v[84:85], v[88:89], v[72:73]
    v_pk_mul_f32 v[86:87], v[88:89], v[74:75]
    v_pk_fma_f32 v[84:85], v[90:91], v[74:75], v[84:85] neg_lo:[1,0,0] neg_hi:[1,0,0]
    v_pk_fma_f32 v[86:87], v[90:91], v[72:73], v[86:87]
    v_cvt_pk_bf16_f32 v34, v88, v89
    v_cvt_pk_bf16_f32 v35, v90, v91
    ds_write2_b64 v234, v[32:33], v[34:35] offset0:0 offset1:68
    v_pk_mul_f32 v[88:89], v[84:85], v[72:73]
    v_pk_mul_f32 v[90:91], v[84:85], v[74:75]
    v_pk_fma_f32 v[88:89], v[86:87], v[74:75], v[88:89] neg_lo:[1,0,0] neg_hi:[1,0,0]
    v_pk_fma_f32 v[90:91], v[86:87], v[72:73], v[90:91]
    v_cvt_pk_bf16_f32 v36, v84, v85
    v_cvt_pk_bf16_f32 v37, v86, v87
    v_pk_mul_f32 v[84:85], v[88:89], v[72:73]
    v_pk_mul_f32 v[86:87], v[88:89], v[74:75]
    v_pk_fma_f32 v[84:85], v[90:91], v[74:75], v[84:85] neg_lo:[1,0,0] neg_hi:[1,0,0]
    v_pk_fma_f32 v[86:87], v[90:91], v[72:73], v[86:87]
    v_cvt_pk_bf16_f32 v38, v88, v89
    v_cvt_pk_bf16_f32 v39, v90, v91
    ds_write2_b64 v234, v[36:37], v[38:39] offset0:136 offset1:204
    v_pk_mul_f32 v[88:89], v[84:85], v[72:73]
    v_pk_mul_f32 v[90:91], v[84:85], v[74:75]
    v_pk_fma_f32 v[88:89], v[86:87], v[74:75], v[88:89] neg_lo:[1,0,0] neg_hi:[1,0,0]
    v_pk_fma_f32 v[90:91], v[86:87], v[72:73], v[90:91]
    v_cvt_pk_bf16_f32 v32, v84, v85
    v_cvt_pk_bf16_f32 v33, v86, v87
    v_pk_mul_f32 v[84:85], v[88:89], v[72:73]
    v_pk_mul_f32 v[86:87], v[88:89], v[74:75]
    v_pk_fma_f32 v[84:85], v[90:91], v[74:75], v[84:85] neg_lo:[1,0,0] neg_hi:[1,0,0]
    v_pk_fma_f32 v[86:87], v[90:91], v[72:73], v[86:87]
    v_cvt_pk_bf16_f32 v34, v88, v89
    v_cvt_pk_bf16_f32 v35, v90, v91
    ds_write2_b64 v235, v[32:33], v[34:35] offset0:0 offset1:68
    v_pk_mul_f32 v[88:89], v[84:85], v[72:73]
    v_pk_mul_f32 v[90:91], v[84:85], v[74:75]
    v_pk_fma_f32 v[88:89], v[86:87], v[74:75], v[88:89] neg_lo:[1,0,0] neg_hi:[1,0,0]
    v_pk_fma_f32 v[90:91], v[86:87], v[72:73], v[90:91]
    v_cvt_pk_bf16_f32 v36, v84, v85
    v_cvt_pk_bf16_f32 v37, v86, v87
    v_pk_mul_f32 v[84:85], v[88:89], v[72:73]
    v_pk_mul_f32 v[86:87], v[88:89], v[74:75]
    v_pk_fma_f32 v[84:85], v[90:91], v[74:75], v[84:85] neg_lo:[1,0,0] neg_hi:[1,0,0]
    v_pk_fma_f32 v[86:87], v[90:91], v[72:73], v[86:87]
    v_cvt_pk_bf16_f32 v38, v88, v89
    v_cvt_pk_bf16_f32 v39, v90, v91
    ds_write2_b64 v235, v[36:37], v[38:39] offset0:136 offset1:204
    v_pk_mul_f32 v[88:89], v[84:85], v[72:73]
    v_pk_mul_f32 v[90:91], v[84:85], v[74:75]
    v_pk_fma_f32 v[88:89], v[86:87], v[74:75], v[88:89] neg_lo:[1,0,0] neg_hi:[1,0,0]
    v_pk_fma_f32 v[90:91], v[86:87], v[72:73], v[90:91]
    v_cvt_pk_bf16_f32 v32, v84, v85
    v_cvt_pk_bf16_f32 v33, v86, v87
    v_pk_mul_f32 v[84:85], v[88:89], v[72:73]
    v_pk_mul_f32 v[86:87], v[88:89], v[74:75]
    v_pk_fma_f32 v[84:85], v[90:91], v[74:75], v[84:85] neg_lo:[1,0,0] neg_hi:[1,0,0]
    v_pk_fma_f32 v[86:87], v[90:91], v[72:73], v[86:87]
    v_cvt_pk_bf16_f32 v34, v88, v89
    v_cvt_pk_bf16_f32 v35, v90, v91
    ds_write2_b64 v236, v[32:33], v[34:35] offset0:0 offset1:68
    v_pk_mul_f32 v[88:89], v[84:85], v[72:73]
    v_pk_mul_f32 v[90:91], v[84:85], v[74:75]
    v_pk_fma_f32 v[88:89], v[86:87], v[74:75], v[88:89] neg_lo:[1,0,0] neg_hi:[1,0,0]
    v_pk_fma_f32 v[90:91], v[86:87], v[72:73], v[90:91]
    v_cvt_pk_bf16_f32 v36, v84, v85
    v_cvt_pk_bf16_f32 v37, v86, v87
    v_cvt_pk_bf16_f32 v38, v88, v89
    v_cvt_pk_bf16_f32 v39, v90, v91
    ds_write2_b64 v236, v[36:37], v[38:39] offset0:136 offset1:204
    ds_read_b128 v[128:131], v244 offset:0
    ds_read_b128 v[132:135], v244 offset:64
    ds_read_b128 v[136:139], v244 offset:128
    ds_read_b128 v[140:143], v244 offset:192
    ds_read_b128 v[144:147], v244 offset:256
    ds_read_b128 v[148:151], v244 offset:320
    ds_read_b128 v[152:155], v244 offset:384
    ds_read_b128 v[156:159], v244 offset:448
    v_pk_mul_f32 v[60:61], v[56:57], v[56:57]
    v_pk_mul_f32 v[62:63], v[56:57], v[58:59]
    v_pk_fma_f32 v[60:61], v[58:59], v[58:59], v[60:61] neg_lo:[1,0,0] neg_hi:[1,0,0]
    v_pk_fma_f32 v[62:63], v[58:59], v[56:57], v[62:63]
    v_pk_mul_f32 v[64:65], v[60:61], v[60:61]
    v_pk_mul_f32 v[66:67], v[60:61], v[62:63]
    v_pk_fma_f32 v[64:65], v[62:63], v[62:63], v[64:65] neg_lo:[1,0,0] neg_hi:[1,0,0]
    v_pk_fma_f32 v[66:67], v[62:63], v[60:61], v[66:67]
    v_pk_mul_f32 v[68:69], v[64:65], v[64:65]
    v_pk_mul_f32 v[70:71], v[64:65], v[66:67]
    v_pk_fma_f32 v[68:69], v[66:67], v[66:67], v[68:69] neg_lo:[1,0,0] neg_hi:[1,0,0]
    v_pk_fma_f32 v[70:71], v[66:67], v[64:65], v[70:71]
    v_pk_mul_f32 v[84:85], v[52:53], v[56:57]
    v_pk_mul_f32 v[86:87], v[52:53], v[58:59]
    v_pk_fma_f32 v[84:85], v[54:55], v[58:59], v[84:85] neg_lo:[1,0,0] neg_hi:[1,0,0]
    v_pk_fma_f32 v[86:87], v[54:55], v[56:57], v[86:87]
    v_cvt_pk_bf16_f32 v32, v52, v53
    v_cvt_pk_bf16_f32 v33, v54, v55
    v_pk_mul_f32 v[88:89], v[84:85], v[56:57]
    v_pk_mul_f32 v[90:91], v[84:85], v[58:59]
    v_pk_fma_f32 v[88:89], v[86:87], v[58:59], v[88:89] neg_lo:[1,0,0] neg_hi:[1,0,0]
    v_pk_fma_f32 v[90:91], v[86:87], v[56:57], v[90:91]
    v_cvt_pk_bf16_f32 v34, v84, v85
    v_cvt_pk_bf16_f32 v35, v86, v87
    ds_write2_b64 v243, v[32:33], v[34:35] offset0:0 offset1:68
    v_pk_mul_f32 v[84:85], v[88:89], v[56:57]
    v_pk_mul_f32 v[86:87], v[88:89], v[58:59]
    v_pk_fma_f32 v[84:85], v[90:91], v[58:59], v[84:85] neg_lo:[1,0,0] neg_hi:[1,0,0]
    v_pk_fma_f32 v[86:87], v[90:91], v[56:57], v[86:87]
    v_cvt_pk_bf16_f32 v36, v88, v89
    v_cvt_pk_bf16_f32 v37, v90, v91
    v_pk_mul_f32 v[88:89], v[84:85], v[56:57]
    v_pk_mul_f32 v[90:91], v[84:85], v[58:59]
    v_pk_fma_f32 v[88:89], v[86:87], v[58:59], v[88:89] neg_lo:[1,0,0] neg_hi:[1,0,0]
    v_pk_fma_f32 v[90:91], v[86:87], v[56:57], v[90:91]
    v_cvt_pk_bf16_f32 v38, v84, v85
    v_cvt_pk_bf16_f32 v39, v86, v87
    ds_write2_b64 v243, v[36:37], v[38:39] offset0:136 offset1:204
    v_pk_mul_f32 v[84:85], v[88:89], v[56:57]
    v_pk_mul_f32 v[86:87], v[88:89], v[58:59]
    v_pk_fma_f32 v[84:85], v[90:91], v[58:59], v[84:85] neg_lo:[1,0,0] neg_hi:[1,0,0]
    v_pk_fma_f32 v[86:87], v[90:91], v[56:57], v[86:87]
    v_cvt_pk_bf16_f32 v32, v88, v89
    v_cvt_pk_bf16_f32 v33, v90, v91
    v_pk_mul_f32 v[88:89], v[84:85], v[56:57]
    v_pk_mul_f32 v[90:91], v[84:85], v[58:59]
    v_pk_fma_f32 v[88:89], v[86:87], v[58:59], v[88:89] neg_lo:[1,0,0] neg_hi:[1,0,0]
    v_pk_fma_f32 v[90:91], v[86:87], v[56:57], v[90:91]
    v_cvt_pk_bf16_f32 v34, v84, v85
    v_cvt_pk_bf16_f32 v35, v86, v87
    ds_write2_b64 v234, v[32:33], v[34:35] offset0:0 offset1:68
    v_pk_mul_f32 v[84:85], v[88:89], v[56:57]
    v_pk_mul_f32 v[86:87], v[88:89], v[58:59]
    v_pk_fma_f32 v[84:85], v[90:91], v[58:59], v[84:85] neg_lo:[1,0,0] neg_hi:[1,0,0]
    v_pk_fma_f32 v[86:87], v[90:91], v[56:57], v[86:87]
    v_cvt_pk_bf16_f32 v36, v88, v89
    v_cvt_pk_bf16_f32 v37, v90, v91
    v_pk_mul_f32 v[88:89], v[84:85], v[56:57]
    v_pk_mul_f32 v[90:91], v[84:85], v[58:59]
    v_pk_fma_f32 v[88:89], v[86:87], v[58:59], v[88:89] neg_lo:[1,0,0] neg_hi:[1,0,0]
    v_pk_fma_f32 v[90:91], v[86:87], v[56:57], v[90:91]
    v_cvt_pk_bf16_f32 v38, v84, v85
    v_cvt_pk_bf16_f32 v39, v86, v87
    ds_write2_b64 v234, v[36:37], v[38:39] offset0:136 offset1:204
    v_pk_mul_f32 v[84:85], v[88:89], v[56:57]
    v_pk_mul_f32 v[86:87], v[88:89], v[58:59]
    v_pk_fma_f32 v[84:85], v[90:91], v[58:59], v[84:85] neg_lo:[1,0,0] neg_hi:[1,0,0]
    v_pk_fma_f32 v[86:87], v[90:91], v[56:57], v[86:87]
    v_cvt_pk_bf16_f32 v32, v88, v89
    v_cvt_pk_bf16_f32 v33, v90, v91
    v_pk_mul_f32 v[88:89], v[84:85], v[56:57]
    v_pk_mul_f32 v[90:91], v[84:85], v[58:59]
    v_pk_fma_f32 v[88:89], v[86:87], v[58:59], v[88:89] neg_lo:[1,0,0] neg_hi:[1,0,0]
    v_pk_fma_f32 v[90:91], v[86:87], v[56:57], v[90:91]
    v_cvt_pk_bf16_f32 v34, v84, v85
    v_cvt_pk_bf16_f32 v35, v86, v87
    ds_write2_b64 v235, v[32:33], v[34:35] offset0:0 offset1:68
    v_pk_mul_f32 v[84:85], v[88:89], v[56:57]
    v_pk_mul_f32 v[86:87], v[88:89], v[58:59]
    v_pk_fma_f32 v[84:85], v[90:91], v[58:59], v[84:85] neg_lo:[1,0,0] neg_hi:[1,0,0]
    v_pk_fma_f32 v[86:87], v[90:91], v[56:57], v[86:87]
    v_cvt_pk_bf16_f32 v36, v88, v89
    v_cvt_pk_bf16_f32 v37, v90, v91
    v_pk_mul_f32 v[88:89], v[84:85], v[56:57]
    v_pk_mul_f32 v[90:91], v[84:85], v[58:59]
    v_pk_fma_f32 v[88:89], v[86:87], v[58:59], v[88:89] neg_lo:[1,0,0] neg_hi:[1,0,0]
    v_pk_fma_f32 v[90:91], v[86:87], v[56:57], v[90:91]
    v_cvt_pk_bf16_f32 v38, v84, v85
    v_cvt_pk_bf16_f32 v39, v86, v87
    ds_write2_b64 v235, v[36:37], v[38:39] offset0:136 offset1:204
    v_pk_mul_f32 v[84:85], v[88:89], v[56:57]
    v_pk_mul_f32 v[86:87], v[88:89], v[58:59]
    v_pk_fma_f32 v[84:85], v[90:91], v[58:59], v[84:85] neg_lo:[1,0,0] neg_hi:[1,0,0]
    v_pk_fma_f32 v[86:87], v[90:91], v[56:57], v[86:87]
    v_cvt_pk_bf16_f32 v32, v88, v89
    v_cvt_pk_bf16_f32 v33, v90, v91
    v_pk_mul_f32 v[88:89], v[84:85], v[56:57]
    v_pk_mul_f32 v[90:91], v[84:85], v[58:59]
    v_pk_fma_f32 v[88:89], v[86:87], v[58:59], v[88:89] neg_lo:[1,0,0] neg_hi:[1,0,0]
    v_pk_fma_f32 v[90:91], v[86:87], v[56:57], v[90:91]
    v_cvt_pk_bf16_f32 v34, v84, v85
    v_cvt_pk_bf16_f32 v35, v86, v87
    ds_write2_b64 v236, v[32:33], v[34:35] offset0:0 offset1:68
    v_pk_mul_f32 v[84:85], v[88:89], v[56:57]
    v_pk_mul_f32 v[86:87], v[88:89], v[58:59]
    v_pk_fma_f32 v[84:85], v[90:91], v[58:59], v[84:85] neg_lo:[1,0,0] neg_hi:[1,0,0]
    v_pk_fma_f32 v[86:87], v[90:91], v[56:57], v[86:87]
    v_cvt_pk_bf16_f32 v36, v88, v89
    v_cvt_pk_bf16_f32 v37, v90, v91
    v_cvt_pk_bf16_f32 v38, v84, v85
    v_cvt_pk_bf16_f32 v39, v86, v87
    ds_write2_b64 v236, v[36:37], v[38:39] offset0:136 offset1:204
    ds_read_b128 v[160:163], v244 offset:0
    ds_read_b128 v[164:167], v244 offset:64
    ds_read_b128 v[168:171], v244 offset:128
    ds_read_b128 v[172:175], v244 offset:192
    ds_read_b128 v[176:179], v244 offset:256
    ds_read_b128 v[180:183], v244 offset:320
    ds_read_b128 v[184:187], v244 offset:384
    ds_read_b128 v[188:191], v244 offset:448
    v_pk_mul_f32 v[92:93], v[52:53], v[76:77]
    v_pk_mul_f32 v[94:95], v[52:53], v[78:79]
    v_pk_fma_f32 v[92:93], v[54:55], v[78:79], v[92:93] neg_lo:[1,0,0] neg_hi:[1,0,0]
    v_pk_fma_f32 v[94:95], v[54:55], v[76:77], v[94:95]
    v_pk_mul_f32 v[96:97], v[92:93], v[76:77]
    v_pk_mul_f32 v[98:99], v[92:93], v[78:79]
    v_pk_fma_f32 v[96:97], v[94:95], v[78:79], v[96:97] neg_lo:[1,0,0] neg_hi:[1,0,0]
    v_pk_fma_f32 v[98:99], v[94:95], v[76:77], v[98:99]
    v_pk_mul_f32 v[100:101], v[96:97], v[76:77]
    v_pk_mul_f32 v[102:103], v[96:97], v[78:79]
    v_pk_fma_f32 v[100:101], v[98:99], v[78:79], v[100:101] neg_lo:[1,0,0] neg_hi:[1,0,0]
    v_pk_fma_f32 v[102:103], v[98:99], v[76:77], v[102:103]
    v_pk_mul_f32 v[104:105], v[100:101], v[76:77]
    v_pk_mul_f32 v[106:107], v[100:101], v[78:79]
    v_pk_fma_f32 v[104:105], v[102:103], v[78:79], v[104:105] neg_lo:[1,0,0] neg_hi:[1,0,0]
    v_pk_fma_f32 v[106:107], v[102:103], v[76:77], v[106:107]
    v_pk_mul_f32 v[108:109], v[104:105], v[76:77]
    v_pk_mul_f32 v[110:111], v[104:105], v[78:79]
    v_pk_fma_f32 v[108:109], v[106:107], v[78:79], v[108:109] neg_lo:[1,0,0] neg_hi:[1,0,0]
    v_pk_fma_f32 v[110:111], v[106:107], v[76:77], v[110:111]
    v_pk_mul_f32 v[112:113], v[108:109], v[76:77]
    v_pk_mul_f32 v[114:115], v[108:109], v[78:79]
    v_pk_fma_f32 v[112:113], v[110:111], v[78:79], v[112:113] neg_lo:[1,0,0] neg_hi:[1,0,0]
    v_pk_fma_f32 v[114:115], v[110:111], v[76:77], v[114:115]
    v_pk_mul_f32 v[116:117], v[112:113], v[76:77]
    v_pk_mul_f32 v[118:119], v[112:113], v[78:79]
    v_pk_fma_f32 v[116:117], v[114:115], v[78:79], v[116:117] neg_lo:[1,0,0] neg_hi:[1,0,0]
    v_pk_fma_f32 v[118:119], v[114:115], v[76:77], v[118:119]
    v_pk_mul_f32 v[84:85], v[92:93], v[60:61]
    v_pk_mul_f32 v[86:87], v[92:93], v[62:63]
    v_pk_fma_f32 v[84:85], v[94:95], v[62:63], v[84:85] neg_lo:[1,0,0] neg_hi:[1,0,0]
    v_pk_fma_f32 v[86:87], v[94:95], v[60:61], v[86:87]
    v_cvt_pk_bf16_f32 v32, v92, v93
    v_cvt_pk_bf16_f32 v33, v94, v95
    v_pk_mul_f32 v[88:89], v[84:85], v[60:61]
    v_pk_mul_f32 v[90:91], v[84:85], v[62:63]
    v_pk_fma_f32 v[88:89], v[86:87], v[62:63], v[88:89] neg_lo:[1,0,0] neg_hi:[1,0,0]
    v_pk_fma_f32 v[90:91], v[86:87], v[60:61], v[90:91]
    v_cvt_pk_bf16_f32 v34, v84, v85
    v_cvt_pk_bf16_f32 v35, v86, v87
    ds_write2_b64 v243, v[32:33], v[34:35] offset0:0 offset1:68
    v_pk_mul_f32 v[84:85], v[88:89], v[60:61]
    v_pk_mul_f32 v[86:87], v[88:89], v[62:63]
    v_pk_fma_f32 v[84:85], v[90:91], v[62:63], v[84:85] neg_lo:[1,0,0] neg_hi:[1,0,0]
    v_pk_fma_f32 v[86:87], v[90:91], v[60:61], v[86:87]
    v_cvt_pk_bf16_f32 v36, v88, v89
    v_cvt_pk_bf16_f32 v37, v90, v91
    v_pk_mul_f32 v[88:89], v[84:85], v[60:61]
    v_pk_mul_f32 v[90:91], v[84:85], v[62:63]
    v_pk_fma_f32 v[88:89], v[86:87], v[62:63], v[88:89] neg_lo:[1,0,0] neg_hi:[1,0,0]
    v_pk_fma_f32 v[90:91], v[86:87], v[60:61], v[90:91]
    v_cvt_pk_bf16_f32 v38, v84, v85
    v_cvt_pk_bf16_f32 v39, v86, v87
    ds_write2_b64 v243, v[36:37], v[38:39] offset0:136 offset1:204
    v_pk_mul_f32 v[84:85], v[88:89], v[60:61]
    v_pk_mul_f32 v[86:87], v[88:89], v[62:63]
    v_pk_fma_f32 v[84:85], v[90:91], v[62:63], v[84:85] neg_lo:[1,0,0] neg_hi:[1,0,0]
    v_pk_fma_f32 v[86:87], v[90:91], v[60:61], v[86:87]
    v_cvt_pk_bf16_f32 v32, v88, v89
    v_cvt_pk_bf16_f32 v33, v90, v91
    v_pk_mul_f32 v[88:89], v[84:85], v[60:61]
    v_pk_mul_f32 v[90:91], v[84:85], v[62:63]
    v_pk_fma_f32 v[88:89], v[86:87], v[62:63], v[88:89] neg_lo:[1,0,0] neg_hi:[1,0,0]
    v_pk_fma_f32 v[90:91], v[86:87], v[60:61], v[90:91]
    v_cvt_pk_bf16_f32 v34, v84, v85
    v_cvt_pk_bf16_f32 v35, v86, v87
    ds_write2_b64 v234, v[32:33], v[34:35] offset0:0 offset1:68
    v_pk_mul_f32 v[84:85], v[88:89], v[60:61]
    v_pk_mul_f32 v[86:87], v[88:89], v[62:63]
    v_pk_fma_f32 v[84:85], v[90:91], v[62:63], v[84:85] neg_lo:[1,0,0] neg_hi:[1,0,0]
    v_pk_fma_f32 v[86:87], v[90:91], v[60:61], v[86:87]
    v_cvt_pk_bf16_f32 v36, v88, v89
    v_cvt_pk_bf16_f32 v37, v90, v91
    v_pk_mul_f32 v[88:89], v[84:85], v[60:61]
    v_pk_mul_f32 v[90:91], v[84:85], v[62:63]
    v_pk_fma_f32 v[88:89], v[86:87], v[62:63], v[88:89] neg_lo:[1,0,0] neg_hi:[1,0,0]
    v_pk_fma_f32 v[90:91], v[86:87], v[60:61], v[90:91]
    v_cvt_pk_bf16_f32 v38, v84, v85
    v_cvt_pk_bf16_f32 v39, v86, v87
    ds_write2_b64 v234, v[36:37], v[38:39] offset0:136 offset1:204
    v_cvt_pk_bf16_f32 v32, v88, v89
    v_cvt_pk_bf16_f32 v33, v90, v91
    ds_write_b64 v243, v[32:33] offset:4352
    s_waitcnt lgkmcnt(5)
    s_nop 0
    v_mfma_f32_16x16x32_bf16 v[192:195], v[160:163], v[128:131], 0
    ds_read_b128 v[160:163], v245 offset:0
    v_mfma_f32_16x16x32_bf16 v[192:195], v[164:167], v[132:135], v[192:195]
    ds_read_b128 v[164:167], v245 offset:64
    v_mfma_f32_16x16x32_bf16 v[192:195], v[168:171], v[136:139], v[192:195]
    ds_read_b128 v[168:171], v245 offset:128
    v_mfma_f32_16x16x32_bf16 v[192:195], v[172:175], v[140:143], v[192:195]
    ds_read_b128 v[172:175], v245 offset:192
    v_mfma_f32_16x16x32_bf16 v[192:195], v[176:179], v[144:147], v[192:195]
    ds_read_b128 v[176:179], v245 offset:256
    v_mfma_f32_16x16x32_bf16 v[192:195], v[180:183], v[148:151], v[192:195]
    ds_read_b128 v[180:183], v245 offset:320
    v_mfma_f32_16x16x32_bf16 v[192:195], v[184:187], v[152:155], v[192:195]
    ds_read_b128 v[184:187], v245 offset:384
    v_mfma_f32_16x16x32_bf16 v[192:195], v[188:191], v[156:159], v[192:195]
    ds_read_b128 v[188:191], v245 offset:448
    v_pk_mul_f32 v[84:85], v[96:97], v[64:65]
    v_pk_mul_f32 v[86:87], v[96:97], v[66:67]
    v_pk_fma_f32 v[84:85], v[98:99], v[66:67], v[84:85] neg_lo:[1,0,0] neg_hi:[1,0,0]
    v_pk_fma_f32 v[86:87], v[98:99], v[64:65], v[86:87]
    v_cvt_pk_bf16_f32 v34, v96, v97
    v_cvt_pk_bf16_f32 v35, v98, v99
    v_pk_mul_f32 v[88:89], v[84:85], v[64:65]
    v_pk_mul_f32 v[90:91], v[84:85], v[66:67]
    v_pk_fma_f32 v[88:89], v[86:87], v[66:67], v[88:89] neg_lo:[1,0,0] neg_hi:[1,0,0]
    v_pk_fma_f32 v[90:91], v[86:87], v[64:65], v[90:91]
    v_cvt_pk_bf16_f32 v36, v84, v85
    v_cvt_pk_bf16_f32 v37, v86, v87
    ds_write2_b64 v243, v[34:35], v[36:37] offset0:0 offset1:68
    v_pk_mul_f32 v[84:85], v[88:89], v[64:65]
    v_pk_mul_f32 v[86:87], v[88:89], v[66:67]
    v_pk_fma_f32 v[84:85], v[90:91], v[66:67], v[84:85] neg_lo:[1,0,0] neg_hi:[1,0,0]
    v_pk_fma_f32 v[86:87], v[90:91], v[64:65], v[86:87]
    v_cvt_pk_bf16_f32 v38, v88, v89
    v_cvt_pk_bf16_f32 v39, v90, v91
    v_pk_mul_f32 v[88:89], v[84:85], v[64:65]
    v_pk_mul_f32 v[90:91], v[84:85], v[66:67]
    v_pk_fma_f32 v[88:89], v[86:87], v[66:67], v[88:89] neg_lo:[1,0,0] neg_hi:[1,0,0]
    v_pk_fma_f32 v[90:91], v[86:87], v[64:65], v[90:91]
    v_cvt_pk_bf16_f32 v32, v84, v85
    v_cvt_pk_bf16_f32 v33, v86, v87
    ds_write2_b64 v243, v[38:39], v[32:33] offset0:136 offset1:204
    v_cvt_pk_bf16_f32 v34, v88, v89
    v_cvt_pk_bf16_f32 v35, v90, v91
    v_pk_mul_f32 v[84:85], v[100:101], v[64:65]
    v_pk_mul_f32 v[86:87], v[100:101], v[66:67]
    v_pk_fma_f32 v[84:85], v[102:103], v[66:67], v[84:85] neg_lo:[1,0,0] neg_hi:[1,0,0]
    v_pk_fma_f32 v[86:87], v[102:103], v[64:65], v[86:87]
    v_cvt_pk_bf16_f32 v36, v100, v101
    v_cvt_pk_bf16_f32 v37, v102, v103
    ds_write2_b64 v234, v[34:35], v[36:37] offset0:0 offset1:68
    v_pk_mul_f32 v[88:89], v[84:85], v[64:65]
    v_pk_mul_f32 v[90:91], v[84:85], v[66:67]
    v_pk_fma_f32 v[88:89], v[86:87], v[66:67], v[88:89] neg_lo:[1,0,0] neg_hi:[1,0,0]
    v_pk_fma_f32 v[90:91], v[86:87], v[64:65], v[90:91]
    v_cvt_pk_bf16_f32 v38, v84, v85
    v_cvt_pk_bf16_f32 v39, v86, v87
    v_pk_mul_f32 v[84:85], v[88:89], v[64:65]
    v_pk_mul_f32 v[86:87], v[88:89], v[66:67]
    v_pk_fma_f32 v[84:85], v[90:91], v[66:67], v[84:85] neg_lo:[1,0,0] neg_hi:[1,0,0]
    v_pk_fma_f32 v[86:87], v[90:91], v[64:65], v[86:87]
    v_cvt_pk_bf16_f32 v32, v88, v89
    v_cvt_pk_bf16_f32 v33, v90, v91
    ds_write2_b64 v234, v[38:39], v[32:33] offset0:136 offset1:204
    v_pk_mul_f32 v[88:89], v[84:85], v[64:65]
    v_pk_mul_f32 v[90:91], v[84:85], v[66:67]
    v_pk_fma_f32 v[88:89], v[86:87], v[66:67], v[88:89] neg_lo:[1,0,0] neg_hi:[1,0,0]
    v_pk_fma_f32 v[90:91], v[86:87], v[64:65], v[90:91]
    v_cvt_pk_bf16_f32 v34, v84, v85
    v_cvt_pk_bf16_f32 v35, v86, v87
    v_cvt_pk_bf16_f32 v36, v88, v89
    v_cvt_pk_bf16_f32 v37, v90, v91
    ds_write2_b64 v235, v[34:35], v[36:37] offset0:0 offset1:68
    s_waitcnt lgkmcnt(5)
    s_nop 0
    v_mfma_f32_16x16x32_bf16 v[196:199], v[160:163], v[128:131], 0
    ds_read_b128 v[160:163], v246 offset:0
    v_mfma_f32_16x16x32_bf16 v[196:199], v[164:167], v[132:135], v[196:199]
    ds_read_b128 v[164:167], v246 offset:64
    v_mfma_f32_16x16x32_bf16 v[196:199], v[168:171], v[136:139], v[196:199]
    ds_read_b128 v[168:171], v246 offset:128
    v_mfma_f32_16x16x32_bf16 v[196:199], v[172:175], v[140:143], v[196:199]
    ds_read_b128 v[172:175], v246 offset:192
    v_mfma_f32_16x16x32_bf16 v[196:199], v[176:179], v[144:147], v[196:199]
    ds_read_b128 v[176:179], v246 offset:256
    v_mfma_f32_16x16x32_bf16 v[196:199], v[180:183], v[148:151], v[196:199]
    ds_read_b128 v[180:183], v246 offset:320
    v_mfma_f32_16x16x32_bf16 v[196:199], v[184:187], v[152:155], v[196:199]
    ds_read_b128 v[184:187], v246 offset:384
    v_mfma_f32_16x16x32_bf16 v[196:199], v[188:191], v[156:159], v[196:199]
    ds_read_b128 v[188:191], v246 offset:448
    v_pk_mul_f32 v[84:85], v[104:105], v[68:69]
    v_pk_mul_f32 v[86:87], v[104:105], v[70:71]
    v_pk_fma_f32 v[84:85], v[106:107], v[70:71], v[84:85] neg_lo:[1,0,0] neg_hi:[1,0,0]
    v_pk_fma_f32 v[86:87], v[106:107], v[68:69], v[86:87]
    v_cvt_pk_bf16_f32 v38, v104, v105
    v_cvt_pk_bf16_f32 v39, v106, v107
    v_pk_mul_f32 v[88:89], v[84:85], v[68:69]
    v_pk_mul_f32 v[90:91], v[84:85], v[70:71]
    v_pk_fma_f32 v[88:89], v[86:87], v[70:71], v[88:89] neg_lo:[1,0,0] neg_hi:[1,0,0]
    v_pk_fma_f32 v[90:91], v[86:87], v[68:69], v[90:91]
    v_cvt_pk_bf16_f32 v32, v84, v85
    v_cvt_pk_bf16_f32 v33, v86, v87
    ds_write2_b64 v243, v[38:39], v[32:33] offset0:0 offset1:68
    v_cvt_pk_bf16_f32 v34, v88, v89
    v_cvt_pk_bf16_f32 v35, v90, v91
    v_pk_mul_f32 v[84:85], v[108:109], v[68:69]
    v_pk_mul_f32 v[86:87], v[108:109], v[70:71]
    v_pk_fma_f32 v[84:85], v[110:111], v[70:71], v[84:85] neg_lo:[1,0,0] neg_hi:[1,0,0]
    v_pk_fma_f32 v[86:87], v[110:111], v[68:69], v[86:87]
    v_cvt_pk_bf16_f32 v36, v108, v109
    v_cvt_pk_bf16_f32 v37, v110, v111
    ds_write2_b64 v243, v[34:35], v[36:37] offset0:136 offset1:204
    v_pk_mul_f32 v[88:89], v[84:85], v[68:69]
    v_pk_mul_f32 v[90:91], v[84:85], v[70:71]
    v_pk_fma_f32 v[88:89], v[86:87], v[70:71], v[88:89] neg_lo:[1,0,0] neg_hi:[1,0,0]
    v_pk_fma_f32 v[90:91], v[86:87], v[68:69], v[90:91]
    v_cvt_pk_bf16_f32 v38, v84, v85
    v_cvt_pk_bf16_f32 v39, v86, v87
    v_cvt_pk_bf16_f32 v32, v88, v89
    v_cvt_pk_bf16_f32 v33, v90, v91
    ds_write2_b64 v234, v[38:39], v[32:33] offset0:0 offset1:68
    v_pk_mul_f32 v[84:85], v[112:113], v[68:69]
    v_pk_mul_f32 v[86:87], v[112:113], v[70:71]
    v_pk_fma_f32 v[84:85], v[114:115], v[70:71], v[84:85] neg_lo:[1,0,0] neg_hi:[1,0,0]
    v_pk_fma_f32 v[86:87], v[114:115], v[68:69], v[86:87]
    v_cvt_pk_bf16_f32 v34, v112, v113
    v_cvt_pk_bf16_f32 v35, v114, v115
    v_pk_mul_f32 v[88:89], v[84:85], v[68:69]
    v_pk_mul_f32 v[90:91], v[84:85], v[70:71]
    v_pk_fma_f32 v[88:89], v[86:87], v[70:71], v[88:89] neg_lo:[1,0,0] neg_hi:[1,0,0]
    v_pk_fma_f32 v[90:91], v[86:87], v[68:69], v[90:91]
    v_cvt_pk_bf16_f32 v36, v84, v85
    v_cvt_pk_bf16_f32 v37, v86, v87
    ds_write2_b64 v234, v[34:35], v[36:37] offset0:136 offset1:204
    v_cvt_pk_bf16_f32 v38, v88, v89
    v_cvt_pk_bf16_f32 v39, v90, v91
    v_pk_mul_f32 v[84:85], v[116:117], v[68:69]
    v_pk_mul_f32 v[86:87], v[116:117], v[70:71]
    v_pk_fma_f32 v[84:85], v[118:119], v[70:71], v[84:85] neg_lo:[1,0,0] neg_hi:[1,0,0]
    v_pk_fma_f32 v[86:87], v[118:119], v[68:69], v[86:87]
    v_cvt_pk_bf16_f32 v32, v116, v117
    v_cvt_pk_bf16_f32 v33, v118, v119
    ds_write2_b64 v235, v[38:39], v[32:33] offset0:0 offset1:68
    v_pk_mul_f32 v[88:89], v[84:85], v[68:69]
    v_pk_mul_f32 v[90:91], v[84:85], v[70:71]
    v_pk_fma_f32 v[88:89], v[86:87], v[70:71], v[88:89] neg_lo:[1,0,0] neg_hi:[1,0,0]
    v_pk_fma_f32 v[90:91], v[86:87], v[68:69], v[90:91]
    v_cvt_pk_bf16_f32 v34, v84, v85
    v_cvt_pk_bf16_f32 v35, v86, v87
    v_cvt_pk_bf16_f32 v36, v88, v89
    v_cvt_pk_bf16_f32 v37, v90, v91
    ds_write2_b64 v235, v[34:35], v[36:37] offset0:136 offset1:204
    s_waitcnt lgkmcnt(6)
    s_nop 0
    v_mfma_f32_16x16x32_bf16 v[200:203], v[160:163], v[128:131], 0
    ds_read_b128 v[160:163], v247 offset:0
    v_mfma_f32_16x16x32_bf16 v[200:203], v[164:167], v[132:135], v[200:203]
    ds_read_b128 v[164:167], v247 offset:64
    v_mfma_f32_16x16x32_bf16 v[200:203], v[168:171], v[136:139], v[200:203]
    ds_read_b128 v[168:171], v247 offset:128
    v_mfma_f32_16x16x32_bf16 v[200:203], v[172:175], v[140:143], v[200:203]
    ds_read_b128 v[172:175], v247 offset:192
    v_mfma_f32_16x16x32_bf16 v[200:203], v[176:179], v[144:147], v[200:203]
    ds_read_b128 v[176:179], v247 offset:256
    v_mfma_f32_16x16x32_bf16 v[200:203], v[180:183], v[148:151], v[200:203]
    ds_read_b128 v[180:183], v247 offset:320
    v_mfma_f32_16x16x32_bf16 v[200:203], v[184:187], v[152:155], v[200:203]
    ds_read_b128 v[184:187], v247 offset:384
    v_mfma_f32_16x16x32_bf16 v[200:203], v[188:191], v[156:159], v[200:203]
    ds_read_b128 v[188:191], v247 offset:448
    s_lshr_b32 s76, s76, s63
    s_lshl_b32 s76, s76, 16
    v_mov_b32 v237, 0
    v_writelane_b32 v237, s76, 0
    v_add_f32 v192, v237, v192
    v_cvt_pk_bf16_f32 v84, v192, v193
    v_cvt_pk_bf16_f32 v85, v194, v195
    v_cvt_pk_bf16_f32 v86, v196, v196
    v_cvt_pk_bf16_f32 v87, v197, v198
    s_waitcnt lgkmcnt(0)
    v_mfma_f32_16x16x32_bf16 v[204:207], v[160:163], v[128:131], 0
    ds_write2st64_b64 v248, v[84:85], v[86:87] offset0:0 offset1:1
    v_mfma_f32_16x16x32_bf16 v[204:207], v[164:167], v[132:135], v[204:207]
    v_cvt_pk_bf16_f32 v88, v200, v200
    v_cvt_pk_bf16_f32 v89, v200, v201
    v_mfma_f32_16x16x32_bf16 v[204:207], v[168:171], v[136:139], v[204:207]
    v_cvt_pk_bf16_f32 v90, v201, v201
    v_cvt_pk_bf16_f32 v91, v202, v202
    v_mfma_f32_16x16x32_bf16 v[204:207], v[172:175], v[140:143], v[204:207]
    ds_write_b128 v249, v[88:91] offset:1024
    v_mfma_f32_16x16x32_bf16 v[204:207], v[176:179], v[144:147], v[204:207]
    v_mfma_f32_16x16x32_bf16 v[204:207], v[180:183], v[148:151], v[204:207]
    v_mfma_f32_16x16x32_bf16 v[204:207], v[184:187], v[152:155], v[204:207]
    v_mfma_f32_16x16x32_bf16 v[204:207], v[188:191], v[156:159], v[204:207]
    s_nop 7
    v_cvt_pk_bf16_f32 v92, v204, v204
    v_cvt_pk_bf16_f32 v93, v204, v204
    v_cvt_pk_bf16_f32 v94, v204, v205
    v_cvt_pk_bf16_f32 v95, v205, v205
    v_cvt_pk_bf16_f32 v96, v205, v205
    v_cvt_pk_bf16_f32 v97, v205, v205
    v_cvt_pk_bf16_f32 v98, v206, v206
    v_cvt_pk_bf16_f32 v99, v206, v206
    ds_write_b128 v250, v[92:95] offset:2048
    ds_write_b128 v250, v[96:99] offset:2064
    s_mov_b64 exec, 1
    ds_add_u32 v254, v255 offset:12
    s_mov_b64 exec, -1
    s_branch L_conv
.p2align 12
L_padc:
    s_cbranch_execz L_retc
L_conv:
    s_setprio 2
    v_mov_b32 v0, v230
    v_mov_b32 v1, v231
    s_mov_b32 s14, 0
L_kwait:
    ds_read_b32 v252, v254 offset:20
    s_add_u32 s14, s14, 1
    s_waitcnt lgkmcnt(0)
    v_cmp_gt_u32 vcc, s15, v252
    s_cbranch_vccz L_kok
    s_sleep 1
    s_cmp_lt_u32 s14, 262144
    s_cbranch_scc1 L_kwait
L_kok:
    ds_read_b64_tr_b16 v[136:137], v251 offset:0
    ds_read_b64_tr_b16 v[134:135], v251 offset:128
    ds_read_b64_tr_b16 v[132:133], v251 offset:256
    ds_read_b64_tr_b16 v[130:131], v251 offset:384
    ds_read_b64_tr_b16 v[128:129], v251 offset:512
    ds_read_b64_tr_b16 v[126:127], v251 offset:640
    ds_read_b64_tr_b16 v[124:125], v251 offset:768
    ds_read_b64_tr_b16 v[122:123], v251 offset:896
    ds_read_b64_tr_b16 v[120:121], v251 offset:1024
    ds_read_b64_tr_b16 v[118:119], v251 offset:1152
    ds_read_b64_tr_b16 v[116:117], v251 offset:1280
    ds_read_b64_tr_b16 v[114:115], v251 offset:1408
    ds_read_b64_tr_b16 v[112:113], v251 offset:1536
    ds_read_b64_tr_b16 v[110:111], v251 offset:1664
    ds_read_b64_tr_b16 v[108:109], v251 offset:1792
    ds_read_b64_tr_b16 v[106:107], v251 offset:1920
    ds_read_b64_tr_b16 v[104:105], v251 offset:2048
    ds_read_b64_tr_b16 v[102:103], v251 offset:2176
    ds_read_b64_tr_b16 v[100:101], v251 offset:2304
    ds_read_b64_tr_b16 v[98:99], v251 offset:2432
    ds_read_b64_tr_b16 v[96:97], v251 offset:2560
    ds_read_b64_tr_b16 v[94:95], v251 offset:2688
    ds_read_b64_tr_b16 v[92:93], v251 offset:2816
    ds_read_b64_tr_b16 v[90:91], v251 offset:2944
    ds_read_b64_tr_b16 v[88:89], v251 offset:3072
    ds_read_b64_tr_b16 v[86:87], v251 offset:3200
    ds_read_b64_tr_b16 v[84:85], v251 offset:3328
    ds_read_b64_tr_b16 v[82:83], v251 offset:3456
    ds_read_b64_tr_b16 v[80:81], v251 offset:3584
    ds_read_b64_tr_b16 v[78:79], v251 offset:3712
    s_mov_b32 s14, 0
L_uwait:
    ds_read_b32 v252, v254 offset:4
    s_add_u32 s14, s14, 1
    s_waitcnt lgkmcnt(0)
    v_cmp_ne_u32 vcc, 1, v252
    s_cbranch_vccz L_uok
    s_cmp_lt_u32 s14, 262144
    s_cbranch_scc1 L_uwait
L_uok:
    ds_read_b64_tr_b16 v[138:139], v253 offset:0
    ds_read_b64_tr_b16 v[140:141], v253 offset:128
    ds_read_b64_tr_b16 v[142:143], v253 offset:256
    ds_read_b64_tr_b16 v[144:145], v253 offset:384
    s_waitcnt lgkmcnt(2)
    v_mfma_f32_16x16x32_bf16 v[202:205], v[134:137], v[138:141], 0
    ds_read_b64_tr_b16 v[146:147], v253 offset:512
    v_mfma_f32_16x16x32_bf16 v[206:209], v[132:135], v[138:141], 0
    ds_read_b64_tr_b16 v[148:149], v253 offset:640
    v_mfma_f32_16x16x32_bf16 v[210:213], v[130:133], v[138:141], 0
    s_waitcnt lgkmcnt(2)
    ds_read_b64_tr_b16 v[150:151], v253 offset:768
    v_mfma_f32_16x16x32_bf16 v[210:213], v[134:137], v[142:145], v[210:213]
    ds_read_b32 v246, v254 offset:12
    v_add_f32_dpp v234, v205, v204 wave_shr:1 row_mask:0xf bank_mask:0xf bound_ctrl:0
    v_mfma_f32_16x16x32_bf16 v[214:217], v[128:131], v[138:141], 0
    ds_read_b64_tr_b16 v[152:153], v253 offset:896
    v_add_f32_dpp v236, v234, v203 wave_shr:1 row_mask:0xf bank_mask:0xf bound_ctrl:0
    v_mfma_f32_16x16x32_bf16 v[214:217], v[132:135], v[142:145], v[214:217]
    s_nop 0
    v_add_f32_dpp v238, v236, v202 wave_shr:1 row_mask:0xf bank_mask:0xf bound_ctrl:0
    v_add_f32_dpp v235, v205, v208 wave_ror:1 row_mask:0x1 bank_mask:0x1
    v_mfma_f32_16x16x32_bf16 v[218:221], v[126:129], v[138:141], 0
    ds_write_addtid_b32 v238 offset:0
    v_add_f32_dpp v237, v234, v207 wave_ror:1 row_mask:0x1 bank_mask:0x1
    v_mfma_f32_16x16x32_bf16 v[218:221], v[130:133], v[142:145], v[218:221]
    s_waitcnt lgkmcnt(4)
    v_add_f32_dpp v239, v236, v206 wave_ror:1 row_mask:0x1 bank_mask:0x1
    v_add_f32_dpp v235, v209, v208 wave_shr:1 row_mask:0xf bank_mask:0xf
    v_mfma_f32_16x16x32_bf16 v[218:221], v[134:137], v[146:149], v[218:221]
    s_nop 0
    v_add_f32_dpp v237, v235, v207 wave_shr:1 row_mask:0xf bank_mask:0xf
    v_add_f32_dpp v234, v209, v212 wave_ror:1 row_mask:0x1 bank_mask:0x1
    v_mfma_f32_16x16x32_bf16 v[222:225], v[124:127], v[138:141], 0
    v_add_f32_dpp v239, v237, v206 wave_shr:1 row_mask:0xf bank_mask:0xf
    v_add_f32_dpp v236, v235, v211 wave_ror:1 row_mask:0x1 bank_mask:0x1
    v_mfma_f32_16x16x32_bf16 v[222:225], v[128:131], v[142:145], v[222:225]
    s_waitcnt lgkmcnt(0)
    v_cmp_ne_u32 vcc, 8, v246
    s_cbranch_vccnz L_slow3
L_back3:
    v_mfma_f32_16x16x32_bf16 v[222:225], v[132:135], v[146:149], v[222:225]
    ds_read_b64_tr_b16 v[154:155], v253 offset:1024
    v_add_f32_dpp v238, v237, v210 wave_ror:1 row_mask:0x1 bank_mask:0x1
    v_mfma_f32_16x16x32_bf16 v[226:229], v[122:125], v[138:141], 0
    ds_read_b64_tr_b16 v[156:157], v253 offset:1152
    v_add_f32_dpp v234, v213, v212 wave_shr:1 row_mask:0xf bank_mask:0xf
    v_mfma_f32_16x16x32_bf16 v[226:229], v[126:129], v[142:145], v[226:229]
    ds_write_addtid_b32 v239 offset:256
    v_add_f32_dpp v236, v234, v211 wave_shr:1 row_mask:0xf bank_mask:0xf
    v_mfma_f32_16x16x32_bf16 v[226:229], v[130:133], v[146:149], v[226:229]
    s_nop 0
    v_add_f32_dpp v238, v236, v210 wave_shr:1 row_mask:0xf bank_mask:0xf
    v_add_f32_dpp v235, v213, v216 wave_ror:1 row_mask:0x1 bank_mask:0x1
    v_mfma_f32_16x16x32_bf16 v[226:229], v[134:137], v[150:153], v[226:229]
    ds_write_addtid_b32 v238 offset:2048
    v_add_f32_dpp v237, v234, v215 wave_ror:1 row_mask:0x1 bank_mask:0x1
    v_mfma_f32_16x16x32_bf16 v[230:233], v[120:123], v[138:141], 0
    v_add_f32_dpp v239, v236, v214 wave_ror:1 row_mask:0x1 bank_mask:0x1
    v_add_f32_dpp v235, v217, v216 wave_shr:1 row_mask:0xf bank_mask:0xf
    v_mfma_f32_16x16x32_bf16 v[230:233], v[124:127], v[142:145], v[230:233]
    s_nop 0
    v_add_f32_dpp v237, v235, v215 wave_shr:1 row_mask:0xf bank_mask:0xf
    v_add_f32_dpp v234, v217, v220 wave_ror:1 row_mask:0x1 bank_mask:0x1
    v_mfma_f32_16x16x32_bf16 v[230:233], v[128:131], v[146:149], v[230:233]
    v_add_f32_dpp v239, v237, v214 wave_shr:1 row_mask:0xf bank_mask:0xf
    v_add_f32_dpp v236, v235, v219 wave_ror:1 row_mask:0x1 bank_mask:0x1
    v_mfma_f32_16x16x32_bf16 v[230:233], v[132:135], v[150:153], v[230:233]
    ds_write_addtid_b32 v239 offset:2304
    v_add_f32_dpp v238, v237, v218 wave_ror:1 row_mask:0x1 bank_mask:0x1
    v_mfma_f32_16x16x32_bf16 v[202:205], v[118:121], v[138:141], 0
    v_add_f32_dpp v234, v221, v220 wave_shr:1 row_mask:0xf bank_mask:0xf
    v_add_f32_dpp v235, v221, v224 wave_ror:1 row_mask:0x1 bank_mask:0x1
    v_mfma_f32_16x16x32_bf16 v[202:205], v[122:125], v[142:145], v[202:205]
    v_add_f32_dpp v236, v234, v219 wave_shr:1 row_mask:0xf bank_mask:0xf
    v_add_f32_dpp v237, v234, v223 wave_ror:1 row_mask:0x1 bank_mask:0x1
    v_mfma_f32_16x16x32_bf16 v[202:205], v[126:129], v[146:149], v[202:205]
    ds_read_b64_tr_b16 v[158:159], v253 offset:1280
    v_add_f32_dpp v238, v236, v218 wave_shr:1 row_mask:0xf bank_mask:0xf
    v_mfma_f32_16x16x32_bf16 v[202:205], v[130:133], v[150:153], v[202:205]
    s_waitcnt lgkmcnt(2)
    ds_read_b64_tr_b16 v[160:161], v253 offset:1408
    v_mfma_f32_16x16x32_bf16 v[202:205], v[134:137], v[154:157], v[202:205]
    ds_write_addtid_b32 v238 offset:4096
    v_add_f32_dpp v239, v236, v222 wave_ror:1 row_mask:0x1 bank_mask:0x1
    v_mfma_f32_16x16x32_bf16 v[206:209], v[116:119], v[138:141], 0
    v_add_f32_dpp v235, v225, v224 wave_shr:1 row_mask:0xf bank_mask:0xf
    v_add_f32_dpp v234, v225, v228 wave_ror:1 row_mask:0x1 bank_mask:0x1
    v_mfma_f32_16x16x32_bf16 v[206:209], v[120:123], v[142:145], v[206:209]
    v_add_f32_dpp v237, v235, v223 wave_shr:1 row_mask:0xf bank_mask:0xf
    v_add_f32_dpp v236, v235, v227 wave_ror:1 row_mask:0x1 bank_mask:0x1
    v_mfma_f32_16x16x32_bf16 v[206:209], v[124:127], v[146:149], v[206:209]
    v_add_f32_dpp v239, v237, v222 wave_shr:1 row_mask:0xf bank_mask:0xf
    v_add_f32_dpp v238, v237, v226 wave_ror:1 row_mask:0x1 bank_mask:0x1
    v_mfma_f32_16x16x32_bf16 v[206:209], v[128:131], v[150:153], v[206:209]
    ds_write_addtid_b32 v239 offset:4352
    v_add_f32_dpp v234, v229, v228 wave_shr:1 row_mask:0xf bank_mask:0xf
    v_mfma_f32_16x16x32_bf16 v[206:209], v[132:135], v[154:157], v[206:209]
    s_nop 0
    v_add_f32_dpp v236, v234, v227 wave_shr:1 row_mask:0xf bank_mask:0xf
    v_add_f32_dpp v235, v229, v232 wave_ror:1 row_mask:0x1 bank_mask:0x1
    v_mfma_f32_16x16x32_bf16 v[210:213], v[114:117], v[138:141], 0
    v_add_f32_dpp v238, v236, v226 wave_shr:1 row_mask:0xf bank_mask:0xf
    v_add_f32_dpp v237, v234, v231 wave_ror:1 row_mask:0x1 bank_mask:0x1
    v_mfma_f32_16x16x32_bf16 v[210:213], v[118:121], v[142:145], v[210:213]
    ds_write_addtid_b32 v238 offset:6144
    v_add_f32_dpp v239, v236, v230 wave_ror:1 row_mask:0x1 bank_mask:0x1
    v_mfma_f32_16x16x32_bf16 v[210:213], v[122:125], v[146:149], v[210:213]
    v_add_f32_dpp v235, v233, v232 wave_shr:1 row_mask:0xf bank_mask:0xf
    v_add_f32_dpp v234, v233, v204 wave_ror:1 row_mask:0x1 bank_mask:0x1
    v_mfma_f32_16x16x32_bf16 v[210:213], v[126:129], v[150:153], v[210:213]
    v_add_f32_dpp v237, v235, v231 wave_shr:1 row_mask:0xf bank_mask:0xf
    v_add_f32_dpp v236, v235, v203 wave_ror:1 row_mask:0x1 bank_mask:0x1
    v_mfma_f32_16x16x32_bf16 v[210:213], v[130:133], v[154:157], v[210:213]
    s_waitcnt lgkmcnt(2)
    v_add_f32_dpp v239, v237, v230 wave_shr:1 row_mask:0xf bank_mask:0xf
    v_add_f32_dpp v238, v237, v202 wave_ror:1 row_mask:0x1 bank_mask:0x1
    v_mfma_f32_16x16x32_bf16 v[210:213], v[134:137], v[158:161], v[210:213]
    ds_read_b64_tr_b16 v[162:163], v253 offset:1536
    v_add_f32_dpp v234, v205, v204 wave_shr:1 row_mask:0xf bank_mask:0xf
    v_mfma_f32_16x16x32_bf16 v[214:217], v[112:115], v[138:141], 0
    ds_read_b64_tr_b16 v[164:165], v253 offset:1664
    v_add_f32_dpp v236, v234, v203 wave_shr:1 row_mask:0xf bank_mask:0xf
    v_mfma_f32_16x16x32_bf16 v[214:217], v[116:119], v[142:145], v[214:217]
    ds_write_addtid_b32 v239 offset:6400
    v_add_f32_dpp v238, v236, v202 wave_shr:1 row_mask:0xf bank_mask:0xf
    v_mfma_f32_16x16x32_bf16 v[214:217], v[120:123], v[146:149], v[214:217]
    ds_write_addtid_b32 v238 offset:8192
    v_add_f32_dpp v235, v205, v208 wave_ror:1 row_mask:0x1 bank_mask:0x1
    v_mfma_f32_16x16x32_bf16 v[214:217], v[124:127], v[150:153], v[214:217]
    v_add_f32_dpp v237, v234, v207 wave_ror:1 row_mask:0x1 bank_mask:0x1
    v_add_f32_dpp v239, v236, v206 wave_ror:1 row_mask:0x1 bank_mask:0x1
    v_mfma_f32_16x16x32_bf16 v[214:217], v[128:131], v[154:157], v[214:217]
    v_add_f32_dpp v235, v209, v208 wave_shr:1 row_mask:0xf bank_mask:0xf
    v_add_f32_dpp v234, v209, v212 wave_ror:1 row_mask:0x1 bank_mask:0x1
    v_mfma_f32_16x16x32_bf16 v[214:217], v[132:135], v[158:161], v[214:217]
    v_add_f32_dpp v237, v235, v207 wave_shr:1 row_mask:0xf bank_mask:0xf
    v_add_f32_dpp v236, v235, v211 wave_ror:1 row_mask:0x1 bank_mask:0x1
    v_mfma_f32_16x16x32_bf16 v[218:221], v[110:113], v[138:141], 0
    v_add_f32_dpp v239, v237, v206 wave_shr:1 row_mask:0xf bank_mask:0xf
    v_add_f32_dpp v238, v237, v210 wave_ror:1 row_mask:0x1 bank_mask:0x1
    v_mfma_f32_16x16x32_bf16 v[218:221], v[114:117], v[142:145], v[218:221]
    ds_write_addtid_b32 v239 offset:8448
    v_add_f32_dpp v234, v213, v212 wave_shr:1 row_mask:0xf bank_mask:0xf
    v_mfma_f32_16x16x32_bf16 v[218:221], v[118:121], v[146:149], v[218:221]
    s_nop 0
    v_add_f32_dpp v236, v234, v211 wave_shr:1 row_mask:0xf bank_mask:0xf
    v_add_f32_dpp v235, v213, v216 wave_ror:1 row_mask:0x1 bank_mask:0x1
    v_mfma_f32_16x16x32_bf16 v[218:221], v[122:125], v[150:153], v[218:221]
    v_add_f32_dpp v238, v236, v210 wave_shr:1 row_mask:0xf bank_mask:0xf
    v_add_f32_dpp v237, v234, v215 wave_ror:1 row_mask:0x1 bank_mask:0x1
    v_mfma_f32_16x16x32_bf16 v[218:221], v[126:129], v[154:157], v[218:221]
    ds_write_addtid_b32 v238 offset:10240
    v_add_f32_dpp v239, v236, v214 wave_ror:1 row_mask:0x1 bank_mask:0x1
    v_mfma_f32_16x16x32_bf16 v[218:221], v[130:133], v[158:161], v[218:221]
    s_waitcnt lgkmcnt(2)
    v_add_f32_dpp v235, v217, v216 wave_shr:1 row_mask:0xf bank_mask:0xf
    v_mfma_f32_16x16x32_bf16 v[218:221], v[134:137], v[162:165], v[218:221]
    ds_read_b64_tr_b16 v[2:3], v0 offset:4736
    v_add_f32_dpp v237, v235, v215 wave_shr:1 row_mask:0xf bank_mask:0xf
    v_mfma_f32_16x16x32_bf16 v[222:225], v[108:111], v[138:141], 0
    ds_read_b64_tr_b16 v[4:5], v0 offset:4608
    v_add_f32_dpp v239, v237, v214 wave_shr:1 row_mask:0xf bank_mask:0xf
    v_mfma_f32_16x16x32_bf16 v[222:225], v[112:115], v[142:145], v[222:225]
    ds_read_b64_tr_b16 v[166:167], v253 offset:1792
    ds_write_addtid_b32 v239 offset:10496
    v_mfma_f32_16x16x32_bf16 v[222:225], v[116:119], v[146:149], v[222:225]
    ds_read_b64_tr_b16 v[168:169], v253 offset:1920
    v_add_f32_dpp v234, v217, v220 wave_ror:1 row_mask:0x1 bank_mask:0x1
    v_mfma_f32_16x16x32_bf16 v[222:225], v[120:123], v[150:153], v[222:225]
    v_add_f32_dpp v236, v235, v219 wave_ror:1 row_mask:0x1 bank_mask:0x1
    v_add_f32_dpp v238, v237, v218 wave_ror:1 row_mask:0x1 bank_mask:0x1
    v_mfma_f32_16x16x32_bf16 v[222:225], v[124:127], v[154:157], v[222:225]
    ds_read_b64_tr_b16 v[6:7], v0 offset:4480
    v_add_f32_dpp v234, v221, v220 wave_shr:1 row_mask:0xf bank_mask:0xf
    v_mfma_f32_16x16x32_bf16 v[222:225], v[128:131], v[158:161], v[222:225]
    ds_read_b64_tr_b16 v[8:9], v0 offset:4352
    v_add_f32_dpp v236, v234, v219 wave_shr:1 row_mask:0xf bank_mask:0xf
    v_mfma_f32_16x16x32_bf16 v[222:225], v[132:135], v[162:165], v[222:225]
    s_cmp_eq_u32 s16, 4
    s_cselect_b32 s18, s17, 0
    v_add_u32 v0, s18, v0
    v_mfma_f32_16x16x32_bf16 v[226:229], v[106:109], v[138:141], 0
    ds_read_b64_tr_b16 v[10:11], v0 offset:4224
    v_add_f32_dpp v238, v236, v218 wave_shr:1 row_mask:0xf bank_mask:0xf
    v_mfma_f32_16x16x32_bf16 v[226:229], v[110:113], v[142:145], v[226:229]
    ds_write_addtid_b32 v238 offset:12288
    v_add_f32_dpp v235, v221, v224 wave_ror:1 row_mask:0x1 bank_mask:0x1
    v_mfma_f32_16x16x32_bf16 v[226:229], v[114:117], v[146:149], v[226:229]
    v_add_f32_dpp v237, v234, v223 wave_ror:1 row_mask:0x1 bank_mask:0x1
    v_add_f32_dpp v239, v236, v222 wave_ror:1 row_mask:0x1 bank_mask:0x1
    v_mfma_f32_16x16x32_bf16 v[226:229], v[118:121], v[150:153], v[226:229]
    ds_read_b64_tr_b16 v[12:13], v0 offset:4096
    v_add_f32_dpp v235, v225, v224 wave_shr:1 row_mask:0xf bank_mask:0xf
    v_mfma_f32_16x16x32_bf16 v[226:229], v[122:125], v[154:157], v[226:229]
    s_cmp_eq_u32 s16, 6
    s_cselect_b32 s18, s17, 0
    v_add_u32 v0, s18, v0
    v_mfma_f32_16x16x32_bf16 v[226:229], v[126:129], v[158:161], v[226:229]
    ds_read_b64_tr_b16 v[14:15], v0 offset:3968
    v_add_f32_dpp v237, v235, v223 wave_shr:1 row_mask:0xf bank_mask:0xf
    v_mfma_f32_16x16x32_bf16 v[226:229], v[130:133], v[162:165], v[226:229]
    s_waitcnt lgkmcnt(4)
    v_add_f32_dpp v239, v237, v222 wave_shr:1 row_mask:0xf bank_mask:0xf
    v_mfma_f32_16x16x32_bf16 v[226:229], v[134:137], v[166:169], v[226:229]
    ds_read_b32 v252, v254 offset:8
    ds_write_addtid_b32 v239 offset:12544
    v_mfma_f32_16x16x32_bf16 v[230:233], v[104:107], v[138:141], 0
    ds_read_b64_tr_b16 v[16:17], v0 offset:3840
    v_mfma_f32_16x16x32_bf16 v[230:233], v[108:111], v[142:145], v[230:233]
    s_cmp_eq_u32 s16, 8
    s_cselect_b32 s18, s17, 0
    v_add_u32 v0, s18, v0
    v_mfma_f32_16x16x32_bf16 v[230:233], v[112:115], v[146:149], v[230:233]
    v_add_f32_dpp v234, v225, v228 wave_ror:1 row_mask:0x1 bank_mask:0x1
    v_add_f32_dpp v236, v235, v227 wave_ror:1 row_mask:0x1 bank_mask:0x1
    v_mfma_f32_16x16x32_bf16 v[230:233], v[116:119], v[150:153], v[230:233]
    v_add_f32_dpp v238, v237, v226 wave_ror:1 row_mask:0x1 bank_mask:0x1
    v_add_f32_dpp v234, v229, v228 wave_shr:1 row_mask:0xf bank_mask:0xf
    v_mfma_f32_16x16x32_bf16 v[230:233], v[120:123], v[154:157], v[230:233]
    ds_read_b64_tr_b16 v[18:19], v0 offset:3712
    v_add_f32_dpp v236, v234, v227 wave_shr:1 row_mask:0xf bank_mask:0xf
    v_mfma_f32_16x16x32_bf16 v[230:233], v[124:127], v[158:161], v[230:233]
    s_waitcnt lgkmcnt(0)
    v_cmp_ne_u32 vcc, 1, v252
    s_cbranch_vccnz L_slow1
L_back1:
    v_mfma_f32_16x16x32_bf16 v[230:233], v[128:131], v[162:165], v[230:233]
    ds_read_b64_tr_b16 v[170:171], v253 offset:2048
    v_add_f32_dpp v238, v236, v226 wave_shr:1 row_mask:0xf bank_mask:0xf
    v_mfma_f32_16x16x32_bf16 v[230:233], v[132:135], v[166:169], v[230:233]
    ds_read_b64_tr_b16 v[172:173], v253 offset:2176
    ds_write_addtid_b32 v238 offset:14336
    v_mfma_f32_16x16x32_bf16 v[202:205], v[102:105], v[138:141], 0
    ds_read_b64_tr_b16 v[20:21], v0 offset:3584
    v_mfma_f32_16x16x32_bf16 v[202:205], v[106:109], v[142:145], v[202:205]
    s_cmp_eq_u32 s16, 10
    s_cselect_b32 s18, s17, 0
    v_add_u32 v0, s18, v0
    v_mfma_f32_16x16x32_bf16 v[202:205], v[110:113], v[146:149], v[202:205]
    v_add_f32_dpp v235, v229, v232 wave_ror:1 row_mask:0x1 bank_mask:0x1
    v_add_f32_dpp v237, v234, v231 wave_ror:1 row_mask:0x1 bank_mask:0x1
    v_mfma_f32_16x16x32_bf16 v[202:205], v[114:117], v[150:153], v[202:205]
    v_add_f32_dpp v239, v236, v230 wave_ror:1 row_mask:0x1 bank_mask:0x1
    v_add_f32_dpp v235, v233, v232 wave_shr:1 row_mask:0xf bank_mask:0xf
    v_mfma_f32_16x16x32_bf16 v[202:205], v[118:121], v[154:157], v[202:205]
    ds_read_b64_tr_b16 v[22:23], v0 offset:3456
    v_add_f32_dpp v237, v235, v231 wave_shr:1 row_mask:0xf bank_mask:0xf
    v_mfma_f32_16x16x32_bf16 v[202:205], v[122:125], v[158:161], v[202:205]
    ds_read_b64_tr_b16 v[24:25], v0 offset:3328
    v_add_f32_dpp v239, v237, v230 wave_shr:1 row_mask:0xf bank_mask:0xf
    v_mfma_f32_16x16x32_bf16 v[202:205], v[126:129], v[162:165], v[202:205]
    ds_write_addtid_b32 v239 offset:14592
    v_mfma_f32_16x16x32_bf16 v[202:205], v[130:133], v[166:169], v[202:205]
    s_waitcnt lgkmcnt(3)
    v_mfma_f32_16x16x32_bf16 v[202:205], v[134:137], v[170:173], v[202:205]
    s_cmp_eq_u32 s16, 12
    s_cselect_b32 s18, s17, 0
    v_add_u32 v0, s18, v0
    v_mfma_f32_16x16x32_bf16 v[206:209], v[100:103], v[138:141], 0
    ds_read_b64_tr_b16 v[26:27], v0 offset:3200
    v_mfma_f32_16x16x32_bf16 v[206:209], v[104:107], v[142:145], v[206:209]
    ds_read_b64_tr_b16 v[28:29], v0 offset:3072
    v_mfma_f32_16x16x32_bf16 v[206:209], v[108:111], v[146:149], v[206:209]
    v_add_f32_dpp v234, v233, v204 wave_ror:1 row_mask:0x1 bank_mask:0x1
    v_add_f32_dpp v236, v235, v203 wave_ror:1 row_mask:0x1 bank_mask:0x1
    v_mfma_f32_16x16x32_bf16 v[206:209], v[112:115], v[150:153], v[206:209]
    v_add_f32_dpp v238, v237, v202 wave_ror:1 row_mask:0x1 bank_mask:0x1
    v_add_f32_dpp v234, v205, v204 wave_shr:1 row_mask:0xf bank_mask:0xf
    v_mfma_f32_16x16x32_bf16 v[206:209], v[116:119], v[154:157], v[206:209]
    s_cmp_eq_u32 s16, 14
    s_cselect_b32 s18, s17, 0
    v_add_u32 v0, s18, v0
    v_mfma_f32_16x16x32_bf16 v[206:209], v[120:123], v[158:161], v[206:209]
    ds_read_b64_tr_b16 v[174:175], v253 offset:2304
    v_add_f32_dpp v236, v234, v203 wave_shr:1 row_mask:0xf bank_mask:0xf
    v_mfma_f32_16x16x32_bf16 v[206:209], v[124:127], v[162:165], v[206:209]
    ds_read_b64_tr_b16 v[176:177], v253 offset:2432
    v_add_f32_dpp v238, v236, v202 wave_shr:1 row_mask:0xf bank_mask:0xf
    v_mfma_f32_16x16x32_bf16 v[206:209], v[128:131], v[166:169], v[206:209]
    ds_write_addtid_b32 v238 offset:16384
    v_mfma_f32_16x16x32_bf16 v[206:209], v[132:135], v[170:173], v[206:209]
    ds_read_b64_tr_b16 v[30:31], v0 offset:2944
    v_mfma_f32_16x16x32_bf16 v[210:213], v[98:101], v[138:141], 0
    ds_read_b64_tr_b16 v[32:33], v0 offset:2816
    v_mfma_f32_16x16x32_bf16 v[210:213], v[102:105], v[142:145], v[210:213]
    s_cmp_eq_u32 s16, 16
    s_cselect_b32 s18, s17, 0
    v_add_u32 v0, s18, v0
    v_mfma_f32_16x16x32_bf16 v[210:213], v[106:109], v[146:149], v[210:213]
    v_add_f32_dpp v235, v205, v208 wave_ror:1 row_mask:0x1 bank_mask:0x1
    v_add_f32_dpp v237, v234, v207 wave_ror:1 row_mask:0x1 bank_mask:0x1
    v_mfma_f32_16x16x32_bf16 v[210:213], v[110:113], v[150:153], v[210:213]
    v_add_f32_dpp v239, v236, v206 wave_ror:1 row_mask:0x1 bank_mask:0x1
    v_add_f32_dpp v235, v209, v208 wave_shr:1 row_mask:0xf bank_mask:0xf
    v_mfma_f32_16x16x32_bf16 v[210:213], v[114:117], v[154:157], v[210:213]
    ds_read_b64_tr_b16 v[34:35], v0 offset:2688
    v_add_f32_dpp v237, v235, v207 wave_shr:1 row_mask:0xf bank_mask:0xf
    v_mfma_f32_16x16x32_bf16 v[210:213], v[118:121], v[158:161], v[210:213]
    ds_read_b64_tr_b16 v[36:37], v0 offset:2560
    v_add_f32_dpp v239, v237, v206 wave_shr:1 row_mask:0xf bank_mask:0xf
    v_mfma_f32_16x16x32_bf16 v[210:213], v[122:125], v[162:165], v[210:213]
    ds_write_addtid_b32 v239 offset:16640
    v_mfma_f32_16x16x32_bf16 v[210:213], v[126:129], v[166:169], v[210:213]
    s_cmp_eq_u32 s16, 18
    s_cselect_b32 s18, s17, 0
    v_add_u32 v0, s18, v0
    v_mfma_f32_16x16x32_bf16 v[210:213], v[130:133], v[170:173], v[210:213]
    s_waitcnt lgkmcnt(3)
    ds_read_b64_tr_b16 v[38:39], v0 offset:2432
    v_mfma_f32_16x16x32_bf16 v[210:213], v[134:137], v[174:177], v[210:213]
    ds_read_b64_tr_b16 v[40:41], v0 offset:2304
    v_mfma_f32_16x16x32_bf16 v[214:217], v[96:99], v[138:141], 0
    ds_read_b64_tr_b16 v[42:43], v0 offset:2176
    v_mfma_f32_16x16x32_bf16 v[214:217], v[100:103], v[142:145], v[214:217]
    ds_read_b64_tr_b16 v[44:45], v0 offset:2048
    v_mfma_f32_16x16x32_bf16 v[214:217], v[104:107], v[146:149], v[214:217]
    ds_read_b64_tr_b16 v[46:47], v0 offset:1920
    v_mfma_f32_16x16x32_bf16 v[214:217], v[108:111], v[150:153], v[214:217]
    v_add_f32_dpp v234, v209, v212 wave_ror:1 row_mask:0x1 bank_mask:0x1
    v_add_f32_dpp v236, v235, v211 wave_ror:1 row_mask:0x1 bank_mask:0x1
    v_mfma_f32_16x16x32_bf16 v[214:217], v[112:115], v[154:157], v[214:217]
    v_add_f32_dpp v238, v237, v210 wave_ror:1 row_mask:0x1 bank_mask:0x1
    v_add_f32_dpp v234, v213, v212 wave_shr:1 row_mask:0xf bank_mask:0xf
    v_mfma_f32_16x16x32_bf16 v[214:217], v[116:119], v[158:161], v[214:217]
    ds_read_b64_tr_b16 v[48:49], v0 offset:1792
    v_add_f32_dpp v236, v234, v211 wave_shr:1 row_mask:0xf bank_mask:0xf
    v_mfma_f32_16x16x32_bf16 v[214:217], v[120:123], v[162:165], v[214:217]
    ds_read_b64_tr_b16 v[50:51], v0 offset:1664
    v_add_f32_dpp v238, v236, v210 wave_shr:1 row_mask:0xf bank_mask:0xf
    v_mfma_f32_16x16x32_bf16 v[214:217], v[124:127], v[166:169], v[214:217]
    ds_read_b64_tr_b16 v[178:179], v253 offset:2560
    ds_write_addtid_b32 v238 offset:18432
    v_mfma_f32_16x16x32_bf16 v[214:217], v[128:131], v[170:173], v[214:217]
    ds_read_b64_tr_b16 v[180:181], v253 offset:2688
    v_mfma_f32_16x16x32_bf16 v[214:217], v[132:135], v[174:177], v[214:217]
    ds_read_b64_tr_b16 v[52:53], v0 offset:1536
    v_mfma_f32_16x16x32_bf16 v[218:221], v[94:97], v[138:141], 0
    ds_read_b64_tr_b16 v[54:55], v0 offset:1408
    v_mfma_f32_16x16x32_bf16 v[218:221], v[98:101], v[142:145], v[218:221]
    ds_read_b64_tr_b16 v[56:57], v0 offset:1280
    v_mfma_f32_16x16x32_bf16 v[218:221], v[102:105], v[146:149], v[218:221]
    ds_read_b64_tr_b16 v[58:59], v0 offset:1152
    v_mfma_f32_16x16x32_bf16 v[218:221], v[106:109], v[150:153], v[218:221]
    v_add_f32_dpp v235, v213, v216 wave_ror:1 row_mask:0x1 bank_mask:0x1
    v_add_f32_dpp v237, v234, v215 wave_ror:1 row_mask:0x1 bank_mask:0x1
    v_mfma_f32_16x16x32_bf16 v[218:221], v[110:113], v[154:157], v[218:221]
    v_add_f32_dpp v239, v236, v214 wave_ror:1 row_mask:0x1 bank_mask:0x1
    v_add_f32_dpp v235, v217, v216 wave_shr:1 row_mask:0xf bank_mask:0xf
    v_mfma_f32_16x16x32_bf16 v[218:221], v[114:117], v[158:161], v[218:221]
    ds_read_b64_tr_b16 v[60:61], v0 offset:1024
    v_add_f32_dpp v237, v235, v215 wave_shr:1 row_mask:0xf bank_mask:0xf
    v_mfma_f32_16x16x32_bf16 v[218:221], v[118:121], v[162:165], v[218:221]
    ds_read_b64_tr_b16 v[62:63], v0 offset:896
    v_add_f32_dpp v239, v237, v214 wave_shr:1 row_mask:0xf bank_mask:0xf
    v_mfma_f32_16x16x32_bf16 v[218:221], v[122:125], v[166:169], v[218:221]
    ds_write_addtid_b32 v239 offset:18688
    v_mfma_f32_16x16x32_bf16 v[218:221], v[126:129], v[170:173], v[218:221]
    ds_read_b64_tr_b16 v[64:65], v0 offset:768
    v_mfma_f32_16x16x32_bf16 v[218:221], v[130:133], v[174:177], v[218:221]
    s_waitcnt lgkmcnt(4)
    ds_read_b64_tr_b16 v[66:67], v0 offset:640
    v_mfma_f32_16x16x32_bf16 v[218:221], v[134:137], v[178:181], v[218:221]
    ds_read_b64_tr_b16 v[68:69], v0 offset:512
    v_mfma_f32_16x16x32_bf16 v[222:225], v[92:95], v[138:141], 0
    ds_read_b64_tr_b16 v[70:71], v0 offset:384
    v_mfma_f32_16x16x32_bf16 v[222:225], v[96:99], v[142:145], v[222:225]
    ds_read_b64_tr_b16 v[72:73], v0 offset:256
    v_mfma_f32_16x16x32_bf16 v[222:225], v[100:103], v[146:149], v[222:225]
    ds_read_b64_tr_b16 v[74:75], v0 offset:128
    v_mfma_f32_16x16x32_bf16 v[222:225], v[104:107], v[150:153], v[222:225]
    v_add_f32_dpp v234, v217, v220 wave_ror:1 row_mask:0x1 bank_mask:0x1
    v_add_f32_dpp v236, v235, v219 wave_ror:1 row_mask:0x1 bank_mask:0x1
    v_mfma_f32_16x16x32_bf16 v[222:225], v[108:111], v[154:157], v[222:225]
    v_add_f32_dpp v238, v237, v218 wave_ror:1 row_mask:0x1 bank_mask:0x1
    v_add_f32_dpp v234, v221, v220 wave_shr:1 row_mask:0xf bank_mask:0xf
    v_mfma_f32_16x16x32_bf16 v[222:225], v[112:115], v[158:161], v[222:225]
    ds_read_b64_tr_b16 v[76:77], v0 offset:0
    v_add_f32_dpp v236, v234, v219 wave_shr:1 row_mask:0xf bank_mask:0xf
    v_mfma_f32_16x16x32_bf16 v[222:225], v[116:119], v[162:165], v[222:225]
    s_nop 0
    v_add_f32_dpp v238, v236, v218 wave_shr:1 row_mask:0xf bank_mask:0xf
    v_mfma_f32_16x16x32_bf16 v[222:225], v[120:123], v[166:169], v[222:225]
    ds_write_addtid_b32 v238 offset:20480
    v_mfma_f32_16x16x32_bf16 v[222:225], v[124:127], v[170:173], v[222:225]
    v_mfma_f32_16x16x32_bf16 v[222:225], v[128:131], v[174:177], v[222:225]
    ds_read_b64_tr_b16 v[182:183], v253 offset:2816
    v_mfma_f32_16x16x32_bf16 v[222:225], v[132:135], v[178:181], v[222:225]
    ds_read_b64_tr_b16 v[184:185], v253 offset:2944
    v_mfma_f32_16x16x32_bf16 v[226:229], v[90:93], v[138:141], 0
    v_mfma_f32_16x16x32_bf16 v[226:229], v[94:97], v[142:145], v[226:229]
    ds_read_b32 v252, v254 offset:28
    v_mfma_f32_16x16x32_bf16 v[226:229], v[98:101], v[146:149], v[226:229]
    v_mfma_f32_16x16x32_bf16 v[226:229], v[102:105], v[150:153], v[226:229]
    v_mfma_f32_16x16x32_bf16 v[226:229], v[106:109], v[154:157], v[226:229]
    s_nop 0
    v_add_f32_dpp v235, v221, v224 wave_ror:1 row_mask:0x1 bank_mask:0x1
    v_add_f32_dpp v237, v234, v223 wave_ror:1 row_mask:0x1 bank_mask:0x1
    v_mfma_f32_16x16x32_bf16 v[226:229], v[110:113], v[158:161], v[226:229]
    v_add_f32_dpp v239, v236, v222 wave_ror:1 row_mask:0x1 bank_mask:0x1
    v_add_f32_dpp v235, v225, v224 wave_shr:1 row_mask:0xf bank_mask:0xf
    v_mfma_f32_16x16x32_bf16 v[226:229], v[114:117], v[162:165], v[226:229]
    s_nop 0
    v_add_f32_dpp v237, v235, v223 wave_shr:1 row_mask:0xf bank_mask:0xf
    v_mfma_f32_16x16x32_bf16 v[226:229], v[118:121], v[166:169], v[226:229]
    s_nop 0
    v_add_f32_dpp v239, v237, v222 wave_shr:1 row_mask:0xf bank_mask:0xf
    v_mfma_f32_16x16x32_bf16 v[226:229], v[122:125], v[170:173], v[226:229]
    ds_write_addtid_b32 v239 offset:20736
    v_mfma_f32_16x16x32_bf16 v[226:229], v[126:129], v[174:177], v[226:229]
    s_waitcnt lgkmcnt(0)
    v_cmp_ne_u32 vcc, 4, v252
    s_cbranch_vccnz L_slow2
L_back2:
    v_mfma_f32_16x16x32_bf16 v[226:229], v[130:133], v[178:181], v[226:229]
    v_mfma_f32_16x16x32_bf16 v[226:229], v[134:137], v[182:185], v[226:229]
    ds_read_b64_tr_b16 v[186:187], v1 offset:0
    v_mfma_f32_16x16x32_bf16 v[230:233], v[88:91], v[138:141], 0
    ds_read_b64_tr_b16 v[188:189], v1 offset:512
    v_mfma_f32_16x16x32_bf16 v[230:233], v[92:95], v[142:145], v[230:233]
    v_mfma_f32_16x16x32_bf16 v[230:233], v[96:99], v[146:149], v[230:233]
    s_cmp_eq_u32 s4, 0
    s_cbranch_scc1 L_tail0
    v_mfma_f32_16x16x32_bf16 v[230:233], v[100:103], v[150:153], v[230:233]
    s_cmp_eq_u32 s4, 1
    s_cbranch_scc1 L_tail1
    v_add_f32_dpp v234, v225, v228 wave_ror:1 row_mask:0x1 bank_mask:0x1
    v_mfma_f32_16x16x32_bf16 v[230:233], v[104:107], v[154:157], v[230:233]
    s_cmp_eq_u32 s4, 2
    s_cbranch_scc1 L_tail2
    v_add_f32_dpp v236, v235, v227 wave_ror:1 row_mask:0x1 bank_mask:0x1
    v_mfma_f32_16x16x32_bf16 v[230:233], v[108:111], v[158:161], v[230:233]
    s_cmp_eq_u32 s4, 3
    s_cbranch_scc1 L_tail3
    v_add_f32_dpp v238, v237, v226 wave_ror:1 row_mask:0x1 bank_mask:0x1
    v_mfma_f32_16x16x32_bf16 v[230:233], v[112:115], v[162:165], v[230:233]
    s_cmp_eq_u32 s4, 4
    s_cbranch_scc1 L_tail4
    v_add_f32_dpp v234, v229, v228 wave_shr:1 row_mask:0xf bank_mask:0xf
    v_mfma_f32_16x16x32_bf16 v[230:233], v[116:119], v[166:169], v[230:233]
    s_cmp_eq_u32 s4, 5
    s_cbranch_scc1 L_tail5
    v_add_f32_dpp v236, v234, v227 wave_shr:1 row_mask:0xf bank_mask:0xf
    v_mfma_f32_16x16x32_bf16 v[230:233], v[120:123], v[170:173], v[230:233]
    s_cmp_eq_u32 s4, 6
    s_cbranch_scc1 L_tail6
    v_add_f32_dpp v238, v236, v226 wave_shr:1 row_mask:0xf bank_mask:0xf
    v_mfma_f32_16x16x32_bf16 v[230:233], v[124:127], v[174:177], v[230:233]
    s_branch L_tail7
L_slow1:
    s_mov_b32 s14, 0
L_slow1b:
    ds_read_b32 v252, v254 offset:8
    s_add_u32 s14, s14, 1
    s_waitcnt lgkmcnt(0)
    v_cmp_ne_u32 vcc, 1, v252
    s_cbranch_vccz L_back1
    s_cmp_lt_u32 s14, 262144
    s_cbranch_scc1 L_slow1b
    s_branch L_back1
L_slow3:
    s_mov_b32 s14, 0
L_slow3b:
    ds_read_b32 v246, v254 offset:12
    s_add_u32 s14, s14, 1
    s_waitcnt lgkmcnt(0)
    v_cmp_ne_u32 vcc, 8, v246
    s_cbranch_vccz L_back3
    s_cmp_lt_u32 s14, 262144
    s_cbranch_scc1 L_slow3b
    s_branch L_back3
L_slow2:
    s_mov_b32 s14, 0
L_slow2b:
    ds_read_b32 v252, v254 offset:28
    s_add_u32 s14, s14, 1
    s_waitcnt lgkmcnt(0)
    v_cmp_ne_u32 vcc, 4, v252
    s_cbranch_vccz L_back2
    s_cmp_lt_u32 s14, 262144
    s_cbranch_scc1 L_slow2b
    s_branch L_back2
.p2align 12
L_padt0:
    s_cbranch_execz L_rett
L_tail0:
    v_mfma_f32_16x16x32_bf16 v[230:233], v[100:103], v[150:153], v[230:233]
    ds_read_b64_tr_b16 v[190:191], v1 offset:1024
    v_add_f32_dpp v234, v225, v228 wave_ror:1 row_mask:0x1 bank_mask:0x1
    v_mfma_f32_16x16x32_bf16 v[230:233], v[104:107], v[154:157], v[230:233]
    ds_read_b64_tr_b16 v[192:193], v1 offset:1536
    v_add_f32_dpp v236, v235, v227 wave_ror:1 row_mask:0x1 bank_mask:0x1
    v_mfma_f32_16x16x32_bf16 v[230:233], v[108:111], v[158:161], v[230:233]
    ds_read_b64_tr_b16 v[194:195], v1 offset:2048
    v_add_f32_dpp v238, v237, v226 wave_ror:1 row_mask:0x1 bank_mask:0x1
    v_mfma_f32_16x16x32_bf16 v[230:233], v[112:115], v[162:165], v[230:233]
    ds_read_b64_tr_b16 v[196:197], v1 offset:2560
    v_add_f32_dpp v234, v229, v228 wave_shr:1 row_mask:0xf bank_mask:0xf
    v_mfma_f32_16x16x32_bf16 v[230:233], v[116:119], v[166:169], v[230:233]
    s_nop 0
    v_add_f32_dpp v236, v234, v227 wave_shr:1 row_mask:0xf bank_mask:0xf
    v_mfma_f32_16x16x32_bf16 v[230:233], v[120:123], v[170:173], v[230:233]
    ds_read_b64_tr_b16 v[198:199], v1 offset:3072
    v_add_f32_dpp v238, v236, v226 wave_shr:1 row_mask:0xf bank_mask:0xf
    v_mfma_f32_16x16x32_bf16 v[230:233], v[124:127], v[174:177], v[230:233]
    ds_read_b64_tr_b16 v[200:201], v1 offset:3584
    ds_write_addtid_b32 v238 offset:22528
    v_mfma_f32_16x16x32_bf16 v[230:233], v[128:131], v[178:181], v[230:233]
    v_mfma_f32_16x16x32_bf16 v[230:233], v[132:135], v[182:185], v[230:233]
    s_waitcnt lgkmcnt(5)
    v_mfma_f32_16x16x32_bf16 v[202:205], v[6:9], v[186:189], 0
    v_mfma_f32_16x16x32_bf16 v[206:209], v[4:7], v[186:189], 0
    v_mfma_f32_16x16x32_bf16 v[210:213], v[2:5], v[186:189], 0
    v_mfma_f32_16x16x32_bf16 v[214:217], v[12:15], v[186:189], 0
    v_mfma_f32_16x16x32_bf16 v[218:221], v[10:13], v[186:189], 0
    ds_read_b64_tr_b16 v[186:187], v1 offset:4096
    v_mfma_f32_16x16x32_bf16 v[210:213], v[6:9], v[190:193], v[210:213]
    v_add_f32_dpp v235, v229, v232 wave_ror:1 row_mask:0x1 bank_mask:0x1
    v_add_f32_dpp v237, v234, v231 wave_ror:1 row_mask:0x1 bank_mask:0x1
    v_mfma_f32_16x16x32_bf16 v[214:217], v[16:19], v[190:193], v[214:217]
    ds_read_b64_tr_b16 v[188:189], v1 offset:4608
    v_add_f32_dpp v239, v236, v230 wave_ror:1 row_mask:0x1 bank_mask:0x1
    v_mfma_f32_16x16x32_bf16 v[218:221], v[14:17], v[190:193], v[218:221]
    s_waitcnt lgkmcnt(2)
    v_add_f32_dpp v235, v233, v232 wave_shr:1 row_mask:0xf bank_mask:0xf
    v_add_f32_dpp v240, v205, v204 wave_shr:1 row_mask:0xf bank_mask:0xf bound_ctrl:0
    v_mfma_f32_16x16x32_bf16 v[214:217], v[20:23], v[194:197], v[214:217]
    ds_read_b64_tr_b16 v[190:191], v1 offset:5120
    ds_read_b64_tr_b16 v[192:193], v1 offset:5632
    v_mfma_f32_16x16x32_bf16 v[218:221], v[18:21], v[194:197], v[218:221]
    ds_read_b64_tr_b16 v[194:195], v1 offset:6144
    ds_read_b64_tr_b16 v[196:197], v1 offset:6656
    v_mfma_f32_16x16x32_bf16 v[214:217], v[24:27], v[198:201], v[214:217]
    v_add_f32_dpp v237, v235, v231 wave_shr:1 row_mask:0xf bank_mask:0xf
    v_add_f32_dpp v242, v240, v203 wave_shr:1 row_mask:0xf bank_mask:0xf bound_ctrl:0
    v_mfma_f32_16x16x32_bf16 v[218:221], v[22:25], v[198:201], v[218:221]
    s_waitcnt lgkmcnt(4)
    v_add_f32_dpp v239, v237, v230 wave_shr:1 row_mask:0xf bank_mask:0xf
    v_add_f32_dpp v244, v242, v202 wave_shr:1 row_mask:0xf bank_mask:0xf bound_ctrl:0
    v_mfma_f32_16x16x32_bf16 v[214:217], v[28:31], v[186:189], v[214:217]
    ds_read_b64_tr_b16 v[198:199], v1 offset:7168
    ds_read_b64_tr_b16 v[200:201], v1 offset:7680
    v_mfma_f32_16x16x32_bf16 v[218:221], v[26:29], v[186:189], v[218:221]
    s_waitcnt lgkmcnt(4)
    ds_write_addtid_b32 v239 offset:22784
    v_mfma_f32_16x16x32_bf16 v[214:217], v[32:35], v[190:193], v[214:217]
    ds_read_b64_tr_b16 v[186:187], v1 offset:8192
    ds_read_b64_tr_b16 v[188:189], v1 offset:8704
    v_mfma_f32_16x16x32_bf16 v[218:221], v[30:33], v[190:193], v[218:221]
    s_waitcnt lgkmcnt(5)
    ds_write_addtid_b32 v244 offset:36864
    v_mfma_f32_16x16x32_bf16 v[214:217], v[36:39], v[194:197], v[214:217]
    ds_read_b64_tr_b16 v[190:191], v1 offset:9216
    ds_read_b64_tr_b16 v[192:193], v1 offset:9728
    v_mfma_f32_16x16x32_bf16 v[218:221], v[34:37], v[194:197], v[218:221]
    s_waitcnt lgkmcnt(6)
    v_add_f32_dpp v241, v205, v208 wave_ror:1 row_mask:0x1 bank_mask:0x1
    v_add_f32_dpp v243, v240, v207 wave_ror:1 row_mask:0x1 bank_mask:0x1
    v_mfma_f32_16x16x32_bf16 v[214:217], v[40:43], v[198:201], v[214:217]
    ds_read_b64_tr_b16 v[194:195], v1 offset:10240
    ds_read_b64_tr_b16 v[196:197], v1 offset:10752
    v_mfma_f32_16x16x32_bf16 v[218:221], v[38:41], v[198:201], v[218:221]
    s_waitcnt lgkmcnt(5)
    v_add_f32_dpp v245, v242, v206 wave_ror:1 row_mask:0x1 bank_mask:0x1
    v_add_f32_dpp v241, v209, v208 wave_shr:1 row_mask:0xf bank_mask:0xf
    v_mfma_f32_16x16x32_bf16 v[214:217], v[44:47], v[186:189], v[214:217]
    ds_read_b64_tr_b16 v[198:199], v1 offset:11264
    ds_read_b64_tr_b16 v[200:201], v1 offset:11776
    v_mfma_f32_16x16x32_bf16 v[218:221], v[42:45], v[186:189], v[218:221]
    s_waitcnt lgkmcnt(4)
    v_add_f32_dpp v243, v241, v207 wave_shr:1 row_mask:0xf bank_mask:0xf
    v_add_f32_dpp v240, v209, v212 wave_ror:1 row_mask:0x1 bank_mask:0x1
    v_mfma_f32_16x16x32_bf16 v[214:217], v[48:51], v[190:193], v[214:217]
    ds_read_b64_tr_b16 v[186:187], v1 offset:12288
    ds_read_b64_tr_b16 v[188:189], v1 offset:12800
    v_mfma_f32_16x16x32_bf16 v[218:221], v[46:49], v[190:193], v[218:221]
    s_waitcnt lgkmcnt(4)
    v_add_f32_dpp v245, v243, v206 wave_shr:1 row_mask:0xf bank_mask:0xf
    v_add_f32_dpp v242, v241, v211 wave_ror:1 row_mask:0x1 bank_mask:0x1
    v_mfma_f32_16x16x32_bf16 v[214:217], v[52:55], v[194:197], v[214:217]
    ds_read_b64_tr_b16 v[190:191], v1 offset:13312
    ds_read_b64_tr_b16 v[192:193], v1 offset:13824
    v_mfma_f32_16x16x32_bf16 v[218:221], v[50:53], v[194:197], v[218:221]
    s_waitcnt lgkmcnt(4)
    ds_write_addtid_b32 v245 offset:32768
    v_mfma_f32_16x16x32_bf16 v[214:217], v[56:59], v[198:201], v[214:217]
    ds_read_b64_tr_b16 v[194:195], v1 offset:14336
    ds_read_b64_tr_b16 v[196:197], v1 offset:14848
    v_mfma_f32_16x16x32_bf16 v[218:221], v[54:57], v[198:201], v[218:221]
    s_waitcnt lgkmcnt(5)
    v_add_f32_dpp v244, v243, v210 wave_ror:1 row_mask:0x1 bank_mask:0x1
    v_add_f32_dpp v240, v213, v212 wave_shr:1 row_mask:0xf bank_mask:0xf
    v_mfma_f32_16x16x32_bf16 v[214:217], v[60:63], v[186:189], v[214:217]
    ds_read_b64_tr_b16 v[198:199], v1 offset:15360
    ds_read_b64_tr_b16 v[200:201], v1 offset:15872
    v_mfma_f32_16x16x32_bf16 v[218:221], v[58:61], v[186:189], v[218:221]
    s_waitcnt lgkmcnt(5)
    v_add_f32_dpp v242, v240, v211 wave_shr:1 row_mask:0xf bank_mask:0xf
    v_mfma_f32_16x16x32_bf16 v[214:217], v[64:67], v[190:193], v[214:217]
    s_nop 0
    v_add_f32_dpp v244, v242, v210 wave_shr:1 row_mask:0xf bank_mask:0xf
    v_mfma_f32_16x16x32_bf16 v[218:221], v[62:65], v[190:193], v[218:221]
    s_waitcnt lgkmcnt(2)
    ds_write_addtid_b32 v244 offset:33024
    v_mfma_f32_16x16x32_bf16 v[214:217], v[68:71], v[194:197], v[214:217]
    v_mfma_f32_16x16x32_bf16 v[218:221], v[66:69], v[194:197], v[218:221]
    s_waitcnt lgkmcnt(1)
    v_mfma_f32_16x16x32_bf16 v[214:217], v[72:75], v[198:201], v[214:217]
    v_mfma_f32_16x16x32_bf16 v[218:221], v[70:73], v[198:201], v[218:221]
    ds_read_b64_tr_b16 v[186:187], v253 offset:3072
    v_mfma_f32_16x16x32_bf16 v[222:225], v[86:89], v[138:141], 0
    ds_read_b64_tr_b16 v[188:189], v253 offset:3200
    v_mfma_f32_16x16x32_bf16 v[222:225], v[90:93], v[142:145], v[222:225]
    v_mfma_f32_16x16x32_bf16 v[222:225], v[94:97], v[146:149], v[222:225]
    v_mfma_f32_16x16x32_bf16 v[222:225], v[98:101], v[150:153], v[222:225]
    s_nop 0
    v_add_f32_dpp v240, v217, v216 wave_shr:1 row_mask:0xf bank_mask:0xf bound_ctrl:0
    v_add_f32_dpp v241, v217, v220 wave_ror:1 row_mask:0x1 bank_mask:0x1
    v_mfma_f32_16x16x32_bf16 v[222:225], v[102:105], v[154:157], v[222:225]
    v_add_f32_dpp v242, v240, v215 wave_shr:1 row_mask:0xf bank_mask:0xf bound_ctrl:0
    v_add_f32_dpp v243, v240, v219 wave_ror:1 row_mask:0x1 bank_mask:0x1
    v_mfma_f32_16x16x32_bf16 v[222:225], v[106:109], v[158:161], v[222:225]
    v_add_f32_dpp v244, v242, v214 wave_shr:1 row_mask:0xf bank_mask:0xf bound_ctrl:0
    v_add_f32_dpp v245, v242, v218 wave_ror:1 row_mask:0x1 bank_mask:0x1
    v_mfma_f32_16x16x32_bf16 v[222:225], v[110:113], v[162:165], v[222:225]
    ds_write_addtid_b32 v244 offset:34816
    v_add_f32_dpp v241, v221, v220 wave_shr:1 row_mask:0xf bank_mask:0xf
    v_mfma_f32_16x16x32_bf16 v[222:225], v[114:117], v[166:169], v[222:225]
    s_nop 0
    v_add_f32_dpp v243, v241, v219 wave_shr:1 row_mask:0xf bank_mask:0xf
    v_mfma_f32_16x16x32_bf16 v[222:225], v[118:121], v[170:173], v[222:225]
    s_nop 0
    v_add_f32_dpp v245, v243, v218 wave_shr:1 row_mask:0xf bank_mask:0xf
    v_mfma_f32_16x16x32_bf16 v[222:225], v[122:125], v[174:177], v[222:225]
    ds_write_addtid_b32 v245 offset:35072
    v_mfma_f32_16x16x32_bf16 v[222:225], v[126:129], v[178:181], v[222:225]
    v_mfma_f32_16x16x32_bf16 v[222:225], v[130:133], v[182:185], v[222:225]
    s_waitcnt lgkmcnt(2)
    v_mfma_f32_16x16x32_bf16 v[222:225], v[134:137], v[186:189], v[222:225]
    v_mfma_f32_16x16x32_bf16 v[226:229], v[84:87], v[138:141], 0
    v_mfma_f32_16x16x32_bf16 v[226:229], v[88:91], v[142:145], v[226:229]
    v_mfma_f32_16x16x32_bf16 v[226:229], v[92:95], v[146:149], v[226:229]
    v_mfma_f32_16x16x32_bf16 v[226:229], v[96:99], v[150:153], v[226:229]
    v_mfma_f32_16x16x32_bf16 v[226:229], v[100:103], v[154:157], v[226:229]
    v_mfma_f32_16x16x32_bf16 v[226:229], v[104:107], v[158:161], v[226:229]
    v_mfma_f32_16x16x32_bf16 v[226:229], v[108:111], v[162:165], v[226:229]
    s_nop 0
    v_add_f32_dpp v234, v233, v224 wave_ror:1 row_mask:0x1 bank_mask:0x1
    v_add_f32_dpp v236, v235, v223 wave_ror:1 row_mask:0x1 bank_mask:0x1
    v_mfma_f32_16x16x32_bf16 v[226:229], v[112:115], v[166:169], v[226:229]
    v_add_f32_dpp v238, v237, v222 wave_ror:1 row_mask:0x1 bank_mask:0x1
    v_add_f32_dpp v234, v225, v224 wave_shr:1 row_mask:0xf bank_mask:0xf
    v_mfma_f32_16x16x32_bf16 v[226:229], v[116:119], v[170:173], v[226:229]
    s_nop 0
    v_add_f32_dpp v236, v234, v223 wave_shr:1 row_mask:0xf bank_mask:0xf
    v_mfma_f32_16x16x32_bf16 v[226:229], v[120:123], v[174:177], v[226:229]
    s_nop 0
    v_add_f32_dpp v238, v236, v222 wave_shr:1 row_mask:0xf bank_mask:0xf
    v_mfma_f32_16x16x32_bf16 v[226:229], v[124:127], v[178:181], v[226:229]
    ds_write_addtid_b32 v238 offset:24576
    v_mfma_f32_16x16x32_bf16 v[226:229], v[128:131], v[182:185], v[226:229]
    v_mfma_f32_16x16x32_bf16 v[226:229], v[132:135], v[186:189], v[226:229]
    v_mfma_f32_16x16x32_bf16 v[230:233], v[82:85], v[138:141], 0
    ds_read_b64_tr_b16 v[190:191], v253 offset:3328
    v_mfma_f32_16x16x32_bf16 v[230:233], v[86:89], v[142:145], v[230:233]
    ds_read_b64_tr_b16 v[192:193], v253 offset:3456
    v_mfma_f32_16x16x32_bf16 v[230:233], v[90:93], v[146:149], v[230:233]
    v_mfma_f32_16x16x32_bf16 v[230:233], v[94:97], v[150:153], v[230:233]
    v_mfma_f32_16x16x32_bf16 v[230:233], v[98:101], v[154:157], v[230:233]
    s_nop 0
    v_add_f32_dpp v235, v225, v228 wave_ror:1 row_mask:0x1 bank_mask:0x1
    v_add_f32_dpp v237, v234, v227 wave_ror:1 row_mask:0x1 bank_mask:0x1
    v_mfma_f32_16x16x32_bf16 v[230:233], v[102:105], v[158:161], v[230:233]
    v_add_f32_dpp v239, v236, v226 wave_ror:1 row_mask:0x1 bank_mask:0x1
    v_add_f32_dpp v235, v229, v228 wave_shr:1 row_mask:0xf bank_mask:0xf
    v_mfma_f32_16x16x32_bf16 v[230:233], v[106:109], v[162:165], v[230:233]
    s_nop 0
    v_add_f32_dpp v237, v235, v227 wave_shr:1 row_mask:0xf bank_mask:0xf
    v_mfma_f32_16x16x32_bf16 v[230:233], v[110:113], v[166:169], v[230:233]
    s_nop 0
    v_add_f32_dpp v239, v237, v226 wave_shr:1 row_mask:0xf bank_mask:0xf
    v_mfma_f32_16x16x32_bf16 v[230:233], v[114:117], v[170:173], v[230:233]
    ds_write_addtid_b32 v239 offset:24832
    v_mfma_f32_16x16x32_bf16 v[230:233], v[118:121], v[174:177], v[230:233]
    v_mfma_f32_16x16x32_bf16 v[230:233], v[122:125], v[178:181], v[230:233]
    v_mfma_f32_16x16x32_bf16 v[230:233], v[126:129], v[182:185], v[230:233]
    v_mfma_f32_16x16x32_bf16 v[230:233], v[130:133], v[186:189], v[230:233]
    s_waitcnt lgkmcnt(1)
    v_mfma_f32_16x16x32_bf16 v[230:233], v[134:137], v[190:193], v[230:233]
    v_mfma_f32_16x16x32_bf16 v[202:205], v[80:83], v[138:141], 0
    v_mfma_f32_16x16x32_bf16 v[202:205], v[84:87], v[142:145], v[202:205]
    v_mfma_f32_16x16x32_bf16 v[202:205], v[88:91], v[146:149], v[202:205]
    v_mfma_f32_16x16x32_bf16 v[202:205], v[92:95], v[150:153], v[202:205]
    v_mfma_f32_16x16x32_bf16 v[202:205], v[96:99], v[154:157], v[202:205]
    v_mfma_f32_16x16x32_bf16 v[202:205], v[100:103], v[158:161], v[202:205]
    v_mfma_f32_16x16x32_bf16 v[202:205], v[104:107], v[162:165], v[202:205]
    s_nop 0
    v_add_f32_dpp v234, v229, v232 wave_ror:1 row_mask:0x1 bank_mask:0x1
    v_add_f32_dpp v236, v235, v231 wave_ror:1 row_mask:0x1 bank_mask:0x1
    v_mfma_f32_16x16x32_bf16 v[202:205], v[108:111], v[166:169], v[202:205]
    v_add_f32_dpp v238, v237, v230 wave_ror:1 row_mask:0x1 bank_mask:0x1
    v_add_f32_dpp v234, v233, v232 wave_shr:1 row_mask:0xf bank_mask:0xf
    v_mfma_f32_16x16x32_bf16 v[202:205], v[112:115], v[170:173], v[202:205]
    s_nop 0
    v_add_f32_dpp v236, v234, v231 wave_shr:1 row_mask:0xf bank_mask:0xf
    v_mfma_f32_16x16x32_bf16 v[202:205], v[116:119], v[174:177], v[202:205]
    s_nop 0
    v_add_f32_dpp v238, v236, v230 wave_shr:1 row_mask:0xf bank_mask:0xf
    v_mfma_f32_16x16x32_bf16 v[202:205], v[120:123], v[178:181], v[202:205]
    ds_write_addtid_b32 v238 offset:26624
    v_mfma_f32_16x16x32_bf16 v[202:205], v[124:127], v[182:185], v[202:205]
    v_mfma_f32_16x16x32_bf16 v[202:205], v[128:131], v[186:189], v[202:205]
    v_mfma_f32_16x16x32_bf16 v[202:205], v[132:135], v[190:193], v[202:205]
    v_mfma_f32_16x16x32_bf16 v[206:209], v[78:81], v[138:141], 0
    v_mfma_f32_16x16x32_bf16 v[206:209], v[82:85], v[142:145], v[206:209]
    ds_read_b64_tr_b16 v[194:195], v253 offset:3584
    v_mfma_f32_16x16x32_bf16 v[206:209], v[86:89], v[146:149], v[206:209]
    ds_read_b64_tr_b16 v[196:197], v253 offset:3712
    v_mfma_f32_16x16x32_bf16 v[206:209], v[90:93], v[150:153], v[206:209]
    ds_read_b64_tr_b16 v[76:77], v251 offset:3840
    v_mfma_f32_16x16x32_bf16 v[206:209], v[94:97], v[154:157], v[206:209]
    v_add_f32_dpp v235, v233, v204 wave_ror:1 row_mask:0x1 bank_mask:0x1
    v_add_f32_dpp v237, v234, v203 wave_ror:1 row_mask:0x1 bank_mask:0x1
    v_mfma_f32_16x16x32_bf16 v[206:209], v[98:101], v[158:161], v[206:209]
    v_add_f32_dpp v239, v236, v202 wave_ror:1 row_mask:0x1 bank_mask:0x1
    v_add_f32_dpp v235, v205, v204 wave_shr:1 row_mask:0xf bank_mask:0xf
    v_mfma_f32_16x16x32_bf16 v[206:209], v[102:105], v[162:165], v[206:209]
    s_nop 0
    v_add_f32_dpp v237, v235, v203 wave_shr:1 row_mask:0xf bank_mask:0xf
    v_mfma_f32_16x16x32_bf16 v[206:209], v[106:109], v[166:169], v[206:209]
    s_nop 0
    v_add_f32_dpp v239, v237, v202 wave_shr:1 row_mask:0xf bank_mask:0xf
    v_mfma_f32_16x16x32_bf16 v[206:209], v[110:113], v[170:173], v[206:209]
    ds_write_addtid_b32 v239 offset:26880
    v_mfma_f32_16x16x32_bf16 v[206:209], v[114:117], v[174:177], v[206:209]
    v_mfma_f32_16x16x32_bf16 v[206:209], v[118:121], v[178:181], v[206:209]
    v_mfma_f32_16x16x32_bf16 v[206:209], v[122:125], v[182:185], v[206:209]
    v_mfma_f32_16x16x32_bf16 v[206:209], v[126:129], v[186:189], v[206:209]
    v_mfma_f32_16x16x32_bf16 v[206:209], v[130:133], v[190:193], v[206:209]
    s_waitcnt lgkmcnt(1)
    v_mfma_f32_16x16x32_bf16 v[206:209], v[134:137], v[194:197], v[206:209]
    v_mfma_f32_16x16x32_bf16 v[210:213], v[76:79], v[138:141], 0
    v_mfma_f32_16x16x32_bf16 v[210:213], v[80:83], v[142:145], v[210:213]
    v_mfma_f32_16x16x32_bf16 v[210:213], v[84:87], v[146:149], v[210:213]
    ds_read_b64_tr_b16 v[74:75], v251 offset:3968
    v_mfma_f32_16x16x32_bf16 v[210:213], v[88:91], v[150:153], v[210:213]
    v_mfma_f32_16x16x32_bf16 v[210:213], v[92:95], v[154:157], v[210:213]
    v_mfma_f32_16x16x32_bf16 v[210:213], v[96:99], v[158:161], v[210:213]
    s_nop 0
    v_add_f32_dpp v234, v205, v208 wave_ror:1 row_mask:0x1 bank_mask:0x1
    v_add_f32_dpp v236, v235, v207 wave_ror:1 row_mask:0x1 bank_mask:0x1
    v_mfma_f32_16x16x32_bf16 v[210:213], v[100:103], v[162:165], v[210:213]
    v_add_f32_dpp v238, v237, v206 wave_ror:1 row_mask:0x1 bank_mask:0x1
    v_add_f32_dpp v234, v209, v208 wave_shr:1 row_mask:0xf bank_mask:0xf
    v_mfma_f32_16x16x32_bf16 v[210:213], v[104:107], v[166:169], v[210:213]
    s_nop 0
    v_add_f32_dpp v236, v234, v207 wave_shr:1 row_mask:0xf bank_mask:0xf
    v_mfma_f32_16x16x32_bf16 v[210:213], v[108:111], v[170:173], v[210:213]
    s_nop 0
    v_add_f32_dpp v238, v236, v206 wave_shr:1 row_mask:0xf bank_mask:0xf
    v_mfma_f32_16x16x32_bf16 v[210:213], v[112:115], v[174:177], v[210:213]
    ds_write_addtid_b32 v238 offset:28672
    v_mfma_f32_16x16x32_bf16 v[210:213], v[116:119], v[178:181], v[210:213]
    v_mfma_f32_16x16x32_bf16 v[210:213], v[120:123], v[182:185], v[210:213]
    v_mfma_f32_16x16x32_bf16 v[210:213], v[124:127], v[186:189], v[210:213]
    v_mfma_f32_16x16x32_bf16 v[210:213], v[128:131], v[190:193], v[210:213]
    v_mfma_f32_16x16x32_bf16 v[210:213], v[132:135], v[194:197], v[210:213]
    s_waitcnt lgkmcnt(1)
    v_mfma_f32_16x16x32_bf16 v[214:217], v[74:77], v[138:141], 0
    v_mfma_f32_16x16x32_bf16 v[214:217], v[78:81], v[142:145], v[214:217]
    v_mfma_f32_16x16x32_bf16 v[214:217], v[82:85], v[146:149], v[214:217]
    ds_read_b64_tr_b16 v[198:199], v253 offset:3840
    v_mfma_f32_16x16x32_bf16 v[214:217], v[86:89], v[150:153], v[214:217]
    ds_read_b64_tr_b16 v[200:201], v253 offset:3968
    v_mfma_f32_16x16x32_bf16 v[214:217], v[90:93], v[154:157], v[214:217]
    ds_read_b64_tr_b16 v[72:73], v251 offset:4096
    v_add_f32_dpp v235, v209, v212 wave_ror:1 row_mask:0x1 bank_mask:0x1
    v_mfma_f32_16x16x32_bf16 v[214:217], v[94:97], v[158:161], v[214:217]
    v_add_f32_dpp v237, v234, v211 wave_ror:1 row_mask:0x1 bank_mask:0x1
    v_add_f32_dpp v239, v236, v210 wave_ror:1 row_mask:0x1 bank_mask:0x1
    v_mfma_f32_16x16x32_bf16 v[214:217], v[98:101], v[162:165], v[214:217]
    v_add_f32_dpp v235, v213, v212 wave_shr:1 row_mask:0xf bank_mask:0xf
    v_mfma_f32_16x16x32_bf16 v[214:217], v[102:105], v[166:169], v[214:217]
    s_nop 0
    v_add_f32_dpp v237, v235, v211 wave_shr:1 row_mask:0xf bank_mask:0xf
    v_mfma_f32_16x16x32_bf16 v[214:217], v[106:109], v[170:173], v[214:217]
    s_nop 0
    v_add_f32_dpp v239, v237, v210 wave_shr:1 row_mask:0xf bank_mask:0xf
    v_mfma_f32_16x16x32_bf16 v[214:217], v[110:113], v[174:177], v[214:217]
    ds_write_addtid_b32 v239 offset:28928
    v_mfma_f32_16x16x32_bf16 v[214:217], v[114:117], v[178:181], v[214:217]
    v_mfma_f32_16x16x32_bf16 v[214:217], v[118:121], v[182:185], v[214:217]
    v_mfma_f32_16x16x32_bf16 v[214:217], v[122:125], v[186:189], v[214:217]
    v_mfma_f32_16x16x32_bf16 v[214:217], v[126:129], v[190:193], v[214:217]
    v_mfma_f32_16x16x32_bf16 v[214:217], v[130:133], v[194:197], v[214:217]
    s_waitcnt lgkmcnt(1)
    v_mfma_f32_16x16x32_bf16 v[214:217], v[134:137], v[198:201], v[214:217]
    v_mfma_f32_16x16x32_bf16 v[218:221], v[72:75], v[138:141], 0
    v_mfma_f32_16x16x32_bf16 v[218:221], v[76:79], v[142:145], v[218:221]
    v_mfma_f32_16x16x32_bf16 v[218:221], v[80:83], v[146:149], v[218:221]
    v_mfma_f32_16x16x32_bf16 v[218:221], v[84:87], v[150:153], v[218:221]
    v_mfma_f32_16x16x32_bf16 v[218:221], v[88:91], v[154:157], v[218:221]
    v_mfma_f32_16x16x32_bf16 v[218:221], v[92:95], v[158:161], v[218:221]
    v_mfma_f32_16x16x32_bf16 v[218:221], v[96:99], v[162:165], v[218:221]
    s_nop 0
    v_add_f32_dpp v234, v213, v216 wave_ror:1 row_mask:0x1 bank_mask:0x1
    v_add_f32_dpp v236, v235, v215 wave_ror:1 row_mask:0x1 bank_mask:0x1
    v_mfma_f32_16x16x32_bf16 v[218:221], v[100:103], v[166:169], v[218:221]
    v_add_f32_dpp v238, v237, v214 wave_ror:1 row_mask:0x1 bank_mask:0x1
    v_add_f32_dpp v234, v217, v216 wave_shr:1 row_mask:0xf bank_mask:0xf
    v_mfma_f32_16x16x32_bf16 v[218:221], v[104:107], v[170:173], v[218:221]
    s_nop 0
    v_add_f32_dpp v236, v234, v215 wave_shr:1 row_mask:0xf bank_mask:0xf
    v_mfma_f32_16x16x32_bf16 v[218:221], v[108:111], v[174:177], v[218:221]
    s_nop 0
    v_add_f32_dpp v238, v236, v214 wave_shr:1 row_mask:0xf bank_mask:0xf
    v_mfma_f32_16x16x32_bf16 v[218:221], v[112:115], v[178:181], v[218:221]
    ds_write_addtid_b32 v238 offset:30720
    v_mfma_f32_16x16x32_bf16 v[218:221], v[116:119], v[182:185], v[218:221]
    v_mfma_f32_16x16x32_bf16 v[218:221], v[120:123], v[186:189], v[218:221]
    v_mfma_f32_16x16x32_bf16 v[218:221], v[124:127], v[190:193], v[218:221]
    v_mfma_f32_16x16x32_bf16 v[218:221], v[128:131], v[194:197], v[218:221]
    v_mfma_f32_16x16x32_bf16 v[218:221], v[132:135], v[198:201], v[218:221]
    s_nop 7
    v_add_f32_dpp v235, v217, v220 wave_ror:1 row_mask:0x1 bank_mask:0x1
    v_add_f32_dpp v237, v234, v219 wave_ror:1 row_mask:0x1 bank_mask:0x1
    v_add_f32_dpp v239, v236, v218 wave_ror:1 row_mask:0x1 bank_mask:0x1
    v_add_f32_dpp v235, v221, v220 wave_shr:1 row_mask:0xf bank_mask:0xf
    s_nop 1
    v_add_f32_dpp v237, v235, v219 wave_shr:1 row_mask:0xf bank_mask:0xf
    s_nop 1
    v_add_f32_dpp v239, v237, v218 wave_shr:1 row_mask:0xf bank_mask:0xf
    ds_write_addtid_b32 v239 offset:30976
    s_endpgm
.p2align 12
L_padt1:
    s_cbranch_execz L_rett
L_tail1:
    v_mfma_f32_16x16x32_bf16 v[230:233], v[104:107], v[154:157], v[230:233]
    ds_read_b64_tr_b16 v[190:191], v1 offset:1024
    v_add_f32_dpp v234, v225, v228 wave_ror:1 row_mask:0x1 bank_mask:0x1
    v_mfma_f32_16x16x32_bf16 v[230:233], v[108:111], v[158:161], v[230:233]
    ds_read_b64_tr_b16 v[192:193], v1 offset:1536
    v_add_f32_dpp v236, v235, v227 wave_ror:1 row_mask:0x1 bank_mask:0x1
    v_mfma_f32_16x16x32_bf16 v[230:233], v[112:115], v[162:165], v[230:233]
    ds_read_b64_tr_b16 v[194:195], v1 offset:2048
    v_add_f32_dpp v238, v237, v226 wave_ror:1 row_mask:0x1 bank_mask:0x1
    v_mfma_f32_16x16x32_bf16 v[230:233], v[116:119], v[166:169], v[230:233]
    ds_read_b64_tr_b16 v[196:197], v1 offset:2560
    v_add_f32_dpp v234, v229, v228 wave_shr:1 row_mask:0xf bank_mask:0xf
    v_mfma_f32_16x16x32_bf16 v[230:233], v[120:123], v[170:173], v[230:233]
    ds_read_b64_tr_b16 v[198:199], v1 offset:3072
    v_add_f32_dpp v236, v234, v227 wave_shr:1 row_mask:0xf bank_mask:0xf
    v_mfma_f32_16x16x32_bf16 v[230:233], v[124:127], v[174:177], v[230:233]
    ds_read_b64_tr_b16 v[200:201], v1 offset:3584
    v_add_f32_dpp v238, v236, v226 wave_shr:1 row_mask:0xf bank_mask:0xf
    v_mfma_f32_16x16x32_bf16 v[230:233], v[128:131], v[178:181], v[230:233]
    ds_write_addtid_b32 v238 offset:22528
    v_mfma_f32_16x16x32_bf16 v[230:233], v[132:135], v[182:185], v[230:233]
    s_waitcnt lgkmcnt(6)
    v_mfma_f32_16x16x32_bf16 v[202:205], v[4:7], v[186:189], 0
    v_mfma_f32_16x16x32_bf16 v[206:209], v[2:5], v[186:189], 0
    v_mfma_f32_16x16x32_bf16 v[210:213], v[16:19], v[186:189], 0
    v_mfma_f32_16x16x32_bf16 v[214:217], v[14:17], v[186:189], 0
    s_waitcnt lgkmcnt(2)
    ds_read_b64_tr_b16 v[186:187], v1 offset:4096
    v_mfma_f32_16x16x32_bf16 v[202:205], v[8:11], v[190:193], v[202:205]
    v_add_f32_dpp v235, v229, v232 wave_ror:1 row_mask:0x1 bank_mask:0x1
    v_add_f32_dpp v237, v234, v231 wave_ror:1 row_mask:0x1 bank_mask:0x1
    v_mfma_f32_16x16x32_bf16 v[206:209], v[6:9], v[190:193], v[206:209]
    ds_read_b64_tr_b16 v[188:189], v1 offset:4608
    v_add_f32_dpp v239, v236, v230 wave_ror:1 row_mask:0x1 bank_mask:0x1
    v_mfma_f32_16x16x32_bf16 v[210:213], v[20:23], v[190:193], v[210:213]
    v_add_f32_dpp v235, v233, v232 wave_shr:1 row_mask:0xf bank_mask:0xf
    v_mfma_f32_16x16x32_bf16 v[214:217], v[18:21], v[190:193], v[214:217]
    ds_read_b64_tr_b16 v[190:191], v1 offset:5120
    v_add_f32_dpp v237, v235, v231 wave_shr:1 row_mask:0xf bank_mask:0xf
    v_mfma_f32_16x16x32_bf16 v[206:209], v[10:13], v[194:197], v[206:209]
    s_nop 0
    v_add_f32_dpp v239, v237, v230 wave_shr:1 row_mask:0xf bank_mask:0xf
    v_add_f32_dpp v240, v205, v204 wave_shr:1 row_mask:0xf bank_mask:0xf bound_ctrl:0
    v_mfma_f32_16x16x32_bf16 v[210:213], v[24:27], v[194:197], v[210:213]
    ds_read_b64_tr_b16 v[192:193], v1 offset:5632
    v_add_f32_dpp v242, v240, v203 wave_shr:1 row_mask:0xf bank_mask:0xf bound_ctrl:0
    v_mfma_f32_16x16x32_bf16 v[214:217], v[22:25], v[194:197], v[214:217]
    s_waitcnt lgkmcnt(3)
    ds_write_addtid_b32 v239 offset:22784
    v_mfma_f32_16x16x32_bf16 v[210:213], v[28:31], v[198:201], v[210:213]
    ds_read_b64_tr_b16 v[194:195], v1 offset:6144
    ds_read_b64_tr_b16 v[196:197], v1 offset:6656
    v_mfma_f32_16x16x32_bf16 v[214:217], v[26:29], v[198:201], v[214:217]
    s_waitcnt lgkmcnt(5)
    v_add_f32_dpp v244, v242, v202 wave_shr:1 row_mask:0xf bank_mask:0xf bound_ctrl:0
    v_add_f32_dpp v241, v205, v208 wave_ror:1 row_mask:0x1 bank_mask:0x1
    v_mfma_f32_16x16x32_bf16 v[210:213], v[32:35], v[186:189], v[210:213]
    ds_read_b64_tr_b16 v[198:199], v1 offset:7168
    ds_read_b64_tr_b16 v[200:201], v1 offset:7680
    v_mfma_f32_16x16x32_bf16 v[214:217], v[30:33], v[186:189], v[214:217]
    s_waitcnt lgkmcnt(5)
    ds_write_addtid_b32 v244 offset:32768
    v_mfma_f32_16x16x32_bf16 v[210:213], v[36:39], v[190:193], v[210:213]
    ds_read_b64_tr_b16 v[186:187], v1 offset:8192
    ds_read_b64_tr_b16 v[188:189], v1 offset:8704
    v_mfma_f32_16x16x32_bf16 v[214:217], v[34:37], v[190:193], v[214:217]
    s_waitcnt lgkmcnt(5)
    v_add_f32_dpp v243, v240, v207 wave_ror:1 row_mask:0x1 bank_mask:0x1
    v_add_f32_dpp v245, v242, v206 wave_ror:1 row_mask:0x1 bank_mask:0x1
    v_mfma_f32_16x16x32_bf16 v[210:213], v[40:43], v[194:197], v[210:213]
    ds_read_b64_tr_b16 v[190:191], v1 offset:9216
    ds_read_b64_tr_b16 v[192:193], v1 offset:9728
    v_mfma_f32_16x16x32_bf16 v[214:217], v[38:41], v[194:197], v[214:217]
    s_waitcnt lgkmcnt(5)
    v_add_f32_dpp v241, v209, v208 wave_shr:1 row_mask:0xf bank_mask:0xf
    v_mfma_f32_16x16x32_bf16 v[210:213], v[44:47], v[198:201], v[210:213]
    ds_read_b64_tr_b16 v[194:195], v1 offset:10240
    ds_read_b64_tr_b16 v[196:197], v1 offset:10752
    v_mfma_f32_16x16x32_bf16 v[214:217], v[42:45], v[198:201], v[214:217]
    s_waitcnt lgkmcnt(4)
    v_add_f32_dpp v243, v241, v207 wave_shr:1 row_mask:0xf bank_mask:0xf
    v_mfma_f32_16x16x32_bf16 v[210:213], v[48:51], v[186:189], v[210:213]
    ds_read_b64_tr_b16 v[198:199], v1 offset:11264
    ds_read_b64_tr_b16 v[200:201], v1 offset:11776
    v_mfma_f32_16x16x32_bf16 v[214:217], v[46:49], v[186:189], v[214:217]
    s_waitcnt lgkmcnt(4)
    v_add_f32_dpp v245, v243, v206 wave_shr:1 row_mask:0xf bank_mask:0xf
    v_mfma_f32_16x16x32_bf16 v[210:213], v[52:55], v[190:193], v[210:213]
    ds_read_b64_tr_b16 v[186:187], v1 offset:12288
    ds_read_b64_tr_b16 v[188:189], v1 offset:12800
    v_mfma_f32_16x16x32_bf16 v[214:217], v[50:53], v[190:193], v[214:217]
    s_waitcnt lgkmcnt(4)
    ds_write_addtid_b32 v245 offset:33024
    v_mfma_f32_16x16x32_bf16 v[210:213], v[56:59], v[194:197], v[210:213]
    ds_read_b64_tr_b16 v[190:191], v1 offset:13312
    ds_read_b64_tr_b16 v[192:193], v1 offset:13824
    v_mfma_f32_16x16x32_bf16 v[214:217], v[54:57], v[194:197], v[214:217]
    s_waitcnt lgkmcnt(5)
    v_mfma_f32_16x16x32_bf16 v[210:213], v[60:63], v[198:201], v[210:213]
    ds_read_b64_tr_b16 v[194:195], v1 offset:14336
    ds_read_b64_tr_b16 v[196:197], v1 offset:14848
    v_mfma_f32_16x16x32_bf16 v[214:217], v[58:61], v[198:201], v[214:217]
    s_waitcnt lgkmcnt(5)
    v_mfma_f32_16x16x32_bf16 v[210:213], v[64:67], v[186:189], v[210:213]
    ds_read_b64_tr_b16 v[198:199], v1 offset:15360
    ds_read_b64_tr_b16 v[200:201], v1 offset:15872
    v_mfma_f32_16x16x32_bf16 v[214:217], v[62:65], v[186:189], v[214:217]
    s_waitcnt lgkmcnt(4)
    v_mfma_f32_16x16x32_bf16 v[210:213], v[68:71], v[190:193], v[210:213]
    v_mfma_f32_16x16x32_bf16 v[214:217], v[66:69], v[190:193], v[214:217]
    s_waitcnt lgkmcnt(2)
    v_mfma_f32_16x16x32_bf16 v[210:213], v[72:75], v[194:197], v[210:213]
    v_mfma_f32_16x16x32_bf16 v[214:217], v[70:73], v[194:197], v[214:217]
    s_waitcnt lgkmcnt(0)
    v_mfma_f32_16x16x32_bf16 v[214:217], v[74:77], v[198:201], v[214:217]
    ds_read_b64_tr_b16 v[186:187], v253 offset:3072
    v_mfma_f32_16x16x32_bf16 v[218:221], v[86:89], v[138:141], 0
    ds_read_b64_tr_b16 v[188:189], v253 offset:3200
    v_mfma_f32_16x16x32_bf16 v[218:221], v[90:93], v[142:145], v[218:221]
    s_nop 0
    v_add_f32_dpp v240, v213, v212 wave_shr:1 row_mask:0xf bank_mask:0xf bound_ctrl:0
    v_mfma_f32_16x16x32_bf16 v[218:221], v[94:97], v[146:149], v[218:221]
    s_nop 0
    v_add_f32_dpp v242, v240, v211 wave_shr:1 row_mask:0xf bank_mask:0xf bound_ctrl:0
    v_add_f32_dpp v241, v213, v216 wave_ror:1 row_mask:0x1 bank_mask:0x1
    v_mfma_f32_16x16x32_bf16 v[218:221], v[98:101], v[150:153], v[218:221]
    v_add_f32_dpp v244, v242, v210 wave_shr:1 row_mask:0xf bank_mask:0xf bound_ctrl:0
    v_add_f32_dpp v243, v240, v215 wave_ror:1 row_mask:0x1 bank_mask:0x1
    v_mfma_f32_16x16x32_bf16 v[218:221], v[102:105], v[154:157], v[218:221]
    ds_write_addtid_b32 v244 offset:34816
    v_add_f32_dpp v245, v242, v214 wave_ror:1 row_mask:0x1 bank_mask:0x1
    v_mfma_f32_16x16x32_bf16 v[218:221], v[106:109], v[158:161], v[218:221]
    v_add_f32_dpp v241, v217, v216 wave_shr:1 row_mask:0xf bank_mask:0xf
    v_mfma_f32_16x16x32_bf16 v[218:221], v[110:113], v[162:165], v[218:221]
    s_nop 0
    v_add_f32_dpp v243, v241, v215 wave_shr:1 row_mask:0xf bank_mask:0xf
    v_mfma_f32_16x16x32_bf16 v[218:221], v[114:117], v[166:169], v[218:221]
    s_nop 0
    v_add_f32_dpp v245, v243, v214 wave_shr:1 row_mask:0xf bank_mask:0xf
    v_mfma_f32_16x16x32_bf16 v[218:221], v[118:121], v[170:173], v[218:221]
    ds_write_addtid_b32 v245 offset:35072
    v_mfma_f32_16x16x32_bf16 v[218:221], v[122:125], v[174:177], v[218:221]
    v_mfma_f32_16x16x32_bf16 v[218:221], v[126:129], v[178:181], v[218:221]
    v_mfma_f32_16x16x32_bf16 v[218:221], v[130:133], v[182:185], v[218:221]
    s_waitcnt lgkmcnt(1)
    v_mfma_f32_16x16x32_bf16 v[218:221], v[134:137], v[186:189], v[218:221]
    v_mfma_f32_16x16x32_bf16 v[222:225], v[84:87], v[138:141], 0
    v_mfma_f32_16x16x32_bf16 v[222:225], v[88:91], v[142:145], v[222:225]
    v_mfma_f32_16x16x32_bf16 v[222:225], v[92:95], v[146:149], v[222:225]
    v_mfma_f32_16x16x32_bf16 v[222:225], v[96:99], v[150:153], v[222:225]
    v_mfma_f32_16x16x32_bf16 v[222:225], v[100:103], v[154:157], v[222:225]
    v_mfma_f32_16x16x32_bf16 v[222:225], v[104:107], v[158:161], v[222:225]
    v_mfma_f32_16x16x32_bf16 v[222:225], v[108:111], v[162:165], v[222:225]
    s_nop 0
    v_add_f32_dpp v234, v233, v220 wave_ror:1 row_mask:0x1 bank_mask:0x1
    v_add_f32_dpp v236, v235, v219 wave_ror:1 row_mask:0x1 bank_mask:0x1
    v_mfma_f32_16x16x32_bf16 v[222:225], v[112:115], v[166:169], v[222:225]
    v_add_f32_dpp v238, v237, v218 wave_ror:1 row_mask:0x1 bank_mask:0x1
    v_add_f32_dpp v234, v221, v220 wave_shr:1 row_mask:0xf bank_mask:0xf
    v_mfma_f32_16x16x32_bf16 v[222:225], v[116:119], v[170:173], v[222:225]
    s_nop 0
    v_add_f32_dpp v236, v234, v219 wave_shr:1 row_mask:0xf bank_mask:0xf
    v_mfma_f32_16x16x32_bf16 v[222:225], v[120:123], v[174:177], v[222:225]
    s_nop 0
    v_add_f32_dpp v238, v236, v218 wave_shr:1 row_mask:0xf bank_mask:0xf
    v_mfma_f32_16x16x32_bf16 v[222:225], v[124:127], v[178:181], v[222:225]
    ds_write_addtid_b32 v238 offset:24576
    v_mfma_f32_16x16x32_bf16 v[222:225], v[128:131], v[182:185], v[222:225]
    v_mfma_f32_16x16x32_bf16 v[222:225], v[132:135], v[186:189], v[222:225]
    v_mfma_f32_16x16x32_bf16 v[226:229], v[82:85], v[138:141], 0
    ds_read_b64_tr_b16 v[190:191], v253 offset:3328
    v_mfma_f32_16x16x32_bf16 v[226:229], v[86:89], v[142:145], v[226:229]
    ds_read_b64_tr_b16 v[192:193], v253 offset:3456
    v_mfma_f32_16x16x32_bf16 v[226:229], v[90:93], v[146:149], v[226:229]
    v_mfma_f32_16x16x32_bf16 v[226:229], v[94:97], v[150:153], v[226:229]
    v_mfma_f32_16x16x32_bf16 v[226:229], v[98:101], v[154:157], v[226:229]
    s_nop 0
    v_add_f32_dpp v235, v221, v224 wave_ror:1 row_mask:0x1 bank_mask:0x1
    v_add_f32_dpp v237, v234, v223 wave_ror:1 row_mask:0x1 bank_mask:0x1
    v_mfma_f32_16x16x32_bf16 v[226:229], v[102:105], v[158:161], v[226:229]
    v_add_f32_dpp v239, v236, v222 wave_ror:1 row_mask:0x1 bank_mask:0x1
    v_add_f32_dpp v235, v225, v224 wave_shr:1 row_mask:0xf bank_mask:0xf
    v_mfma_f32_16x16x32_bf16 v[226:229], v[106:109], v[162:165], v[226:229]
    s_nop 0
    v_add_f32_dpp v237, v235, v223 wave_shr:1 row_mask:0xf bank_mask:0xf
    v_mfma_f32_16x16x32_bf16 v[226:229], v[110:113], v[166:169], v[226:229]
    s_nop 0
    v_add_f32_dpp v239, v237, v222 wave_shr:1 row_mask:0xf bank_mask:0xf
    v_mfma_f32_16x16x32_bf16 v[226:229], v[114:117], v[170:173], v[226:229]
    ds_write_addtid_b32 v239 offset:24832
    v_mfma_f32_16x16x32_bf16 v[226:229], v[118:121], v[174:177], v[226:229]
    v_mfma_f32_16x16x32_bf16 v[226:229], v[122:125], v[178:181], v[226:229]
    v_mfma_f32_16x16x32_bf16 v[226:229], v[126:129], v[182:185], v[226:229]
    v_mfma_f32_16x16x32_bf16 v[226:229], v[130:133], v[186:189], v[226:229]
    s_waitcnt lgkmcnt(1)
    v_mfma_f32_16x16x32_bf16 v[226:229], v[134:137], v[190:193], v[226:229]
    v_mfma_f32_16x16x32_bf16 v[230:233], v[80:83], v[138:141], 0
    v_mfma_f32_16x16x32_bf16 v[230:233], v[84:87], v[142:145], v[230:233]
    v_mfma_f32_16x16x32_bf16 v[230:233], v[88:91], v[146:149], v[230:233]
    v_mfma_f32_16x16x32_bf16 v[230:233], v[92:95], v[150:153], v[230:233]
    v_mfma_f32_16x16x32_bf16 v[230:233], v[96:99], v[154:157], v[230:233]
    v_mfma_f32_16x16x32_bf16 v[230:233], v[100:103], v[158:161], v[230:233]
    v_mfma_f32_16x16x32_bf16 v[230:233], v[104:107], v[162:165], v[230:233]
    s_nop 0
    v_add_f32_dpp v234, v225, v228 wave_ror:1 row_mask:0x1 bank_mask:0x1
    v_add_f32_dpp v236, v235, v227 wave_ror:1 row_mask:0x1 bank_mask:0x1
    v_mfma_f32_16x16x32_bf16 v[230:233], v[108:111], v[166:169], v[230:233]
    v_add_f32_dpp v238, v237, v226 wave_ror:1 row_mask:0x1 bank_mask:0x1
    v_add_f32_dpp v234, v229, v228 wave_shr:1 row_mask:0xf bank_mask:0xf
    v_mfma_f32_16x16x32_bf16 v[230:233], v[112:115], v[170:173], v[230:233]
    s_nop 0
    v_add_f32_dpp v236, v234, v227 wave_shr:1 row_mask:0xf bank_mask:0xf
    v_mfma_f32_16x16x32_bf16 v[230:233], v[116:119], v[174:177], v[230:233]
    s_nop 0
    v_add_f32_dpp v238, v236, v226 wave_shr:1 row_mask:0xf bank_mask:0xf
    v_mfma_f32_16x16x32_bf16 v[230:233], v[120:123], v[178:181], v[230:233]
    ds_write_addtid_b32 v238 offset:26624
    v_mfma_f32_16x16x32_bf16 v[230:233], v[124:127], v[182:185], v[230:233]
    v_mfma_f32_16x16x32_bf16 v[230:233], v[128:131], v[186:189], v[230:233]
    v_mfma_f32_16x16x32_bf16 v[230:233], v[132:135], v[190:193], v[230:233]
    v_mfma_f32_16x16x32_bf16 v[202:205], v[78:81], v[138:141], 0
    v_mfma_f32_16x16x32_bf16 v[202:205], v[82:85], v[142:145], v[202:205]
    ds_read_b64_tr_b16 v[194:195], v253 offset:3584
    v_mfma_f32_16x16x32_bf16 v[202:205], v[86:89], v[146:149], v[202:205]
    ds_read_b64_tr_b16 v[196:197], v253 offset:3712
    v_mfma_f32_16x16x32_bf16 v[202:205], v[90:93], v[150:153], v[202:205]
    ds_read_b64_tr_b16 v[76:77], v251 offset:3840
    v_mfma_f32_16x16x32_bf16 v[202:205], v[94:97], v[154:157], v[202:205]
    v_add_f32_dpp v235, v229, v232 wave_ror:1 row_mask:0x1 bank_mask:0x1
    v_add_f32_dpp v237, v234, v231 wave_ror:1 row_mask:0x1 bank_mask:0x1
    v_mfma_f32_16x16x32_bf16 v[202:205], v[98:101], v[158:161], v[202:205]
    v_add_f32_dpp v239, v236, v230 wave_ror:1 row_mask:0x1 bank_mask:0x1
    v_add_f32_dpp v235, v233, v232 wave_shr:1 row_mask:0xf bank_mask:0xf
    v_mfma_f32_16x16x32_bf16 v[202:205], v[102:105], v[162:165], v[202:205]
    s_nop 0
    v_add_f32_dpp v237, v235, v231 wave_shr:1 row_mask:0xf bank_mask:0xf
    v_mfma_f32_16x16x32_bf16 v[202:205], v[106:109], v[166:169], v[202:205]
    s_nop 0
    v_add_f32_dpp v239, v237, v230 wave_shr:1 row_mask:0xf bank_mask:0xf
    v_mfma_f32_16x16x32_bf16 v[202:205], v[110:113], v[170:173], v[202:205]
    ds_write_addtid_b32 v239 offset:26880
    v_mfma_f32_16x16x32_bf16 v[202:205], v[114:117], v[174:177], v[202:205]
    v_mfma_f32_16x16x32_bf16 v[202:205], v[118:121], v[178:181], v[202:205]
    v_mfma_f32_16x16x32_bf16 v[202:205], v[122:125], v[182:185], v[202:205]
    v_mfma_f32_16x16x32_bf16 v[202:205], v[126:129], v[186:189], v[202:205]
    v_mfma_f32_16x16x32_bf16 v[202:205], v[130:133], v[190:193], v[202:205]
    s_waitcnt lgkmcnt(1)
    v_mfma_f32_16x16x32_bf16 v[202:205], v[134:137], v[194:197], v[202:205]
    v_mfma_f32_16x16x32_bf16 v[206:209], v[76:79], v[138:141], 0
    v_mfma_f32_16x16x32_bf16 v[206:209], v[80:83], v[142:145], v[206:209]
    v_mfma_f32_16x16x32_bf16 v[206:209], v[84:87], v[146:149], v[206:209]
    ds_read_b64_tr_b16 v[74:75], v251 offset:3968
    v_mfma_f32_16x16x32_bf16 v[206:209], v[88:91], v[150:153], v[206:209]
    v_mfma_f32_16x16x32_bf16 v[206:209], v[92:95], v[154:157], v[206:209]
    v_mfma_f32_16x16x32_bf16 v[206:209], v[96:99], v[158:161], v[206:209]
    s_nop 0
    v_add_f32_dpp v234, v233, v204 wave_ror:1 row_mask:0x1 bank_mask:0x1
    v_add_f32_dpp v236, v235, v203 wave_ror:1 row_mask:0x1 bank_mask:0x1
    v_mfma_f32_16x16x32_bf16 v[206:209], v[100:103], v[162:165], v[206:209]
    v_add_f32_dpp v238, v237, v202 wave_ror:1 row_mask:0x1 bank_mask:0x1
    v_add_f32_dpp v234, v205, v204 wave_shr:1 row_mask:0xf bank_mask:0xf
    v_mfma_f32_16x16x32_bf16 v[206:209], v[104:107], v[166:169], v[206:209]
    s_nop 0
    v_add_f32_dpp v236, v234, v203 wave_shr:1 row_mask:0xf bank_mask:0xf
    v_mfma_f32_16x16x32_bf16 v[206:209], v[108:111], v[170:173], v[206:209]
    s_nop 0
    v_add_f32_dpp v238, v236, v202 wave_shr:1 row_mask:0xf bank_mask:0xf
    v_mfma_f32_16x16x32_bf16 v[206:209], v[112:115], v[174:177], v[206:209]
    ds_write_addtid_b32 v238 offset:28672
    v_mfma_f32_16x16x32_bf16 v[206:209], v[116:119], v[178:181], v[206:209]
    v_mfma_f32_16x16x32_bf16 v[206:209], v[120:123], v[182:185], v[206:209]
    v_mfma_f32_16x16x32_bf16 v[206:209], v[124:127], v[186:189], v[206:209]
    v_mfma_f32_16x16x32_bf16 v[206:209], v[128:131], v[190:193], v[206:209]
    v_mfma_f32_16x16x32_bf16 v[206:209], v[132:135], v[194:197], v[206:209]
    s_waitcnt lgkmcnt(1)
    v_mfma_f32_16x16x32_bf16 v[210:213], v[74:77], v[138:141], 0
    v_mfma_f32_16x16x32_bf16 v[210:213], v[78:81], v[142:145], v[210:213]
    v_mfma_f32_16x16x32_bf16 v[210:213], v[82:85], v[146:149], v[210:213]
    ds_read_b64_tr_b16 v[198:199], v253 offset:3840
    v_mfma_f32_16x16x32_bf16 v[210:213], v[86:89], v[150:153], v[210:213]
    ds_read_b64_tr_b16 v[200:201], v253 offset:3968
    v_mfma_f32_16x16x32_bf16 v[210:213], v[90:93], v[154:157], v[210:213]
    ds_read_b64_tr_b16 v[72:73], v251 offset:4096
    v_add_f32_dpp v235, v205, v208 wave_ror:1 row_mask:0x1 bank_mask:0x1
    v_mfma_f32_16x16x32_bf16 v[210:213], v[94:97], v[158:161], v[210:213]
    v_add_f32_dpp v237, v234, v207 wave_ror:1 row_mask:0x1 bank_mask:0x1
    v_add_f32_dpp v239, v236, v206 wave_ror:1 row_mask:0x1 bank_mask:0x1
    v_mfma_f32_16x16x32_bf16 v[210:213], v[98:101], v[162:165], v[210:213]
    v_add_f32_dpp v235, v209, v208 wave_shr:1 row_mask:0xf bank_mask:0xf
    v_mfma_f32_16x16x32_bf16 v[210:213], v[102:105], v[166:169], v[210:213]
    s_nop 0
    v_add_f32_dpp v237, v235, v207 wave_shr:1 row_mask:0xf bank_mask:0xf
    v_mfma_f32_16x16x32_bf16 v[210:213], v[106:109], v[170:173], v[210:213]
    s_nop 0
    v_add_f32_dpp v239, v237, v206 wave_shr:1 row_mask:0xf bank_mask:0xf
    v_mfma_f32_16x16x32_bf16 v[210:213], v[110:113], v[174:177], v[210:213]
    ds_write_addtid_b32 v239 offset:28928
    v_mfma_f32_16x16x32_bf16 v[210:213], v[114:117], v[178:181], v[210:213]
    v_mfma_f32_16x16x32_bf16 v[210:213], v[118:121], v[182:185], v[210:213]
    v_mfma_f32_16x16x32_bf16 v[210:213], v[122:125], v[186:189], v[210:213]
    v_mfma_f32_16x16x32_bf16 v[210:213], v[126:129], v[190:193], v[210:213]
    v_mfma_f32_16x16x32_bf16 v[210:213], v[130:133], v[194:197], v[210:213]
    s_waitcnt lgkmcnt(1)
    v_mfma_f32_16x16x32_bf16 v[210:213], v[134:137], v[198:201], v[210:213]
    v_mfma_f32_16x16x32_bf16 v[214:217], v[72:75], v[138:141], 0
    v_mfma_f32_16x16x32_bf16 v[214:217], v[76:79], v[142:145], v[214:217]
    v_mfma_f32_16x16x32_bf16 v[214:217], v[80:83], v[146:149], v[214:217]
    v_mfma_f32_16x16x32_bf16 v[214:217], v[84:87], v[150:153], v[214:217]
    v_mfma_f32_16x16x32_bf16 v[214:217], v[88:91], v[154:157], v[214:217]
    v_mfma_f32_16x16x32_bf16 v[214:217], v[92:95], v[158:161], v[214:217]
    v_mfma_f32_16x16x32_bf16 v[214:217], v[96:99], v[162:165], v[214:217]
    s_nop 0
    v_add_f32_dpp v234, v209, v212 wave_ror:1 row_mask:0x1 bank_mask:0x1
    v_add_f32_dpp v236, v235, v211 wave_ror:1 row_mask:0x1 bank_mask:0x1
    v_mfma_f32_16x16x32_bf16 v[214:217], v[100:103], v[166:169], v[214:217]
    v_add_f32_dpp v238, v237, v210 wave_ror:1 row_mask:0x1 bank_mask:0x1
    v_add_f32_dpp v234, v213, v212 wave_shr:1 row_mask:0xf bank_mask:0xf
    v_mfma_f32_16x16x32_bf16 v[214:217], v[104:107], v[170:173], v[214:217]
    s_nop 0
    v_add_f32_dpp v236, v234, v211 wave_shr:1 row_mask:0xf bank_mask:0xf
    v_mfma_f32_16x16x32_bf16 v[214:217], v[108:111], v[174:177], v[214:217]
    s_nop 0
    v_add_f32_dpp v238, v236, v210 wave_shr:1 row_mask:0xf bank_mask:0xf
    v_mfma_f32_16x16x32_bf16 v[214:217], v[112:115], v[178:181], v[214:217]
    ds_write_addtid_b32 v238 offset:30720
    v_mfma_f32_16x16x32_bf16 v[214:217], v[116:119], v[182:185], v[214:217]
    v_mfma_f32_16x16x32_bf16 v[214:217], v[120:123], v[186:189], v[214:217]
    v_mfma_f32_16x16x32_bf16 v[214:217], v[124:127], v[190:193], v[214:217]
    v_mfma_f32_16x16x32_bf16 v[214:217], v[128:131], v[194:197], v[214:217]
    v_mfma_f32_16x16x32_bf16 v[214:217], v[132:135], v[198:201], v[214:217]
    s_nop 7
    v_add_f32_dpp v235, v213, v216 wave_ror:1 row_mask:0x1 bank_mask:0x1
    v_add_f32_dpp v237, v234, v215 wave_ror:1 row_mask:0x1 bank_mask:0x1
    v_add_f32_dpp v239, v236, v214 wave_ror:1 row_mask:0x1 bank_mask:0x1
    v_add_f32_dpp v235, v217, v216 wave_shr:1 row_mask:0xf bank_mask:0xf
    s_nop 1
    v_add_f32_dpp v237, v235, v215 wave_shr:1 row_mask:0xf bank_mask:0xf
    s_nop 1
    v_add_f32_dpp v239, v237, v214 wave_shr:1 row_mask:0xf bank_mask:0xf
    ds_write_addtid_b32 v239 offset:30976
    s_endpgm
.p2align 12
L_padt2:
    s_cbranch_execz L_rett
L_tail2:
    v_mfma_f32_16x16x32_bf16 v[230:233], v[108:111], v[158:161], v[230:233]
    ds_read_b64_tr_b16 v[190:191], v1 offset:1024
    v_add_f32_dpp v236, v235, v227 wave_ror:1 row_mask:0x1 bank_mask:0x1
    v_mfma_f32_16x16x32_bf16 v[230:233], v[112:115], v[162:165], v[230:233]
    ds_read_b64_tr_b16 v[192:193], v1 offset:1536
    v_add_f32_dpp v238, v237, v226 wave_ror:1 row_mask:0x1 bank_mask:0x1
    v_mfma_f32_16x16x32_bf16 v[230:233], v[116:119], v[166:169], v[230:233]
    ds_read_b64_tr_b16 v[194:195], v1 offset:2048
    v_add_f32_dpp v234, v229, v228 wave_shr:1 row_mask:0xf bank_mask:0xf
    v_mfma_f32_16x16x32_bf16 v[230:233], v[120:123], v[170:173], v[230:233]
    ds_read_b64_tr_b16 v[196:197], v1 offset:2560
    v_add_f32_dpp v236, v234, v227 wave_shr:1 row_mask:0xf bank_mask:0xf
    v_mfma_f32_16x16x32_bf16 v[230:233], v[124:127], v[174:177], v[230:233]
    ds_read_b64_tr_b16 v[198:199], v1 offset:3072
    v_add_f32_dpp v238, v236, v226 wave_shr:1 row_mask:0xf bank_mask:0xf
    v_mfma_f32_16x16x32_bf16 v[230:233], v[128:131], v[178:181], v[230:233]
    ds_read_b64_tr_b16 v[200:201], v1 offset:3584
    ds_write_addtid_b32 v238 offset:22528
    v_mfma_f32_16x16x32_bf16 v[230:233], v[132:135], v[182:185], v[230:233]
    s_waitcnt lgkmcnt(7)
    v_mfma_f32_16x16x32_bf16 v[202:205], v[4:7], v[186:189], 0
    v_mfma_f32_16x16x32_bf16 v[206:209], v[2:5], v[186:189], 0
    v_mfma_f32_16x16x32_bf16 v[210:213], v[20:23], v[186:189], 0
    v_mfma_f32_16x16x32_bf16 v[214:217], v[18:21], v[186:189], 0
    s_waitcnt lgkmcnt(3)
    ds_read_b64_tr_b16 v[186:187], v1 offset:4096
    v_mfma_f32_16x16x32_bf16 v[202:205], v[8:11], v[190:193], v[202:205]
    v_add_f32_dpp v235, v229, v232 wave_ror:1 row_mask:0x1 bank_mask:0x1
    v_add_f32_dpp v237, v234, v231 wave_ror:1 row_mask:0x1 bank_mask:0x1
    v_mfma_f32_16x16x32_bf16 v[206:209], v[6:9], v[190:193], v[206:209]
    ds_read_b64_tr_b16 v[188:189], v1 offset:4608
    v_add_f32_dpp v239, v236, v230 wave_ror:1 row_mask:0x1 bank_mask:0x1
    v_mfma_f32_16x16x32_bf16 v[210:213], v[24:27], v[190:193], v[210:213]
    v_add_f32_dpp v235, v233, v232 wave_shr:1 row_mask:0xf bank_mask:0xf
    v_mfma_f32_16x16x32_bf16 v[214:217], v[22:25], v[190:193], v[214:217]
    ds_read_b64_tr_b16 v[190:191], v1 offset:5120
    v_add_f32_dpp v237, v235, v231 wave_shr:1 row_mask:0xf bank_mask:0xf
    v_mfma_f32_16x16x32_bf16 v[202:205], v[12:15], v[194:197], v[202:205]
    s_nop 0
    v_add_f32_dpp v239, v237, v230 wave_shr:1 row_mask:0xf bank_mask:0xf
    v_mfma_f32_16x16x32_bf16 v[206:209], v[10:13], v[194:197], v[206:209]
    ds_read_b64_tr_b16 v[192:193], v1 offset:5632
    ds_write_addtid_b32 v239 offset:22784
    v_mfma_f32_16x16x32_bf16 v[210:213], v[28:31], v[194:197], v[210:213]
    v_mfma_f32_16x16x32_bf16 v[214:217], v[26:29], v[194:197], v[214:217]
    s_waitcnt lgkmcnt(4)
    ds_read_b64_tr_b16 v[194:195], v1 offset:6144
    v_mfma_f32_16x16x32_bf16 v[206:209], v[14:17], v[198:201], v[206:209]
    v_add_f32_dpp v240, v205, v204 wave_shr:1 row_mask:0xf bank_mask:0xf bound_ctrl:0
    v_mfma_f32_16x16x32_bf16 v[210:213], v[32:35], v[198:201], v[210:213]
    ds_read_b64_tr_b16 v[196:197], v1 offset:6656
    v_add_f32_dpp v242, v240, v203 wave_shr:1 row_mask:0xf bank_mask:0xf bound_ctrl:0
    v_mfma_f32_16x16x32_bf16 v[214:217], v[30:33], v[198:201], v[214:217]
    s_waitcnt lgkmcnt(4)
    v_add_f32_dpp v244, v242, v202 wave_shr:1 row_mask:0xf bank_mask:0xf bound_ctrl:0
    v_mfma_f32_16x16x32_bf16 v[210:213], v[36:39], v[186:189], v[210:213]
    ds_read_b64_tr_b16 v[198:199], v1 offset:7168
    ds_read_b64_tr_b16 v[200:201], v1 offset:7680
    v_mfma_f32_16x16x32_bf16 v[214:217], v[34:37], v[186:189], v[214:217]
    s_waitcnt lgkmcnt(4)
    ds_write_addtid_b32 v244 offset:32768
    v_mfma_f32_16x16x32_bf16 v[210:213], v[40:43], v[190:193], v[210:213]
    ds_read_b64_tr_b16 v[186:187], v1 offset:8192
    ds_read_b64_tr_b16 v[188:189], v1 offset:8704
    v_mfma_f32_16x16x32_bf16 v[214:217], v[38:41], v[190:193], v[214:217]
    s_waitcnt lgkmcnt(5)
    v_add_f32_dpp v241, v205, v208 wave_ror:1 row_mask:0x1 bank_mask:0x1
    v_add_f32_dpp v243, v240, v207 wave_ror:1 row_mask:0x1 bank_mask:0x1
    v_mfma_f32_16x16x32_bf16 v[210:213], v[44:47], v[194:197], v[210:213]
    ds_read_b64_tr_b16 v[190:191], v1 offset:9216
    ds_read_b64_tr_b16 v[192:193], v1 offset:9728
    v_mfma_f32_16x16x32_bf16 v[214:217], v[42:45], v[194:197], v[214:217]
    s_waitcnt lgkmcnt(5)
    v_add_f32_dpp v245, v242, v206 wave_ror:1 row_mask:0x1 bank_mask:0x1
    v_add_f32_dpp v241, v209, v208 wave_shr:1 row_mask:0xf bank_mask:0xf
    v_mfma_f32_16x16x32_bf16 v[210:213], v[48:51], v[198:201], v[210:213]
    ds_read_b64_tr_b16 v[194:195], v1 offset:10240
    ds_read_b64_tr_b16 v[196:197], v1 offset:10752
    v_mfma_f32_16x16x32_bf16 v[214:217], v[46:49], v[198:201], v[214:217]
    s_waitcnt lgkmcnt(4)
    v_add_f32_dpp v243, v241, v207 wave_shr:1 row_mask:0xf bank_mask:0xf
    v_mfma_f32_16x16x32_bf16 v[210:213], v[52:55], v[186:189], v[210:213]
    ds_read_b64_tr_b16 v[198:199], v1 offset:11264
    ds_read_b64_tr_b16 v[200:201], v1 offset:11776
    v_mfma_f32_16x16x32_bf16 v[214:217], v[50:53], v[186:189], v[214:217]
    s_waitcnt lgkmcnt(4)
    v_add_f32_dpp v245, v243, v206 wave_shr:1 row_mask:0xf bank_mask:0xf
    v_mfma_f32_16x16x32_bf16 v[210:213], v[56:59], v[190:193], v[210:213]
    ds_read_b64_tr_b16 v[186:187], v1 offset:12288
    ds_read_b64_tr_b16 v[188:189], v1 offset:12800
    v_mfma_f32_16x16x32_bf16 v[214:217], v[54:57], v[190:193], v[214:217]
    s_waitcnt lgkmcnt(4)
    ds_write_addtid_b32 v245 offset:33024
    v_mfma_f32_16x16x32_bf16 v[210:213], v[60:63], v[194:197], v[210:213]
    ds_read_b64_tr_b16 v[190:191], v1 offset:13312
    ds_read_b64_tr_b16 v[192:193], v1 offset:13824
    v_mfma_f32_16x16x32_bf16 v[214:217], v[58:61], v[194:197], v[214:217]
    s_waitcnt lgkmcnt(5)
    v_mfma_f32_16x16x32_bf16 v[210:213], v[64:67], v[198:201], v[210:213]
    ds_read_b64_tr_b16 v[194:195], v1 offset:14336
    ds_read_b64_tr_b16 v[196:197], v1 offset:14848
    v_mfma_f32_16x16x32_bf16 v[214:217], v[62:65], v[198:201], v[214:217]
    s_waitcnt lgkmcnt(5)
    v_mfma_f32_16x16x32_bf16 v[210:213], v[68:71], v[186:189], v[210:213]
    v_mfma_f32_16x16x32_bf16 v[214:217], v[66:69], v[186:189], v[214:217]
    s_waitcnt lgkmcnt(2)
    v_mfma_f32_16x16x32_bf16 v[210:213], v[72:75], v[190:193], v[210:213]
    v_mfma_f32_16x16x32_bf16 v[214:217], v[70:73], v[190:193], v[214:217]
    s_waitcnt lgkmcnt(0)
    v_mfma_f32_16x16x32_bf16 v[214:217], v[74:77], v[194:197], v[214:217]
    ds_read_b64_tr_b16 v[186:187], v253 offset:3072
    v_mfma_f32_16x16x32_bf16 v[218:221], v[86:89], v[138:141], 0
    ds_read_b64_tr_b16 v[188:189], v253 offset:3200
    v_mfma_f32_16x16x32_bf16 v[218:221], v[90:93], v[142:145], v[218:221]
    s_nop 0
    v_add_f32_dpp v240, v213, v212 wave_shr:1 row_mask:0xf bank_mask:0xf bound_ctrl:0
    v_mfma_f32_16x16x32_bf16 v[218:221], v[94:97], v[146:149], v[218:221]
    s_nop 0
    v_add_f32_dpp v242, v240, v211 wave_shr:1 row_mask:0xf bank_mask:0xf bound_ctrl:0
    v_add_f32_dpp v241, v213, v216 wave_ror:1 row_mask:0x1 bank_mask:0x1
    v_mfma_f32_16x16x32_bf16 v[218:221], v[98:101], v[150:153], v[218:221]
    v_add_f32_dpp v244, v242, v210 wave_shr:1 row_mask:0xf bank_mask:0xf bound_ctrl:0
    v_add_f32_dpp v243, v240, v215 wave_ror:1 row_mask:0x1 bank_mask:0x1
    v_mfma_f32_16x16x32_bf16 v[218:221], v[102:105], v[154:157], v[218:221]
    ds_write_addtid_b32 v244 offset:34816
    v_add_f32_dpp v245, v242, v214 wave_ror:1 row_mask:0x1 bank_mask:0x1
    v_mfma_f32_16x16x32_bf16 v[218:221], v[106:109], v[158:161], v[218:221]
    v_add_f32_dpp v241, v217, v216 wave_shr:1 row_mask:0xf bank_mask:0xf
    v_mfma_f32_16x16x32_bf16 v[218:221], v[110:113], v[162:165], v[218:221]
    s_nop 0
    v_add_f32_dpp v243, v241, v215 wave_shr:1 row_mask:0xf bank_mask:0xf
    v_mfma_f32_16x16x32_bf16 v[218:221], v[114:117], v[166:169], v[218:221]
    s_nop 0
    v_add_f32_dpp v245, v243, v214 wave_shr:1 row_mask:0xf bank_mask:0xf
    v_mfma_f32_16x16x32_bf16 v[218:221], v[118:121], v[170:173], v[218:221]
    ds_write_addtid_b32 v245 offset:35072
    v_mfma_f32_16x16x32_bf16 v[218:221], v[122:125], v[174:177], v[218:221]
    v_mfma_f32_16x16x32_bf16 v[218:221], v[126:129], v[178:181], v[218:221]
    v_mfma_f32_16x16x32_bf16 v[218:221], v[130:133], v[182:185], v[218:221]
    s_waitcnt lgkmcnt(1)
    v_mfma_f32_16x16x32_bf16 v[218:221], v[134:137], v[186:189], v[218:221]
    v_mfma_f32_16x16x32_bf16 v[222:225], v[84:87], v[138:141], 0
    v_mfma_f32_16x16x32_bf16 v[222:225], v[88:91], v[142:145], v[222:225]
    v_mfma_f32_16x16x32_bf16 v[222:225], v[92:95], v[146:149], v[222:225]
    v_mfma_f32_16x16x32_bf16 v[222:225], v[96:99], v[150:153], v[222:225]
    v_mfma_f32_16x16x32_bf16 v[222:225], v[100:103], v[154:157], v[222:225]
    v_mfma_f32_16x16x32_bf16 v[222:225], v[104:107], v[158:161], v[222:225]
    v_mfma_f32_16x16x32_bf16 v[222:225], v[108:111], v[162:165], v[222:225]
    s_nop 0
    v_add_f32_dpp v234, v233, v220 wave_ror:1 row_mask:0x1 bank_mask:0x1
    v_add_f32_dpp v236, v235, v219 wave_ror:1 row_mask:0x1 bank_mask:0x1
    v_mfma_f32_16x16x32_bf16 v[222:225], v[112:115], v[166:169], v[222:225]
    v_add_f32_dpp v238, v237, v218 wave_ror:1 row_mask:0x1 bank_mask:0x1
    v_add_f32_dpp v234, v221, v220 wave_shr:1 row_mask:0xf bank_mask:0xf
    v_mfma_f32_16x16x32_bf16 v[222:225], v[116:119], v[170:173], v[222:225]
    s_nop 0
    v_add_f32_dpp v236, v234, v219 wave_shr:1 row_mask:0xf bank_mask:0xf
    v_mfma_f32_16x16x32_bf16 v[222:225], v[120:123], v[174:177], v[222:225]
    s_nop 0
    v_add_f32_dpp v238, v236, v218 wave_shr:1 row_mask:0xf bank_mask:0xf
    v_mfma_f32_16x16x32_bf16 v[222:225], v[124:127], v[178:181], v[222:225]
    ds_write_addtid_b32 v238 offset:24576
    v_mfma_f32_16x16x32_bf16 v[222:225], v[128:131], v[182:185], v[222:225]
    v_mfma_f32_16x16x32_bf16 v[222:225], v[132:135], v[186:189], v[222:225]
    v_mfma_f32_16x16x32_bf16 v[226:229], v[82:85], v[138:141], 0
    ds_read_b64_tr_b16 v[190:191], v253 offset:3328
    v_mfma_f32_16x16x32_bf16 v[226:229], v[86:89], v[142:145], v[226:229]
    ds_read_b64_tr_b16 v[192:193], v253 offset:3456
    v_mfma_f32_16x16x32_bf16 v[226:229], v[90:93], v[146:149], v[226:229]
    v_mfma_f32_16x16x32_bf16 v[226:229], v[94:97], v[150:153], v[226:229]
    v_mfma_f32_16x16x32_bf16 v[226:229], v[98:101], v[154:157], v[226:229]
    s_nop 0
    v_add_f32_dpp v235, v221, v224 wave_ror:1 row_mask:0x1 bank_mask:0x1
    v_add_f32_dpp v237, v234, v223 wave_ror:1 row_mask:0x1 bank_mask:0x1
    v_mfma_f32_16x16x32_bf16 v[226:229], v[102:105], v[158:161], v[226:229]
    v_add_f32_dpp v239, v236, v222 wave_ror:1 row_mask:0x1 bank_mask:0x1
    v_add_f32_dpp v235, v225, v224 wave_shr:1 row_mask:0xf bank_mask:0xf
    v_mfma_f32_16x16x32_bf16 v[226:229], v[106:109], v[162:165], v[226:229]
    s_nop 0
    v_add_f32_dpp v237, v235, v223 wave_shr:1 row_mask:0xf bank_mask:0xf
    v_mfma_f32_16x16x32_bf16 v[226:229], v[110:113], v[166:169], v[226:229]
    s_nop 0
    v_add_f32_dpp v239, v237, v222 wave_shr:1 row_mask:0xf bank_mask:0xf
    v_mfma_f32_16x16x32_bf16 v[226:229], v[114:117], v[170:173], v[226:229]
    ds_write_addtid_b32 v239 offset:24832
    v_mfma_f32_16x16x32_bf16 v[226:229], v[118:121], v[174:177], v[226:229]
    v_mfma_f32_16x16x32_bf16 v[226:229], v[122:125], v[178:181], v[226:229]
    v_mfma_f32_16x16x32_bf16 v[226:229], v[126:129], v[182:185], v[226:229]
    v_mfma_f32_16x16x32_bf16 v[226:229], v[130:133], v[186:189], v[226:229]
    s_waitcnt lgkmcnt(1)
    v_mfma_f32_16x16x32_bf16 v[226:229], v[134:137], v[190:193], v[226:229]
    v_mfma_f32_16x16x32_bf16 v[230:233], v[80:83], v[138:141], 0
    v_mfma_f32_16x16x32_bf16 v[230:233], v[84:87], v[142:145], v[230:233]
    v_mfma_f32_16x16x32_bf16 v[230:233], v[88:91], v[146:149], v[230:233]
    v_mfma_f32_16x16x32_bf16 v[230:233], v[92:95], v[150:153], v[230:233]
    v_mfma_f32_16x16x32_bf16 v[230:233], v[96:99], v[154:157], v[230:233]
    v_mfma_f32_16x16x32_bf16 v[230:233], v[100:103], v[158:161], v[230:233]
    v_mfma_f32_16x16x32_bf16 v[230:233], v[104:107], v[162:165], v[230:233]
    s_nop 0
    v_add_f32_dpp v234, v225, v228 wave_ror:1 row_mask:0x1 bank_mask:0x1
    v_add_f32_dpp v236, v235, v227 wave_ror:1 row_mask:0x1 bank_mask:0x1
    v_mfma_f32_16x16x32_bf16 v[230:233], v[108:111], v[166:169], v[230:233]
    v_add_f32_dpp v238, v237, v226 wave_ror:1 row_mask:0x1 bank_mask:0x1
    v_add_f32_dpp v234, v229, v228 wave_shr:1 row_mask:0xf bank_mask:0xf
    v_mfma_f32_16x16x32_bf16 v[230:233], v[112:115], v[170:173], v[230:233]
    s_nop 0
    v_add_f32_dpp v236, v234, v227 wave_shr:1 row_mask:0xf bank_mask:0xf
    v_mfma_f32_16x16x32_bf16 v[230:233], v[116:119], v[174:177], v[230:233]
    s_nop 0
    v_add_f32_dpp v238, v236, v226 wave_shr:1 row_mask:0xf bank_mask:0xf
    v_mfma_f32_16x16x32_bf16 v[230:233], v[120:123], v[178:181], v[230:233]
    ds_write_addtid_b32 v238 offset:26624
    v_mfma_f32_16x16x32_bf16 v[230:233], v[124:127], v[182:185], v[230:233]
    v_mfma_f32_16x16x32_bf16 v[230:233], v[128:131], v[186:189], v[230:233]
    v_mfma_f32_16x16x32_bf16 v[230:233], v[132:135], v[190:193], v[230:233]
    v_mfma_f32_16x16x32_bf16 v[202:205], v[78:81], v[138:141], 0
    v_mfma_f32_16x16x32_bf16 v[202:205], v[82:85], v[142:145], v[202:205]
    ds_read_b64_tr_b16 v[194:195], v253 offset:3584
    v_mfma_f32_16x16x32_bf16 v[202:205], v[86:89], v[146:149], v[202:205]
    ds_read_b64_tr_b16 v[196:197], v253 offset:3712
    v_mfma_f32_16x16x32_bf16 v[202:205], v[90:93], v[150:153], v[202:205]
    ds_read_b64_tr_b16 v[76:77], v251 offset:3840
    v_mfma_f32_16x16x32_bf16 v[202:205], v[94:97], v[154:157], v[202:205]
    v_add_f32_dpp v235, v229, v232 wave_ror:1 row_mask:0x1 bank_mask:0x1
    v_add_f32_dpp v237, v234, v231 wave_ror:1 row_mask:0x1 bank_mask:0x1
    v_mfma_f32_16x16x32_bf16 v[202:205], v[98:101], v[158:161], v[202:205]
    v_add_f32_dpp v239, v236, v230 wave_ror:1 row_mask:0x1 bank_mask:0x1
    v_add_f32_dpp v235, v233, v232 wave_shr:1 row_mask:0xf bank_mask:0xf
    v_mfma_f32_16x16x32_bf16 v[202:205], v[102:105], v[162:165], v[202:205]
    s_nop 0
    v_add_f32_dpp v237, v235, v231 wave_shr:1 row_mask:0xf bank_mask:0xf
    v_mfma_f32_16x16x32_bf16 v[202:205], v[106:109], v[166:169], v[202:205]
    s_nop 0
    v_add_f32_dpp v239, v237, v230 wave_shr:1 row_mask:0xf bank_mask:0xf
    v_mfma_f32_16x16x32_bf16 v[202:205], v[110:113], v[170:173], v[202:205]
    ds_write_addtid_b32 v239 offset:26880
    v_mfma_f32_16x16x32_bf16 v[202:205], v[114:117], v[174:177], v[202:205]
    v_mfma_f32_16x16x32_bf16 v[202:205], v[118:121], v[178:181], v[202:205]
    v_mfma_f32_16x16x32_bf16 v[202:205], v[122:125], v[182:185], v[202:205]
    v_mfma_f32_16x16x32_bf16 v[202:205], v[126:129], v[186:189], v[202:205]
    v_mfma_f32_16x16x32_bf16 v[202:205], v[130:133], v[190:193], v[202:205]
    s_waitcnt lgkmcnt(1)
    v_mfma_f32_16x16x32_bf16 v[202:205], v[134:137], v[194:197], v[202:205]
    v_mfma_f32_16x16x32_bf16 v[206:209], v[76:79], v[138:141], 0
    v_mfma_f32_16x16x32_bf16 v[206:209], v[80:83], v[142:145], v[206:209]
    v_mfma_f32_16x16x32_bf16 v[206:209], v[84:87], v[146:149], v[206:209]
    ds_read_b64_tr_b16 v[74:75], v251 offset:3968
    v_mfma_f32_16x16x32_bf16 v[206:209], v[88:91], v[150:153], v[206:209]
    v_mfma_f32_16x16x32_bf16 v[206:209], v[92:95], v[154:157], v[206:209]
    v_mfma_f32_16x16x32_bf16 v[206:209], v[96:99], v[158:161], v[206:209]
    s_nop 0
    v_add_f32_dpp v234, v233, v204 wave_ror:1 row_mask:0x1 bank_mask:0x1
    v_add_f32_dpp v236, v235, v203 wave_ror:1 row_mask:0x1 bank_mask:0x1
    v_mfma_f32_16x16x32_bf16 v[206:209], v[100:103], v[162:165], v[206:209]
    v_add_f32_dpp v238, v237, v202 wave_ror:1 row_mask:0x1 bank_mask:0x1
    v_add_f32_dpp v234, v205, v204 wave_shr:1 row_mask:0xf bank_mask:0xf
    v_mfma_f32_16x16x32_bf16 v[206:209], v[104:107], v[166:169], v[206:209]
    s_nop 0
    v_add_f32_dpp v236, v234, v203 wave_shr:1 row_mask:0xf bank_mask:0xf
    v_mfma_f32_16x16x32_bf16 v[206:209], v[108:111], v[170:173], v[206:209]
    s_nop 0
    v_add_f32_dpp v238, v236, v202 wave_shr:1 row_mask:0xf bank_mask:0xf
    v_mfma_f32_16x16x32_bf16 v[206:209], v[112:115], v[174:177], v[206:209]
    ds_write_addtid_b32 v238 offset:28672
    v_mfma_f32_16x16x32_bf16 v[206:209], v[116:119], v[178:181], v[206:209]
    v_mfma_f32_16x16x32_bf16 v[206:209], v[120:123], v[182:185], v[206:209]
    v_mfma_f32_16x16x32_bf16 v[206:209], v[124:127], v[186:189], v[206:209]
    v_mfma_f32_16x16x32_bf16 v[206:209], v[128:131], v[190:193], v[206:209]
    v_mfma_f32_16x16x32_bf16 v[206:209], v[132:135], v[194:197], v[206:209]
    s_waitcnt lgkmcnt(1)
    v_mfma_f32_16x16x32_bf16 v[210:213], v[74:77], v[138:141], 0
    v_mfma_f32_16x16x32_bf16 v[210:213], v[78:81], v[142:145], v[210:213]
    v_mfma_f32_16x16x32_bf16 v[210:213], v[82:85], v[146:149], v[210:213]
    ds_read_b64_tr_b16 v[198:199], v253 offset:3840
    v_mfma_f32_16x16x32_bf16 v[210:213], v[86:89], v[150:153], v[210:213]
    ds_read_b64_tr_b16 v[200:201], v253 offset:3968
    v_mfma_f32_16x16x32_bf16 v[210:213], v[90:93], v[154:157], v[210:213]
    ds_read_b64_tr_b16 v[72:73], v251 offset:4096
    v_add_f32_dpp v235, v205, v208 wave_ror:1 row_mask:0x1 bank_mask:0x1
    v_mfma_f32_16x16x32_bf16 v[210:213], v[94:97], v[158:161], v[210:213]
    v_add_f32_dpp v237, v234, v207 wave_ror:1 row_mask:0x1 bank_mask:0x1
    v_add_f32_dpp v239, v236, v206 wave_ror:1 row_mask:0x1 bank_mask:0x1
    v_mfma_f32_16x16x32_bf16 v[210:213], v[98:101], v[162:165], v[210:213]
    v_add_f32_dpp v235, v209, v208 wave_shr:1 row_mask:0xf bank_mask:0xf
    v_mfma_f32_16x16x32_bf16 v[210:213], v[102:105], v[166:169], v[210:213]
    s_nop 0
    v_add_f32_dpp v237, v235, v207 wave_shr:1 row_mask:0xf bank_mask:0xf
    v_mfma_f32_16x16x32_bf16 v[210:213], v[106:109], v[170:173], v[210:213]
    s_nop 0
    v_add_f32_dpp v239, v237, v206 wave_shr:1 row_mask:0xf bank_mask:0xf
    v_mfma_f32_16x16x32_bf16 v[210:213], v[110:113], v[174:177], v[210:213]
    ds_write_addtid_b32 v239 offset:28928
    v_mfma_f32_16x16x32_bf16 v[210:213], v[114:117], v[178:181], v[210:213]
    v_mfma_f32_16x16x32_bf16 v[210:213], v[118:121], v[182:185], v[210:213]
    v_mfma_f32_16x16x32_bf16 v[210:213], v[122:125], v[186:189], v[210:213]
    v_mfma_f32_16x16x32_bf16 v[210:213], v[126:129], v[190:193], v[210:213]
    v_mfma_f32_16x16x32_bf16 v[210:213], v[130:133], v[194:197], v[210:213]
    s_waitcnt lgkmcnt(1)
    v_mfma_f32_16x16x32_bf16 v[210:213], v[134:137], v[198:201], v[210:213]
    v_mfma_f32_16x16x32_bf16 v[214:217], v[72:75], v[138:141], 0
    v_mfma_f32_16x16x32_bf16 v[214:217], v[76:79], v[142:145], v[214:217]
    v_mfma_f32_16x16x32_bf16 v[214:217], v[80:83], v[146:149], v[214:217]
    v_mfma_f32_16x16x32_bf16 v[214:217], v[84:87], v[150:153], v[214:217]
    v_mfma_f32_16x16x32_bf16 v[214:217], v[88:91], v[154:157], v[214:217]
    v_mfma_f32_16x16x32_bf16 v[214:217], v[92:95], v[158:161], v[214:217]
    v_mfma_f32_16x16x32_bf16 v[214:217], v[96:99], v[162:165], v[214:217]
    s_nop 0
    v_add_f32_dpp v234, v209, v212 wave_ror:1 row_mask:0x1 bank_mask:0x1
    v_add_f32_dpp v236, v235, v211 wave_ror:1 row_mask:0x1 bank_mask:0x1
    v_mfma_f32_16x16x32_bf16 v[214:217], v[100:103], v[166:169], v[214:217]
    v_add_f32_dpp v238, v237, v210 wave_ror:1 row_mask:0x1 bank_mask:0x1
    v_add_f32_dpp v234, v213, v212 wave_shr:1 row_mask:0xf bank_mask:0xf
    v_mfma_f32_16x16x32_bf16 v[214:217], v[104:107], v[170:173], v[214:217]
    s_nop 0
    v_add_f32_dpp v236, v234, v211 wave_shr:1 row_mask:0xf bank_mask:0xf
    v_mfma_f32_16x16x32_bf16 v[214:217], v[108:111], v[174:177], v[214:217]
    s_nop 0
    v_add_f32_dpp v238, v236, v210 wave_shr:1 row_mask:0xf bank_mask:0xf
    v_mfma_f32_16x16x32_bf16 v[214:217], v[112:115], v[178:181], v[214:217]
    ds_write_addtid_b32 v238 offset:30720
    v_mfma_f32_16x16x32_bf16 v[214:217], v[116:119], v[182:185], v[214:217]
    v_mfma_f32_16x16x32_bf16 v[214:217], v[120:123], v[186:189], v[214:217]
    v_mfma_f32_16x16x32_bf16 v[214:217], v[124:127], v[190:193], v[214:217]
    v_mfma_f32_16x16x32_bf16 v[214:217], v[128:131], v[194:197], v[214:217]
    v_mfma_f32_16x16x32_bf16 v[214:217], v[132:135], v[198:201], v[214:217]
    s_nop 7
    v_add_f32_dpp v235, v213, v216 wave_ror:1 row_mask:0x1 bank_mask:0x1
    v_add_f32_dpp v237, v234, v215 wave_ror:1 row_mask:0x1 bank_mask:0x1
    v_add_f32_dpp v239, v236, v214 wave_ror:1 row_mask:0x1 bank_mask:0x1
    v_add_f32_dpp v235, v217, v216 wave_shr:1 row_mask:0xf bank_mask:0xf
    s_nop 1
    v_add_f32_dpp v237, v235, v215 wave_shr:1 row_mask:0xf bank_mask:0xf
    s_nop 1
    v_add_f32_dpp v239, v237, v214 wave_shr:1 row_mask:0xf bank_mask:0xf
    ds_write_addtid_b32 v239 offset:30976
    s_endpgm
.p2align 12
L_padt3:
    s_cbranch_execz L_rett
L_tail3:
    v_mfma_f32_16x16x32_bf16 v[230:233], v[112:115], v[162:165], v[230:233]
    ds_read_b64_tr_b16 v[190:191], v1 offset:1024
    v_add_f32_dpp v238, v237, v226 wave_ror:1 row_mask:0x1 bank_mask:0x1
    v_mfma_f32_16x16x32_bf16 v[230:233], v[116:119], v[166:169], v[230:233]
    ds_read_b64_tr_b16 v[192:193], v1 offset:1536
    v_add_f32_dpp v234, v229, v228 wave_shr:1 row_mask:0xf bank_mask:0xf
    v_mfma_f32_16x16x32_bf16 v[230:233], v[120:123], v[170:173], v[230:233]
    ds_read_b64_tr_b16 v[194:195], v1 offset:2048
    v_add_f32_dpp v236, v234, v227 wave_shr:1 row_mask:0xf bank_mask:0xf
    v_mfma_f32_16x16x32_bf16 v[230:233], v[124:127], v[174:177], v[230:233]
    ds_read_b64_tr_b16 v[196:197], v1 offset:2560
    v_add_f32_dpp v238, v236, v226 wave_shr:1 row_mask:0xf bank_mask:0xf
    v_mfma_f32_16x16x32_bf16 v[230:233], v[128:131], v[178:181], v[230:233]
    ds_read_b64_tr_b16 v[198:199], v1 offset:3072
    ds_write_addtid_b32 v238 offset:22528
    v_mfma_f32_16x16x32_bf16 v[230:233], v[132:135], v[182:185], v[230:233]
    s_waitcnt lgkmcnt(6)
    ds_read_b64_tr_b16 v[200:201], v1 offset:3584
    v_mfma_f32_16x16x32_bf16 v[202:205], v[4:7], v[186:189], 0
    v_mfma_f32_16x16x32_bf16 v[206:209], v[2:5], v[186:189], 0
    v_mfma_f32_16x16x32_bf16 v[210:213], v[24:27], v[186:189], 0
    v_mfma_f32_16x16x32_bf16 v[214:217], v[22:25], v[186:189], 0
    s_waitcnt lgkmcnt(4)
    ds_read_b64_tr_b16 v[186:187], v1 offset:4096
    v_mfma_f32_16x16x32_bf16 v[202:205], v[8:11], v[190:193], v[202:205]
    v_add_f32_dpp v235, v229, v232 wave_ror:1 row_mask:0x1 bank_mask:0x1
    v_add_f32_dpp v237, v234, v231 wave_ror:1 row_mask:0x1 bank_mask:0x1
    v_mfma_f32_16x16x32_bf16 v[206:209], v[6:9], v[190:193], v[206:209]
    ds_read_b64_tr_b16 v[188:189], v1 offset:4608
    v_add_f32_dpp v239, v236, v230 wave_ror:1 row_mask:0x1 bank_mask:0x1
    v_mfma_f32_16x16x32_bf16 v[210:213], v[28:31], v[190:193], v[210:213]
    v_add_f32_dpp v235, v233, v232 wave_shr:1 row_mask:0xf bank_mask:0xf
    v_mfma_f32_16x16x32_bf16 v[214:217], v[26:29], v[190:193], v[214:217]
    s_waitcnt lgkmcnt(2)
    ds_read_b64_tr_b16 v[190:191], v1 offset:5120
    v_mfma_f32_16x16x32_bf16 v[202:205], v[12:15], v[194:197], v[202:205]
    v_add_f32_dpp v237, v235, v231 wave_shr:1 row_mask:0xf bank_mask:0xf
    v_mfma_f32_16x16x32_bf16 v[206:209], v[10:13], v[194:197], v[206:209]
    ds_read_b64_tr_b16 v[192:193], v1 offset:5632
    v_add_f32_dpp v239, v237, v230 wave_shr:1 row_mask:0xf bank_mask:0xf
    v_mfma_f32_16x16x32_bf16 v[210:213], v[32:35], v[194:197], v[210:213]
    ds_write_addtid_b32 v239 offset:22784
    v_mfma_f32_16x16x32_bf16 v[214:217], v[30:33], v[194:197], v[214:217]
    ds_read_b64_tr_b16 v[194:195], v1 offset:6144
    v_mfma_f32_16x16x32_bf16 v[202:205], v[16:19], v[198:201], v[202:205]
    v_mfma_f32_16x16x32_bf16 v[206:209], v[14:17], v[198:201], v[206:209]
    ds_read_b64_tr_b16 v[196:197], v1 offset:6656
    v_mfma_f32_16x16x32_bf16 v[210:213], v[36:39], v[198:201], v[210:213]
    v_mfma_f32_16x16x32_bf16 v[214:217], v[34:37], v[198:201], v[214:217]
    s_waitcnt lgkmcnt(4)
    ds_read_b64_tr_b16 v[198:199], v1 offset:7168
    v_mfma_f32_16x16x32_bf16 v[206:209], v[18:21], v[186:189], v[206:209]
    s_nop 0
    v_add_f32_dpp v240, v205, v204 wave_shr:1 row_mask:0xf bank_mask:0xf bound_ctrl:0
    v_mfma_f32_16x16x32_bf16 v[210:213], v[40:43], v[186:189], v[210:213]
    ds_read_b64_tr_b16 v[200:201], v1 offset:7680
    v_add_f32_dpp v242, v240, v203 wave_shr:1 row_mask:0xf bank_mask:0xf bound_ctrl:0
    v_mfma_f32_16x16x32_bf16 v[214:217], v[38:41], v[186:189], v[214:217]
    s_waitcnt lgkmcnt(3)
    v_add_f32_dpp v244, v242, v202 wave_shr:1 row_mask:0xf bank_mask:0xf bound_ctrl:0
    v_add_f32_dpp v241, v205, v208 wave_ror:1 row_mask:0x1 bank_mask:0x1
    v_mfma_f32_16x16x32_bf16 v[210:213], v[44:47], v[190:193], v[210:213]
    ds_read_b64_tr_b16 v[186:187], v1 offset:8192
    ds_read_b64_tr_b16 v[188:189], v1 offset:8704
    v_mfma_f32_16x16x32_bf16 v[214:217], v[42:45], v[190:193], v[214:217]
    s_waitcnt lgkmcnt(4)
    ds_write_addtid_b32 v244 offset:32768
    v_mfma_f32_16x16x32_bf16 v[210:213], v[48:51], v[194:197], v[210:213]
    ds_read_b64_tr_b16 v[190:191], v1 offset:9216
    ds_read_b64_tr_b16 v[192:193], v1 offset:9728
    v_mfma_f32_16x16x32_bf16 v[214:217], v[46:49], v[194:197], v[214:217]
    s_waitcnt lgkmcnt(5)
    v_add_f32_dpp v243, v240, v207 wave_ror:1 row_mask:0x1 bank_mask:0x1
    v_add_f32_dpp v245, v242, v206 wave_ror:1 row_mask:0x1 bank_mask:0x1
    v_mfma_f32_16x16x32_bf16 v[210:213], v[52:55], v[198:201], v[210:213]
    ds_read_b64_tr_b16 v[194:195], v1 offset:10240
    ds_read_b64_tr_b16 v[196:197], v1 offset:10752
    v_mfma_f32_16x16x32_bf16 v[214:217], v[50:53], v[198:201], v[214:217]
    s_waitcnt lgkmcnt(5)
    v_add_f32_dpp v241, v209, v208 wave_shr:1 row_mask:0xf bank_mask:0xf
    v_mfma_f32_16x16x32_bf16 v[210:213], v[56:59], v[186:189], v[210:213]
    ds_read_b64_tr_b16 v[198:199], v1 offset:11264
    ds_read_b64_tr_b16 v[200:201], v1 offset:11776
    v_mfma_f32_16x16x32_bf16 v[214:217], v[54:57], v[186:189], v[214:217]
    s_waitcnt lgkmcnt(4)
    v_add_f32_dpp v243, v241, v207 wave_shr:1 row_mask:0xf bank_mask:0xf
    v_mfma_f32_16x16x32_bf16 v[210:213], v[60:63], v[190:193], v[210:213]
    ds_read_b64_tr_b16 v[186:187], v1 offset:12288
    ds_read_b64_tr_b16 v[188:189], v1 offset:12800
    v_mfma_f32_16x16x32_bf16 v[214:217], v[58:61], v[190:193], v[214:217]
    s_waitcnt lgkmcnt(4)
    v_add_f32_dpp v245, v243, v206 wave_shr:1 row_mask:0xf bank_mask:0xf
    v_mfma_f32_16x16x32_bf16 v[210:213], v[64:67], v[194:197], v[210:213]
    ds_read_b64_tr_b16 v[190:191], v1 offset:13312
    ds_read_b64_tr_b16 v[192:193], v1 offset:13824
    v_mfma_f32_16x16x32_bf16 v[214:217], v[62:65], v[194:197], v[214:217]
    s_waitcnt lgkmcnt(4)
    ds_write_addtid_b32 v245 offset:33024
    v_mfma_f32_16x16x32_bf16 v[210:213], v[68:71], v[198:201], v[210:213]
    v_mfma_f32_16x16x32_bf16 v[214:217], v[66:69], v[198:201], v[214:217]
    s_waitcnt lgkmcnt(3)
    v_mfma_f32_16x16x32_bf16 v[210:213], v[72:75], v[186:189], v[210:213]
    v_mfma_f32_16x16x32_bf16 v[214:217], v[70:73], v[186:189], v[214:217]
    s_waitcnt lgkmcnt(1)
    v_mfma_f32_16x16x32_bf16 v[214:217], v[74:77], v[190:193], v[214:217]
    ds_read_b64_tr_b16 v[186:187], v253 offset:3072
    v_mfma_f32_16x16x32_bf16 v[218:221], v[86:89], v[138:141], 0
    ds_read_b64_tr_b16 v[188:189], v253 offset:3200
    v_mfma_f32_16x16x32_bf16 v[218:221], v[90:93], v[142:145], v[218:221]
    s_nop 0
    v_add_f32_dpp v240, v213, v212 wave_shr:1 row_mask:0xf bank_mask:0xf bound_ctrl:0
    v_mfma_f32_16x16x32_bf16 v[218:221], v[94:97], v[146:149], v[218:221]
    s_nop 0
    v_add_f32_dpp v242, v240, v211 wave_shr:1 row_mask:0xf bank_mask:0xf bound_ctrl:0
    v_add_f32_dpp v241, v213, v216 wave_ror:1 row_mask:0x1 bank_mask:0x1
    v_mfma_f32_16x16x32_bf16 v[218:221], v[98:101], v[150:153], v[218:221]
    v_add_f32_dpp v244, v242, v210 wave_shr:1 row_mask:0xf bank_mask:0xf bound_ctrl:0
    v_add_f32_dpp v243, v240, v215 wave_ror:1 row_mask:0x1 bank_mask:0x1
    v_mfma_f32_16x16x32_bf16 v[218:221], v[102:105], v[154:157], v[218:221]
    ds_write_addtid_b32 v244 offset:34816
    v_add_f32_dpp v245, v242, v214 wave_ror:1 row_mask:0x1 bank_mask:0x1
    v_mfma_f32_16x16x32_bf16 v[218:221], v[106:109], v[158:161], v[218:221]
    v_add_f32_dpp v241, v217, v216 wave_shr:1 row_mask:0xf bank_mask:0xf
    v_mfma_f32_16x16x32_bf16 v[218:221], v[110:113], v[162:165], v[218:221]
    s_nop 0
    v_add_f32_dpp v243, v241, v215 wave_shr:1 row_mask:0xf bank_mask:0xf
    v_mfma_f32_16x16x32_bf16 v[218:221], v[114:117], v[166:169], v[218:221]
    s_nop 0
    v_add_f32_dpp v245, v243, v214 wave_shr:1 row_mask:0xf bank_mask:0xf
    v_mfma_f32_16x16x32_bf16 v[218:221], v[118:121], v[170:173], v[218:221]
    ds_write_addtid_b32 v245 offset:35072
    v_mfma_f32_16x16x32_bf16 v[218:221], v[122:125], v[174:177], v[218:221]
    v_mfma_f32_16x16x32_bf16 v[218:221], v[126:129], v[178:181], v[218:221]
    v_mfma_f32_16x16x32_bf16 v[218:221], v[130:133], v[182:185], v[218:221]
    s_waitcnt lgkmcnt(1)
    v_mfma_f32_16x16x32_bf16 v[218:221], v[134:137], v[186:189], v[218:221]
    v_mfma_f32_16x16x32_bf16 v[222:225], v[84:87], v[138:141], 0
    v_mfma_f32_16x16x32_bf16 v[222:225], v[88:91], v[142:145], v[222:225]
    v_mfma_f32_16x16x32_bf16 v[222:225], v[92:95], v[146:149], v[222:225]
    v_mfma_f32_16x16x32_bf16 v[222:225], v[96:99], v[150:153], v[222:225]
    v_mfma_f32_16x16x32_bf16 v[222:225], v[100:103], v[154:157], v[222:225]
    v_mfma_f32_16x16x32_bf16 v[222:225], v[104:107], v[158:161], v[222:225]
    v_mfma_f32_16x16x32_bf16 v[222:225], v[108:111], v[162:165], v[222:225]
    s_nop 0
    v_add_f32_dpp v234, v233, v220 wave_ror:1 row_mask:0x1 bank_mask:0x1
    v_add_f32_dpp v236, v235, v219 wave_ror:1 row_mask:0x1 bank_mask:0x1
    v_mfma_f32_16x16x32_bf16 v[222:225], v[112:115], v[166:169], v[222:225]
    v_add_f32_dpp v238, v237, v218 wave_ror:1 row_mask:0x1 bank_mask:0x1
    v_add_f32_dpp v234, v221, v220 wave_shr:1 row_mask:0xf bank_mask:0xf
    v_mfma_f32_16x16x32_bf16 v[222:225], v[116:119], v[170:173], v[222:225]
    s_nop 0
    v_add_f32_dpp v236, v234, v219 wave_shr:1 row_mask:0xf bank_mask:0xf
    v_mfma_f32_16x16x32_bf16 v[222:225], v[120:123], v[174:177], v[222:225]
    s_nop 0
    v_add_f32_dpp v238, v236, v218 wave_shr:1 row_mask:0xf bank_mask:0xf
    v_mfma_f32_16x16x32_bf16 v[222:225], v[124:127], v[178:181], v[222:225]
    ds_write_addtid_b32 v238 offset:24576
    v_mfma_f32_16x16x32_bf16 v[222:225], v[128:131], v[182:185], v[222:225]
    v_mfma_f32_16x16x32_bf16 v[222:225], v[132:135], v[186:189], v[222:225]
    v_mfma_f32_16x16x32_bf16 v[226:229], v[82:85], v[138:141], 0
    ds_read_b64_tr_b16 v[190:191], v253 offset:3328
    v_mfma_f32_16x16x32_bf16 v[226:229], v[86:89], v[142:145], v[226:229]
    ds_read_b64_tr_b16 v[192:193], v253 offset:3456
    v_mfma_f32_16x16x32_bf16 v[226:229], v[90:93], v[146:149], v[226:229]
    v_mfma_f32_16x16x32_bf16 v[226:229], v[94:97], v[150:153], v[226:229]
    v_mfma_f32_16x16x32_bf16 v[226:229], v[98:101], v[154:157], v[226:229]
    s_nop 0
    v_add_f32_dpp v235, v221, v224 wave_ror:1 row_mask:0x1 bank_mask:0x1
    v_add_f32_dpp v237, v234, v223 wave_ror:1 row_mask:0x1 bank_mask:0x1
    v_mfma_f32_16x16x32_bf16 v[226:229], v[102:105], v[158:161], v[226:229]
    v_add_f32_dpp v239, v236, v222 wave_ror:1 row_mask:0x1 bank_mask:0x1
    v_add_f32_dpp v235, v225, v224 wave_shr:1 row_mask:0xf bank_mask:0xf
    v_mfma_f32_16x16x32_bf16 v[226:229], v[106:109], v[162:165], v[226:229]
    s_nop 0
    v_add_f32_dpp v237, v235, v223 wave_shr:1 row_mask:0xf bank_mask:0xf
    v_mfma_f32_16x16x32_bf16 v[226:229], v[110:113], v[166:169], v[226:229]
    s_nop 0
    v_add_f32_dpp v239, v237, v222 wave_shr:1 row_mask:0xf bank_mask:0xf
    v_mfma_f32_16x16x32_bf16 v[226:229], v[114:117], v[170:173], v[226:229]
    ds_write_addtid_b32 v239 offset:24832
    v_mfma_f32_16x16x32_bf16 v[226:229], v[118:121], v[174:177], v[226:229]
    v_mfma_f32_16x16x32_bf16 v[226:229], v[122:125], v[178:181], v[226:229]
    v_mfma_f32_16x16x32_bf16 v[226:229], v[126:129], v[182:185], v[226:229]
    v_mfma_f32_16x16x32_bf16 v[226:229], v[130:133], v[186:189], v[226:229]
    s_waitcnt lgkmcnt(1)
    v_mfma_f32_16x16x32_bf16 v[226:229], v[134:137], v[190:193], v[226:229]
    v_mfma_f32_16x16x32_bf16 v[230:233], v[80:83], v[138:141], 0
    v_mfma_f32_16x16x32_bf16 v[230:233], v[84:87], v[142:145], v[230:233]
    v_mfma_f32_16x16x32_bf16 v[230:233], v[88:91], v[146:149], v[230:233]
    v_mfma_f32_16x16x32_bf16 v[230:233], v[92:95], v[150:153], v[230:233]
    v_mfma_f32_16x16x32_bf16 v[230:233], v[96:99], v[154:157], v[230:233]
    v_mfma_f32_16x16x32_bf16 v[230:233], v[100:103], v[158:161], v[230:233]
    v_mfma_f32_16x16x32_bf16 v[230:233], v[104:107], v[162:165], v[230:233]
    s_nop 0
    v_add_f32_dpp v234, v225, v228 wave_ror:1 row_mask:0x1 bank_mask:0x1
    v_add_f32_dpp v236, v235, v227 wave_ror:1 row_mask:0x1 bank_mask:0x1
    v_mfma_f32_16x16x32_bf16 v[230:233], v[108:111], v[166:169], v[230:233]
    v_add_f32_dpp v238, v237, v226 wave_ror:1 row_mask:0x1 bank_mask:0x1
    v_add_f32_dpp v234, v229, v228 wave_shr:1 row_mask:0xf bank_mask:0xf
    v_mfma_f32_16x16x32_bf16 v[230:233], v[112:115], v[170:173], v[230:233]
    s_nop 0
    v_add_f32_dpp v236, v234, v227 wave_shr:1 row_mask:0xf bank_mask:0xf
    v_mfma_f32_16x16x32_bf16 v[230:233], v[116:119], v[174:177], v[230:233]
    s_nop 0
    v_add_f32_dpp v238, v236, v226 wave_shr:1 row_mask:0xf bank_mask:0xf
    v_mfma_f32_16x16x32_bf16 v[230:233], v[120:123], v[178:181], v[230:233]
    ds_write_addtid_b32 v238 offset:26624
    v_mfma_f32_16x16x32_bf16 v[230:233], v[124:127], v[182:185], v[230:233]
    v_mfma_f32_16x16x32_bf16 v[230:233], v[128:131], v[186:189], v[230:233]
    v_mfma_f32_16x16x32_bf16 v[230:233], v[132:135], v[190:193], v[230:233]
    v_mfma_f32_16x16x32_bf16 v[202:205], v[78:81], v[138:141], 0
    v_mfma_f32_16x16x32_bf16 v[202:205], v[82:85], v[142:145], v[202:205]
    ds_read_b64_tr_b16 v[194:195], v253 offset:3584
    v_mfma_f32_16x16x32_bf16 v[202:205], v[86:89], v[146:149], v[202:205]
    ds_read_b64_tr_b16 v[196:197], v253 offset:3712
    v_mfma_f32_16x16x32_bf16 v[202:205], v[90:93], v[150:153], v[202:205]
    ds_read_b64_tr_b16 v[76:77], v251 offset:3840
    v_mfma_f32_16x16x32_bf16 v[202:205], v[94:97], v[154:157], v[202:205]
    v_add_f32_dpp v235, v229, v232 wave_ror:1 row_mask:0x1 bank_mask:0x1
    v_add_f32_dpp v237, v234, v231 wave_ror:1 row_mask:0x1 bank_mask:0x1
    v_mfma_f32_16x16x32_bf16 v[202:205], v[98:101], v[158:161], v[202:205]
    v_add_f32_dpp v239, v236, v230 wave_ror:1 row_mask:0x1 bank_mask:0x1
    v_add_f32_dpp v235, v233, v232 wave_shr:1 row_mask:0xf bank_mask:0xf
    v_mfma_f32_16x16x32_bf16 v[202:205], v[102:105], v[162:165], v[202:205]
    s_nop 0
    v_add_f32_dpp v237, v235, v231 wave_shr:1 row_mask:0xf bank_mask:0xf
    v_mfma_f32_16x16x32_bf16 v[202:205], v[106:109], v[166:169], v[202:205]
    s_nop 0
    v_add_f32_dpp v239, v237, v230 wave_shr:1 row_mask:0xf bank_mask:0xf
    v_mfma_f32_16x16x32_bf16 v[202:205], v[110:113], v[170:173], v[202:205]
    ds_write_addtid_b32 v239 offset:26880
    v_mfma_f32_16x16x32_bf16 v[202:205], v[114:117], v[174:177], v[202:205]
    v_mfma_f32_16x16x32_bf16 v[202:205], v[118:121], v[178:181], v[202:205]
    v_mfma_f32_16x16x32_bf16 v[202:205], v[122:125], v[182:185], v[202:205]
    v_mfma_f32_16x16x32_bf16 v[202:205], v[126:129], v[186:189], v[202:205]
    v_mfma_f32_16x16x32_bf16 v[202:205], v[130:133], v[190:193], v[202:205]
    s_waitcnt lgkmcnt(1)
    v_mfma_f32_16x16x32_bf16 v[202:205], v[134:137], v[194:197], v[202:205]
    v_mfma_f32_16x16x32_bf16 v[206:209], v[76:79], v[138:141], 0
    v_mfma_f32_16x16x32_bf16 v[206:209], v[80:83], v[142:145], v[206:209]
    v_mfma_f32_16x16x32_bf16 v[206:209], v[84:87], v[146:149], v[206:209]
    ds_read_b64_tr_b16 v[74:75], v251 offset:3968
    v_mfma_f32_16x16x32_bf16 v[206:209], v[88:91], v[150:153], v[206:209]
    v_mfma_f32_16x16x32_bf16 v[206:209], v[92:95], v[154:157], v[206:209]
    v_mfma_f32_16x16x32_bf16 v[206:209], v[96:99], v[158:161], v[206:209]
    s_nop 0
    v_add_f32_dpp v234, v233, v204 wave_ror:1 row_mask:0x1 bank_mask:0x1
    v_add_f32_dpp v236, v235, v203 wave_ror:1 row_mask:0x1 bank_mask:0x1
    v_mfma_f32_16x16x32_bf16 v[206:209], v[100:103], v[162:165], v[206:209]
    v_add_f32_dpp v238, v237, v202 wave_ror:1 row_mask:0x1 bank_mask:0x1
    v_add_f32_dpp v234, v205, v204 wave_shr:1 row_mask:0xf bank_mask:0xf
    v_mfma_f32_16x16x32_bf16 v[206:209], v[104:107], v[166:169], v[206:209]
    s_nop 0
    v_add_f32_dpp v236, v234, v203 wave_shr:1 row_mask:0xf bank_mask:0xf
    v_mfma_f32_16x16x32_bf16 v[206:209], v[108:111], v[170:173], v[206:209]
    s_nop 0
    v_add_f32_dpp v238, v236, v202 wave_shr:1 row_mask:0xf bank_mask:0xf
    v_mfma_f32_16x16x32_bf16 v[206:209], v[112:115], v[174:177], v[206:209]
    ds_write_addtid_b32 v238 offset:28672
    v_mfma_f32_16x16x32_bf16 v[206:209], v[116:119], v[178:181], v[206:209]
    v_mfma_f32_16x16x32_bf16 v[206:209], v[120:123], v[182:185], v[206:209]
    v_mfma_f32_16x16x32_bf16 v[206:209], v[124:127], v[186:189], v[206:209]
    v_mfma_f32_16x16x32_bf16 v[206:209], v[128:131], v[190:193], v[206:209]
    v_mfma_f32_16x16x32_bf16 v[206:209], v[132:135], v[194:197], v[206:209]
    s_waitcnt lgkmcnt(1)
    v_mfma_f32_16x16x32_bf16 v[210:213], v[74:77], v[138:141], 0
    v_mfma_f32_16x16x32_bf16 v[210:213], v[78:81], v[142:145], v[210:213]
    v_mfma_f32_16x16x32_bf16 v[210:213], v[82:85], v[146:149], v[210:213]
    ds_read_b64_tr_b16 v[198:199], v253 offset:3840
    v_mfma_f32_16x16x32_bf16 v[210:213], v[86:89], v[150:153], v[210:213]
    ds_read_b64_tr_b16 v[200:201], v253 offset:3968
    v_mfma_f32_16x16x32_bf16 v[210:213], v[90:93], v[154:157], v[210:213]
    ds_read_b64_tr_b16 v[72:73], v251 offset:4096
    v_add_f32_dpp v235, v205, v208 wave_ror:1 row_mask:0x1 bank_mask:0x1
    v_mfma_f32_16x16x32_bf16 v[210:213], v[94:97], v[158:161], v[210:213]
    v_add_f32_dpp v237, v234, v207 wave_ror:1 row_mask:0x1 bank_mask:0x1
    v_add_f32_dpp v239, v236, v206 wave_ror:1 row_mask:0x1 bank_mask:0x1
    v_mfma_f32_16x16x32_bf16 v[210:213], v[98:101], v[162:165], v[210:213]
    v_add_f32_dpp v235, v209, v208 wave_shr:1 row_mask:0xf bank_mask:0xf
    v_mfma_f32_16x16x32_bf16 v[210:213], v[102:105], v[166:169], v[210:213]
    s_nop 0
    v_add_f32_dpp v237, v235, v207 wave_shr:1 row_mask:0xf bank_mask:0xf
    v_mfma_f32_16x16x32_bf16 v[210:213], v[106:109], v[170:173], v[210:213]
    s_nop 0
    v_add_f32_dpp v239, v237, v206 wave_shr:1 row_mask:0xf bank_mask:0xf
    v_mfma_f32_16x16x32_bf16 v[210:213], v[110:113], v[174:177], v[210:213]
    ds_write_addtid_b32 v239 offset:28928
    v_mfma_f32_16x16x32_bf16 v[210:213], v[114:117], v[178:181], v[210:213]
    v_mfma_f32_16x16x32_bf16 v[210:213], v[118:121], v[182:185], v[210:213]
    v_mfma_f32_16x16x32_bf16 v[210:213], v[122:125], v[186:189], v[210:213]
    v_mfma_f32_16x16x32_bf16 v[210:213], v[126:129], v[190:193], v[210:213]
    v_mfma_f32_16x16x32_bf16 v[210:213], v[130:133], v[194:197], v[210:213]
    s_waitcnt lgkmcnt(1)
    v_mfma_f32_16x16x32_bf16 v[210:213], v[134:137], v[198:201], v[210:213]
    v_mfma_f32_16x16x32_bf16 v[214:217], v[72:75], v[138:141], 0
    v_mfma_f32_16x16x32_bf16 v[214:217], v[76:79], v[142:145], v[214:217]
    v_mfma_f32_16x16x32_bf16 v[214:217], v[80:83], v[146:149], v[214:217]
    v_mfma_f32_16x16x32_bf16 v[214:217], v[84:87], v[150:153], v[214:217]
    v_mfma_f32_16x16x32_bf16 v[214:217], v[88:91], v[154:157], v[214:217]
    v_mfma_f32_16x16x32_bf16 v[214:217], v[92:95], v[158:161], v[214:217]
    v_mfma_f32_16x16x32_bf16 v[214:217], v[96:99], v[162:165], v[214:217]
    s_nop 0
    v_add_f32_dpp v234, v209, v212 wave_ror:1 row_mask:0x1 bank_mask:0x1
    v_add_f32_dpp v236, v235, v211 wave_ror:1 row_mask:0x1 bank_mask:0x1
    v_mfma_f32_16x16x32_bf16 v[214:217], v[100:103], v[166:169], v[214:217]
    v_add_f32_dpp v238, v237, v210 wave_ror:1 row_mask:0x1 bank_mask:0x1
    v_add_f32_dpp v234, v213, v212 wave_shr:1 row_mask:0xf bank_mask:0xf
    v_mfma_f32_16x16x32_bf16 v[214:217], v[104:107], v[170:173], v[214:217]
    s_nop 0
    v_add_f32_dpp v236, v234, v211 wave_shr:1 row_mask:0xf bank_mask:0xf
    v_mfma_f32_16x16x32_bf16 v[214:217], v[108:111], v[174:177], v[214:217]
    s_nop 0
    v_add_f32_dpp v238, v236, v210 wave_shr:1 row_mask:0xf bank_mask:0xf
    v_mfma_f32_16x16x32_bf16 v[214:217], v[112:115], v[178:181], v[214:217]
    ds_write_addtid_b32 v238 offset:30720
    v_mfma_f32_16x16x32_bf16 v[214:217], v[116:119], v[182:185], v[214:217]
    v_mfma_f32_16x16x32_bf16 v[214:217], v[120:123], v[186:189], v[214:217]
    v_mfma_f32_16x16x32_bf16 v[214:217], v[124:127], v[190:193], v[214:217]
    v_mfma_f32_16x16x32_bf16 v[214:217], v[128:131], v[194:197], v[214:217]
    v_mfma_f32_16x16x32_bf16 v[214:217], v[132:135], v[198:201], v[214:217]
    s_nop 7
    v_add_f32_dpp v235, v213, v216 wave_ror:1 row_mask:0x1 bank_mask:0x1
    v_add_f32_dpp v237, v234, v215 wave_ror:1 row_mask:0x1 bank_mask:0x1
    v_add_f32_dpp v239, v236, v214 wave_ror:1 row_mask:0x1 bank_mask:0x1
    v_add_f32_dpp v235, v217, v216 wave_shr:1 row_mask:0xf bank_mask:0xf
    s_nop 1
    v_add_f32_dpp v237, v235, v215 wave_shr:1 row_mask:0xf bank_mask:0xf
    s_nop 1
    v_add_f32_dpp v239, v237, v214 wave_shr:1 row_mask:0xf bank_mask:0xf
    ds_write_addtid_b32 v239 offset:30976
    s_endpgm
.p2align 12
L_padt4:
    s_cbranch_execz L_rett
L_tail4:
    v_mfma_f32_16x16x32_bf16 v[230:233], v[116:119], v[166:169], v[230:233]
    ds_read_b64_tr_b16 v[190:191], v1 offset:1024
    v_add_f32_dpp v234, v229, v228 wave_shr:1 row_mask:0xf bank_mask:0xf
    v_mfma_f32_16x16x32_bf16 v[230:233], v[120:123], v[170:173], v[230:233]
    ds_read_b64_tr_b16 v[192:193], v1 offset:1536
    v_add_f32_dpp v236, v234, v227 wave_shr:1 row_mask:0xf bank_mask:0xf
    v_mfma_f32_16x16x32_bf16 v[230:233], v[124:127], v[174:177], v[230:233]
    ds_read_b64_tr_b16 v[194:195], v1 offset:2048
    v_add_f32_dpp v238, v236, v226 wave_shr:1 row_mask:0xf bank_mask:0xf
    v_mfma_f32_16x16x32_bf16 v[230:233], v[128:131], v[178:181], v[230:233]
    ds_read_b64_tr_b16 v[196:197], v1 offset:2560
    ds_write_addtid_b32 v238 offset:22528
    v_mfma_f32_16x16x32_bf16 v[230:233], v[132:135], v[182:185], v[230:233]
    s_waitcnt lgkmcnt(5)
    ds_read_b64_tr_b16 v[198:199], v1 offset:3072
    v_mfma_f32_16x16x32_bf16 v[202:205], v[4:7], v[186:189], 0
    ds_read_b64_tr_b16 v[200:201], v1 offset:3584
    v_mfma_f32_16x16x32_bf16 v[206:209], v[2:5], v[186:189], 0
    v_mfma_f32_16x16x32_bf16 v[210:213], v[28:31], v[186:189], 0
    v_mfma_f32_16x16x32_bf16 v[214:217], v[26:29], v[186:189], 0
    s_waitcnt lgkmcnt(5)
    ds_read_b64_tr_b16 v[186:187], v1 offset:4096
    v_mfma_f32_16x16x32_bf16 v[202:205], v[8:11], v[190:193], v[202:205]
    v_add_f32_dpp v235, v229, v232 wave_ror:1 row_mask:0x1 bank_mask:0x1
    v_add_f32_dpp v237, v234, v231 wave_ror:1 row_mask:0x1 bank_mask:0x1
    v_mfma_f32_16x16x32_bf16 v[206:209], v[6:9], v[190:193], v[206:209]
    ds_read_b64_tr_b16 v[188:189], v1 offset:4608
    v_add_f32_dpp v239, v236, v230 wave_ror:1 row_mask:0x1 bank_mask:0x1
    v_mfma_f32_16x16x32_bf16 v[210:213], v[32:35], v[190:193], v[210:213]
    v_add_f32_dpp v235, v233, v232 wave_shr:1 row_mask:0xf bank_mask:0xf
    v_mfma_f32_16x16x32_bf16 v[214:217], v[30:33], v[190:193], v[214:217]
    s_waitcnt lgkmcnt(2)
    ds_read_b64_tr_b16 v[190:191], v1 offset:5120
    v_mfma_f32_16x16x32_bf16 v[202:205], v[12:15], v[194:197], v[202:205]
    v_add_f32_dpp v237, v235, v231 wave_shr:1 row_mask:0xf bank_mask:0xf
    v_mfma_f32_16x16x32_bf16 v[206:209], v[10:13], v[194:197], v[206:209]
    ds_read_b64_tr_b16 v[192:193], v1 offset:5632
    v_add_f32_dpp v239, v237, v230 wave_shr:1 row_mask:0xf bank_mask:0xf
    v_mfma_f32_16x16x32_bf16 v[210:213], v[36:39], v[194:197], v[210:213]
    ds_write_addtid_b32 v239 offset:22784
    v_mfma_f32_16x16x32_bf16 v[214:217], v[34:37], v[194:197], v[214:217]
    ds_read_b64_tr_b16 v[194:195], v1 offset:6144
    v_mfma_f32_16x16x32_bf16 v[202:205], v[16:19], v[198:201], v[202:205]
    v_mfma_f32_16x16x32_bf16 v[206:209], v[14:17], v[198:201], v[206:209]
    ds_read_b64_tr_b16 v[196:197], v1 offset:6656
    v_mfma_f32_16x16x32_bf16 v[210:213], v[40:43], v[198:201], v[210:213]
    v_mfma_f32_16x16x32_bf16 v[214:217], v[38:41], v[198:201], v[214:217]
    s_waitcnt lgkmcnt(4)
    ds_read_b64_tr_b16 v[198:199], v1 offset:7168
    v_mfma_f32_16x16x32_bf16 v[202:205], v[20:23], v[186:189], v[202:205]
    v_mfma_f32_16x16x32_bf16 v[206:209], v[18:21], v[186:189], v[206:209]
    ds_read_b64_tr_b16 v[200:201], v1 offset:7680
    v_mfma_f32_16x16x32_bf16 v[210:213], v[44:47], v[186:189], v[210:213]
    v_mfma_f32_16x16x32_bf16 v[214:217], v[42:45], v[186:189], v[214:217]
    s_waitcnt lgkmcnt(3)
    ds_read_b64_tr_b16 v[186:187], v1 offset:8192
    v_mfma_f32_16x16x32_bf16 v[206:209], v[22:25], v[190:193], v[206:209]
    s_nop 0
    v_add_f32_dpp v240, v205, v204 wave_shr:1 row_mask:0xf bank_mask:0xf bound_ctrl:0
    v_mfma_f32_16x16x32_bf16 v[210:213], v[48:51], v[190:193], v[210:213]
    ds_read_b64_tr_b16 v[188:189], v1 offset:8704
    v_add_f32_dpp v242, v240, v203 wave_shr:1 row_mask:0xf bank_mask:0xf bound_ctrl:0
    v_mfma_f32_16x16x32_bf16 v[214:217], v[46:49], v[190:193], v[214:217]
    s_waitcnt lgkmcnt(3)
    v_add_f32_dpp v244, v242, v202 wave_shr:1 row_mask:0xf bank_mask:0xf bound_ctrl:0
    v_add_f32_dpp v241, v205, v208 wave_ror:1 row_mask:0x1 bank_mask:0x1
    v_mfma_f32_16x16x32_bf16 v[210:213], v[52:55], v[194:197], v[210:213]
    ds_read_b64_tr_b16 v[190:191], v1 offset:9216
    ds_read_b64_tr_b16 v[192:193], v1 offset:9728
    v_mfma_f32_16x16x32_bf16 v[214:217], v[50:53], v[194:197], v[214:217]
    s_waitcnt lgkmcnt(4)
    ds_write_addtid_b32 v244 offset:32768
    v_mfma_f32_16x16x32_bf16 v[210:213], v[56:59], v[198:201], v[210:213]
    ds_read_b64_tr_b16 v[194:195], v1 offset:10240
    ds_read_b64_tr_b16 v[196:197], v1 offset:10752
    v_mfma_f32_16x16x32_bf16 v[214:217], v[54:57], v[198:201], v[214:217]
    s_waitcnt lgkmcnt(5)
    v_add_f32_dpp v243, v240, v207 wave_ror:1 row_mask:0x1 bank_mask:0x1
    v_add_f32_dpp v245, v242, v206 wave_ror:1 row_mask:0x1 bank_mask:0x1
    v_mfma_f32_16x16x32_bf16 v[210:213], v[60:63], v[186:189], v[210:213]
    ds_read_b64_tr_b16 v[198:199], v1 offset:11264
    ds_read_b64_tr_b16 v[200:201], v1 offset:11776
    v_mfma_f32_16x16x32_bf16 v[214:217], v[58:61], v[186:189], v[214:217]
    s_waitcnt lgkmcnt(5)
    v_add_f32_dpp v241, v209, v208 wave_shr:1 row_mask:0xf bank_mask:0xf
    v_mfma_f32_16x16x32_bf16 v[210:213], v[64:67], v[190:193], v[210:213]
    ds_read_b64_tr_b16 v[186:187], v1 offset:12288
    ds_read_b64_tr_b16 v[188:189], v1 offset:12800
    v_mfma_f32_16x16x32_bf16 v[214:217], v[62:65], v[190:193], v[214:217]
    s_waitcnt lgkmcnt(4)
    v_add_f32_dpp v243, v241, v207 wave_shr:1 row_mask:0xf bank_mask:0xf
    v_mfma_f32_16x16x32_bf16 v[210:213], v[68:71], v[194:197], v[210:213]
    s_nop 0
    v_add_f32_dpp v245, v243, v206 wave_shr:1 row_mask:0xf bank_mask:0xf
    v_mfma_f32_16x16x32_bf16 v[214:217], v[66:69], v[194:197], v[214:217]
    s_waitcnt lgkmcnt(2)
    ds_write_addtid_b32 v245 offset:33024
    v_mfma_f32_16x16x32_bf16 v[210:213], v[72:75], v[198:201], v[210:213]
    v_mfma_f32_16x16x32_bf16 v[214:217], v[70:73], v[198:201], v[214:217]
    s_waitcnt lgkmcnt(1)
    v_mfma_f32_16x16x32_bf16 v[214:217], v[74:77], v[186:189], v[214:217]
    ds_read_b64_tr_b16 v[186:187], v253 offset:3072
    v_mfma_f32_16x16x32_bf16 v[218:221], v[86:89], v[138:141], 0
    ds_read_b64_tr_b16 v[188:189], v253 offset:3200
    v_mfma_f32_16x16x32_bf16 v[218:221], v[90:93], v[142:145], v[218:221]
    s_nop 0
    v_add_f32_dpp v240, v213, v212 wave_shr:1 row_mask:0xf bank_mask:0xf bound_ctrl:0
    v_mfma_f32_16x16x32_bf16 v[218:221], v[94:97], v[146:149], v[218:221]
    s_nop 0
    v_add_f32_dpp v242, v240, v211 wave_shr:1 row_mask:0xf bank_mask:0xf bound_ctrl:0
    v_add_f32_dpp v241, v213, v216 wave_ror:1 row_mask:0x1 bank_mask:0x1
    v_mfma_f32_16x16x32_bf16 v[218:221], v[98:101], v[150:153], v[218:221]
    v_add_f32_dpp v244, v242, v210 wave_shr:1 row_mask:0xf bank_mask:0xf bound_ctrl:0
    v_add_f32_dpp v243, v240, v215 wave_ror:1 row_mask:0x1 bank_mask:0x1
    v_mfma_f32_16x16x32_bf16 v[218:221], v[102:105], v[154:157], v[218:221]
    ds_write_addtid_b32 v244 offset:34816
    v_add_f32_dpp v245, v242, v214 wave_ror:1 row_mask:0x1 bank_mask:0x1
    v_mfma_f32_16x16x32_bf16 v[218:221], v[106:109], v[158:161], v[218:221]
    v_add_f32_dpp v241, v217, v216 wave_shr:1 row_mask:0xf bank_mask:0xf
    v_mfma_f32_16x16x32_bf16 v[218:221], v[110:113], v[162:165], v[218:221]
    s_nop 0
    v_add_f32_dpp v243, v241, v215 wave_shr:1 row_mask:0xf bank_mask:0xf
    v_mfma_f32_16x16x32_bf16 v[218:221], v[114:117], v[166:169], v[218:221]
    s_nop 0
    v_add_f32_dpp v245, v243, v214 wave_shr:1 row_mask:0xf bank_mask:0xf
    v_mfma_f32_16x16x32_bf16 v[218:221], v[118:121], v[170:173], v[218:221]
    ds_write_addtid_b32 v245 offset:35072
    v_mfma_f32_16x16x32_bf16 v[218:221], v[122:125], v[174:177], v[218:221]
    v_mfma_f32_16x16x32_bf16 v[218:221], v[126:129], v[178:181], v[218:221]
    v_mfma_f32_16x16x32_bf16 v[218:221], v[130:133], v[182:185], v[218:221]
    s_waitcnt lgkmcnt(1)
    v_mfma_f32_16x16x32_bf16 v[218:221], v[134:137], v[186:189], v[218:221]
    v_mfma_f32_16x16x32_bf16 v[222:225], v[84:87], v[138:141], 0
    v_mfma_f32_16x16x32_bf16 v[222:225], v[88:91], v[142:145], v[222:225]
    v_mfma_f32_16x16x32_bf16 v[222:225], v[92:95], v[146:149], v[222:225]
    v_mfma_f32_16x16x32_bf16 v[222:225], v[96:99], v[150:153], v[222:225]
    v_mfma_f32_16x16x32_bf16 v[222:225], v[100:103], v[154:157], v[222:225]
    v_mfma_f32_16x16x32_bf16 v[222:225], v[104:107], v[158:161], v[222:225]
    v_mfma_f32_16x16x32_bf16 v[222:225], v[108:111], v[162:165], v[222:225]
    s_nop 0
    v_add_f32_dpp v234, v233, v220 wave_ror:1 row_mask:0x1 bank_mask:0x1
    v_add_f32_dpp v236, v235, v219 wave_ror:1 row_mask:0x1 bank_mask:0x1
    v_mfma_f32_16x16x32_bf16 v[222:225], v[112:115], v[166:169], v[222:225]
    v_add_f32_dpp v238, v237, v218 wave_ror:1 row_mask:0x1 bank_mask:0x1
    v_add_f32_dpp v234, v221, v220 wave_shr:1 row_mask:0xf bank_mask:0xf
    v_mfma_f32_16x16x32_bf16 v[222:225], v[116:119], v[170:173], v[222:225]
    s_nop 0
    v_add_f32_dpp v236, v234, v219 wave_shr:1 row_mask:0xf bank_mask:0xf
    v_mfma_f32_16x16x32_bf16 v[222:225], v[120:123], v[174:177], v[222:225]
    s_nop 0
    v_add_f32_dpp v238, v236, v218 wave_shr:1 row_mask:0xf bank_mask:0xf
    v_mfma_f32_16x16x32_bf16 v[222:225], v[124:127], v[178:181], v[222:225]
    ds_write_addtid_b32 v238 offset:24576
    v_mfma_f32_16x16x32_bf16 v[222:225], v[128:131], v[182:185], v[222:225]
    v_mfma_f32_16x16x32_bf16 v[222:225], v[132:135], v[186:189], v[222:225]
    v_mfma_f32_16x16x32_bf16 v[226:229], v[82:85], v[138:141], 0
    ds_read_b64_tr_b16 v[190:191], v253 offset:3328
    v_mfma_f32_16x16x32_bf16 v[226:229], v[86:89], v[142:145], v[226:229]
    ds_read_b64_tr_b16 v[192:193], v253 offset:3456
    v_mfma_f32_16x16x32_bf16 v[226:229], v[90:93], v[146:149], v[226:229]
    v_mfma_f32_16x16x32_bf16 v[226:229], v[94:97], v[150:153], v[226:229]
    v_mfma_f32_16x16x32_bf16 v[226:229], v[98:101], v[154:157], v[226:229]
    s_nop 0
    v_add_f32_dpp v235, v221, v224 wave_ror:1 row_mask:0x1 bank_mask:0x1
    v_add_f32_dpp v237, v234, v223 wave_ror:1 row_mask:0x1 bank_mask:0x1
    v_mfma_f32_16x16x32_bf16 v[226:229], v[102:105], v[158:161], v[226:229]
    v_add_f32_dpp v239, v236, v222 wave_ror:1 row_mask:0x1 bank_mask:0x1
    v_add_f32_dpp v235, v225, v224 wave_shr:1 row_mask:0xf bank_mask:0xf
    v_mfma_f32_16x16x32_bf16 v[226:229], v[106:109], v[162:165], v[226:229]
    s_nop 0
    v_add_f32_dpp v237, v235, v223 wave_shr:1 row_mask:0xf bank_mask:0xf
    v_mfma_f32_16x16x32_bf16 v[226:229], v[110:113], v[166:169], v[226:229]
    s_nop 0
    v_add_f32_dpp v239, v237, v222 wave_shr:1 row_mask:0xf bank_mask:0xf
    v_mfma_f32_16x16x32_bf16 v[226:229], v[114:117], v[170:173], v[226:229]
    ds_write_addtid_b32 v239 offset:24832
    v_mfma_f32_16x16x32_bf16 v[226:229], v[118:121], v[174:177], v[226:229]
    v_mfma_f32_16x16x32_bf16 v[226:229], v[122:125], v[178:181], v[226:229]
    v_mfma_f32_16x16x32_bf16 v[226:229], v[126:129], v[182:185], v[226:229]
    v_mfma_f32_16x16x32_bf16 v[226:229], v[130:133], v[186:189], v[226:229]
    s_waitcnt lgkmcnt(1)
    v_mfma_f32_16x16x32_bf16 v[226:229], v[134:137], v[190:193], v[226:229]
    v_mfma_f32_16x16x32_bf16 v[230:233], v[80:83], v[138:141], 0
    v_mfma_f32_16x16x32_bf16 v[230:233], v[84:87], v[142:145], v[230:233]
    v_mfma_f32_16x16x32_bf16 v[230:233], v[88:91], v[146:149], v[230:233]
    v_mfma_f32_16x16x32_bf16 v[230:233], v[92:95], v[150:153], v[230:233]
    v_mfma_f32_16x16x32_bf16 v[230:233], v[96:99], v[154:157], v[230:233]
    v_mfma_f32_16x16x32_bf16 v[230:233], v[100:103], v[158:161], v[230:233]
    v_mfma_f32_16x16x32_bf16 v[230:233], v[104:107], v[162:165], v[230:233]
    s_nop 0
    v_add_f32_dpp v234, v225, v228 wave_ror:1 row_mask:0x1 bank_mask:0x1
    v_add_f32_dpp v236, v235, v227 wave_ror:1 row_mask:0x1 bank_mask:0x1
    v_mfma_f32_16x16x32_bf16 v[230:233], v[108:111], v[166:169], v[230:233]
    v_add_f32_dpp v238, v237, v226 wave_ror:1 row_mask:0x1 bank_mask:0x1
    v_add_f32_dpp v234, v229, v228 wave_shr:1 row_mask:0xf bank_mask:0xf
    v_mfma_f32_16x16x32_bf16 v[230:233], v[112:115], v[170:173], v[230:233]
    s_nop 0
    v_add_f32_dpp v236, v234, v227 wave_shr:1 row_mask:0xf bank_mask:0xf
    v_mfma_f32_16x16x32_bf16 v[230:233], v[116:119], v[174:177], v[230:233]
    s_nop 0
    v_add_f32_dpp v238, v236, v226 wave_shr:1 row_mask:0xf bank_mask:0xf
    v_mfma_f32_16x16x32_bf16 v[230:233], v[120:123], v[178:181], v[230:233]
    ds_write_addtid_b32 v238 offset:26624
    v_mfma_f32_16x16x32_bf16 v[230:233], v[124:127], v[182:185], v[230:233]
    v_mfma_f32_16x16x32_bf16 v[230:233], v[128:131], v[186:189], v[230:233]
    v_mfma_f32_16x16x32_bf16 v[230:233], v[132:135], v[190:193], v[230:233]
    v_mfma_f32_16x16x32_bf16 v[202:205], v[78:81], v[138:141], 0
    v_mfma_f32_16x16x32_bf16 v[202:205], v[82:85], v[142:145], v[202:205]
    ds_read_b64_tr_b16 v[194:195], v253 offset:3584
    v_mfma_f32_16x16x32_bf16 v[202:205], v[86:89], v[146:149], v[202:205]
    ds_read_b64_tr_b16 v[196:197], v253 offset:3712
    v_mfma_f32_16x16x32_bf16 v[202:205], v[90:93], v[150:153], v[202:205]
    ds_read_b64_tr_b16 v[76:77], v251 offset:3840
    v_mfma_f32_16x16x32_bf16 v[202:205], v[94:97], v[154:157], v[202:205]
    v_add_f32_dpp v235, v229, v232 wave_ror:1 row_mask:0x1 bank_mask:0x1
    v_add_f32_dpp v237, v234, v231 wave_ror:1 row_mask:0x1 bank_mask:0x1
    v_mfma_f32_16x16x32_bf16 v[202:205], v[98:101], v[158:161], v[202:205]
    v_add_f32_dpp v239, v236, v230 wave_ror:1 row_mask:0x1 bank_mask:0x1
    v_add_f32_dpp v235, v233, v232 wave_shr:1 row_mask:0xf bank_mask:0xf
    v_mfma_f32_16x16x32_bf16 v[202:205], v[102:105], v[162:165], v[202:205]
    s_nop 0
    v_add_f32_dpp v237, v235, v231 wave_shr:1 row_mask:0xf bank_mask:0xf
    v_mfma_f32_16x16x32_bf16 v[202:205], v[106:109], v[166:169], v[202:205]
    s_nop 0
    v_add_f32_dpp v239, v237, v230 wave_shr:1 row_mask:0xf bank_mask:0xf
    v_mfma_f32_16x16x32_bf16 v[202:205], v[110:113], v[170:173], v[202:205]
    ds_write_addtid_b32 v239 offset:26880
    v_mfma_f32_16x16x32_bf16 v[202:205], v[114:117], v[174:177], v[202:205]
    v_mfma_f32_16x16x32_bf16 v[202:205], v[118:121], v[178:181], v[202:205]
    v_mfma_f32_16x16x32_bf16 v[202:205], v[122:125], v[182:185], v[202:205]
    v_mfma_f32_16x16x32_bf16 v[202:205], v[126:129], v[186:189], v[202:205]
    v_mfma_f32_16x16x32_bf16 v[202:205], v[130:133], v[190:193], v[202:205]
    s_waitcnt lgkmcnt(1)
    v_mfma_f32_16x16x32_bf16 v[202:205], v[134:137], v[194:197], v[202:205]
    v_mfma_f32_16x16x32_bf16 v[206:209], v[76:79], v[138:141], 0
    v_mfma_f32_16x16x32_bf16 v[206:209], v[80:83], v[142:145], v[206:209]
    v_mfma_f32_16x16x32_bf16 v[206:209], v[84:87], v[146:149], v[206:209]
    ds_read_b64_tr_b16 v[74:75], v251 offset:3968
    v_mfma_f32_16x16x32_bf16 v[206:209], v[88:91], v[150:153], v[206:209]
    v_mfma_f32_16x16x32_bf16 v[206:209], v[92:95], v[154:157], v[206:209]
    v_mfma_f32_16x16x32_bf16 v[206:209], v[96:99], v[158:161], v[206:209]
    s_nop 0
    v_add_f32_dpp v234, v233, v204 wave_ror:1 row_mask:0x1 bank_mask:0x1
    v_add_f32_dpp v236, v235, v203 wave_ror:1 row_mask:0x1 bank_mask:0x1
    v_mfma_f32_16x16x32_bf16 v[206:209], v[100:103], v[162:165], v[206:209]
    v_add_f32_dpp v238, v237, v202 wave_ror:1 row_mask:0x1 bank_mask:0x1
    v_add_f32_dpp v234, v205, v204 wave_shr:1 row_mask:0xf bank_mask:0xf
    v_mfma_f32_16x16x32_bf16 v[206:209], v[104:107], v[166:169], v[206:209]
    s_nop 0
    v_add_f32_dpp v236, v234, v203 wave_shr:1 row_mask:0xf bank_mask:0xf
    v_mfma_f32_16x16x32_bf16 v[206:209], v[108:111], v[170:173], v[206:209]
    s_nop 0
    v_add_f32_dpp v238, v236, v202 wave_shr:1 row_mask:0xf bank_mask:0xf
    v_mfma_f32_16x16x32_bf16 v[206:209], v[112:115], v[174:177], v[206:209]
    ds_write_addtid_b32 v238 offset:28672
    v_mfma_f32_16x16x32_bf16 v[206:209], v[116:119], v[178:181], v[206:209]
    v_mfma_f32_16x16x32_bf16 v[206:209], v[120:123], v[182:185], v[206:209]
    v_mfma_f32_16x16x32_bf16 v[206:209], v[124:127], v[186:189], v[206:209]
    v_mfma_f32_16x16x32_bf16 v[206:209], v[128:131], v[190:193], v[206:209]
    v_mfma_f32_16x16x32_bf16 v[206:209], v[132:135], v[194:197], v[206:209]
    s_waitcnt lgkmcnt(1)
    v_mfma_f32_16x16x32_bf16 v[210:213], v[74:77], v[138:141], 0
    v_mfma_f32_16x16x32_bf16 v[210:213], v[78:81], v[142:145], v[210:213]
    v_mfma_f32_16x16x32_bf16 v[210:213], v[82:85], v[146:149], v[210:213]
    ds_read_b64_tr_b16 v[198:199], v253 offset:3840
    v_mfma_f32_16x16x32_bf16 v[210:213], v[86:89], v[150:153], v[210:213]
    ds_read_b64_tr_b16 v[200:201], v253 offset:3968
    v_mfma_f32_16x16x32_bf16 v[210:213], v[90:93], v[154:157], v[210:213]
    ds_read_b64_tr_b16 v[72:73], v251 offset:4096
    v_add_f32_dpp v235, v205, v208 wave_ror:1 row_mask:0x1 bank_mask:0x1
    v_mfma_f32_16x16x32_bf16 v[210:213], v[94:97], v[158:161], v[210:213]
    v_add_f32_dpp v237, v234, v207 wave_ror:1 row_mask:0x1 bank_mask:0x1
    v_add_f32_dpp v239, v236, v206 wave_ror:1 row_mask:0x1 bank_mask:0x1
    v_mfma_f32_16x16x32_bf16 v[210:213], v[98:101], v[162:165], v[210:213]
    v_add_f32_dpp v235, v209, v208 wave_shr:1 row_mask:0xf bank_mask:0xf
    v_mfma_f32_16x16x32_bf16 v[210:213], v[102:105], v[166:169], v[210:213]
    s_nop 0
    v_add_f32_dpp v237, v235, v207 wave_shr:1 row_mask:0xf bank_mask:0xf
    v_mfma_f32_16x16x32_bf16 v[210:213], v[106:109], v[170:173], v[210:213]
    s_nop 0
    v_add_f32_dpp v239, v237, v206 wave_shr:1 row_mask:0xf bank_mask:0xf
    v_mfma_f32_16x16x32_bf16 v[210:213], v[110:113], v[174:177], v[210:213]
    ds_write_addtid_b32 v239 offset:28928
    v_mfma_f32_16x16x32_bf16 v[210:213], v[114:117], v[178:181], v[210:213]
    v_mfma_f32_16x16x32_bf16 v[210:213], v[118:121], v[182:185], v[210:213]
    v_mfma_f32_16x16x32_bf16 v[210:213], v[122:125], v[186:189], v[210:213]
    v_mfma_f32_16x16x32_bf16 v[210:213], v[126:129], v[190:193], v[210:213]
    v_mfma_f32_16x16x32_bf16 v[210:213], v[130:133], v[194:197], v[210:213]
    s_waitcnt lgkmcnt(1)
    v_mfma_f32_16x16x32_bf16 v[210:213], v[134:137], v[198:201], v[210:213]
    v_mfma_f32_16x16x32_bf16 v[214:217], v[72:75], v[138:141], 0
    v_mfma_f32_16x16x32_bf16 v[214:217], v[76:79], v[142:145], v[214:217]
    v_mfma_f32_16x16x32_bf16 v[214:217], v[80:83], v[146:149], v[214:217]
    v_mfma_f32_16x16x32_bf16 v[214:217], v[84:87], v[150:153], v[214:217]
    v_mfma_f32_16x16x32_bf16 v[214:217], v[88:91], v[154:157], v[214:217]
    v_mfma_f32_16x16x32_bf16 v[214:217], v[92:95], v[158:161], v[214:217]
    v_mfma_f32_16x16x32_bf16 v[214:217], v[96:99], v[162:165], v[214:217]
    s_nop 0
    v_add_f32_dpp v234, v209, v212 wave_ror:1 row_mask:0x1 bank_mask:0x1
    v_add_f32_dpp v236, v235, v211 wave_ror:1 row_mask:0x1 bank_mask:0x1
    v_mfma_f32_16x16x32_bf16 v[214:217], v[100:103], v[166:169], v[214:217]
    v_add_f32_dpp v238, v237, v210 wave_ror:1 row_mask:0x1 bank_mask:0x1
    v_add_f32_dpp v234, v213, v212 wave_shr:1 row_mask:0xf bank_mask:0xf
    v_mfma_f32_16x16x32_bf16 v[214:217], v[104:107], v[170:173], v[214:217]
    s_nop 0
    v_add_f32_dpp v236, v234, v211 wave_shr:1 row_mask:0xf bank_mask:0xf
    v_mfma_f32_16x16x32_bf16 v[214:217], v[108:111], v[174:177], v[214:217]
    s_nop 0
    v_add_f32_dpp v238, v236, v210 wave_shr:1 row_mask:0xf bank_mask:0xf
    v_mfma_f32_16x16x32_bf16 v[214:217], v[112:115], v[178:181], v[214:217]
    ds_write_addtid_b32 v238 offset:30720
    v_mfma_f32_16x16x32_bf16 v[214:217], v[116:119], v[182:185], v[214:217]
    v_mfma_f32_16x16x32_bf16 v[214:217], v[120:123], v[186:189], v[214:217]
    v_mfma_f32_16x16x32_bf16 v[214:217], v[124:127], v[190:193], v[214:217]
    v_mfma_f32_16x16x32_bf16 v[214:217], v[128:131], v[194:197], v[214:217]
    v_mfma_f32_16x16x32_bf16 v[214:217], v[132:135], v[198:201], v[214:217]
    s_nop 7
    v_add_f32_dpp v235, v213, v216 wave_ror:1 row_mask:0x1 bank_mask:0x1
    v_add_f32_dpp v237, v234, v215 wave_ror:1 row_mask:0x1 bank_mask:0x1
    v_add_f32_dpp v239, v236, v214 wave_ror:1 row_mask:0x1 bank_mask:0x1
    v_add_f32_dpp v235, v217, v216 wave_shr:1 row_mask:0xf bank_mask:0xf
    s_nop 1
    v_add_f32_dpp v237, v235, v215 wave_shr:1 row_mask:0xf bank_mask:0xf
    s_nop 1
    v_add_f32_dpp v239, v237, v214 wave_shr:1 row_mask:0xf bank_mask:0xf
    ds_write_addtid_b32 v239 offset:30976
    s_endpgm
.p2align 12
L_padt5:
    s_cbranch_execz L_rett
L_tail5:
    v_mfma_f32_16x16x32_bf16 v[230:233], v[120:123], v[170:173], v[230:233]
    ds_read_b64_tr_b16 v[190:191], v1 offset:1024
    v_add_f32_dpp v236, v234, v227 wave_shr:1 row_mask:0xf bank_mask:0xf
    v_mfma_f32_16x16x32_bf16 v[230:233], v[124:127], v[174:177], v[230:233]
    ds_read_b64_tr_b16 v[192:193], v1 offset:1536
    v_add_f32_dpp v238, v236, v226 wave_shr:1 row_mask:0xf bank_mask:0xf
    v_mfma_f32_16x16x32_bf16 v[230:233], v[128:131], v[178:181], v[230:233]
    ds_read_b64_tr_b16 v[194:195], v1 offset:2048
    ds_write_addtid_b32 v238 offset:22528
    v_mfma_f32_16x16x32_bf16 v[230:233], v[132:135], v[182:185], v[230:233]
    s_waitcnt lgkmcnt(4)
    ds_read_b64_tr_b16 v[196:197], v1 offset:2560
    v_mfma_f32_16x16x32_bf16 v[202:205], v[4:7], v[186:189], 0
    ds_read_b64_tr_b16 v[198:199], v1 offset:3072
    v_mfma_f32_16x16x32_bf16 v[206:209], v[2:5], v[186:189], 0
    ds_read_b64_tr_b16 v[200:201], v1 offset:3584
    v_mfma_f32_16x16x32_bf16 v[210:213], v[32:35], v[186:189], 0
    s_nop 0
    v_add_f32_dpp v235, v229, v232 wave_ror:1 row_mask:0x1 bank_mask:0x1
    v_add_f32_dpp v237, v234, v231 wave_ror:1 row_mask:0x1 bank_mask:0x1
    v_mfma_f32_16x16x32_bf16 v[214:217], v[30:33], v[186:189], 0
    s_waitcnt lgkmcnt(5)
    ds_read_b64_tr_b16 v[186:187], v1 offset:4096
    v_mfma_f32_16x16x32_bf16 v[202:205], v[8:11], v[190:193], v[202:205]
    v_add_f32_dpp v239, v236, v230 wave_ror:1 row_mask:0x1 bank_mask:0x1
    v_add_f32_dpp v235, v233, v232 wave_shr:1 row_mask:0xf bank_mask:0xf
    v_mfma_f32_16x16x32_bf16 v[206:209], v[6:9], v[190:193], v[206:209]
    ds_read_b64_tr_b16 v[188:189], v1 offset:4608
    v_add_f32_dpp v237, v235, v231 wave_shr:1 row_mask:0xf bank_mask:0xf
    v_mfma_f32_16x16x32_bf16 v[210:213], v[36:39], v[190:193], v[210:213]
    s_nop 0
    v_add_f32_dpp v239, v237, v230 wave_shr:1 row_mask:0xf bank_mask:0xf
    v_mfma_f32_16x16x32_bf16 v[214:217], v[34:37], v[190:193], v[214:217]
    s_waitcnt lgkmcnt(3)
    ds_read_b64_tr_b16 v[190:191], v1 offset:5120
    v_mfma_f32_16x16x32_bf16 v[202:205], v[12:15], v[194:197], v[202:205]
    ds_write_addtid_b32 v239 offset:22784
    v_mfma_f32_16x16x32_bf16 v[206:209], v[10:13], v[194:197], v[206:209]
    ds_read_b64_tr_b16 v[192:193], v1 offset:5632
    v_mfma_f32_16x16x32_bf16 v[210:213], v[40:43], v[194:197], v[210:213]
    v_mfma_f32_16x16x32_bf16 v[214:217], v[38:41], v[194:197], v[214:217]
    s_waitcnt lgkmcnt(4)
    ds_read_b64_tr_b16 v[194:195], v1 offset:6144
    v_mfma_f32_16x16x32_bf16 v[202:205], v[16:19], v[198:201], v[202:205]
    v_mfma_f32_16x16x32_bf16 v[206:209], v[14:17], v[198:201], v[206:209]
    ds_read_b64_tr_b16 v[196:197], v1 offset:6656
    v_mfma_f32_16x16x32_bf16 v[210:213], v[44:47], v[198:201], v[210:213]
    v_mfma_f32_16x16x32_bf16 v[214:217], v[42:45], v[198:201], v[214:217]
    s_waitcnt lgkmcnt(3)
    ds_read_b64_tr_b16 v[198:199], v1 offset:7168
    v_mfma_f32_16x16x32_bf16 v[202:205], v[20:23], v[186:189], v[202:205]
    v_mfma_f32_16x16x32_bf16 v[206:209], v[18:21], v[186:189], v[206:209]
    ds_read_b64_tr_b16 v[200:201], v1 offset:7680
    v_mfma_f32_16x16x32_bf16 v[210:213], v[48:51], v[186:189], v[210:213]
    v_mfma_f32_16x16x32_bf16 v[214:217], v[46:49], v[186:189], v[214:217]
    s_waitcnt lgkmcnt(3)
    ds_read_b64_tr_b16 v[186:187], v1 offset:8192
    v_mfma_f32_16x16x32_bf16 v[202:205], v[24:27], v[190:193], v[202:205]
    v_mfma_f32_16x16x32_bf16 v[206:209], v[22:25], v[190:193], v[206:209]
    ds_read_b64_tr_b16 v[188:189], v1 offset:8704
    v_mfma_f32_16x16x32_bf16 v[210:213], v[52:55], v[190:193], v[210:213]
    v_mfma_f32_16x16x32_bf16 v[214:217], v[50:53], v[190:193], v[214:217]
    s_waitcnt lgkmcnt(3)
    ds_read_b64_tr_b16 v[190:191], v1 offset:9216
    v_mfma_f32_16x16x32_bf16 v[206:209], v[26:29], v[194:197], v[206:209]
    s_nop 0
    v_add_f32_dpp v240, v205, v204 wave_shr:1 row_mask:0xf bank_mask:0xf bound_ctrl:0
    v_mfma_f32_16x16x32_bf16 v[210:213], v[56:59], v[194:197], v[210:213]
    ds_read_b64_tr_b16 v[192:193], v1 offset:9728
    v_add_f32_dpp v242, v240, v203 wave_shr:1 row_mask:0xf bank_mask:0xf bound_ctrl:0
    v_mfma_f32_16x16x32_bf16 v[214:217], v[54:57], v[194:197], v[214:217]
    s_waitcnt lgkmcnt(3)
    v_add_f32_dpp v244, v242, v202 wave_shr:1 row_mask:0xf bank_mask:0xf bound_ctrl:0
    v_add_f32_dpp v241, v205, v208 wave_ror:1 row_mask:0x1 bank_mask:0x1
    v_mfma_f32_16x16x32_bf16 v[210:213], v[60:63], v[198:201], v[210:213]
    ds_read_b64_tr_b16 v[194:195], v1 offset:10240
    ds_read_b64_tr_b16 v[196:197], v1 offset:10752
    v_mfma_f32_16x16x32_bf16 v[214:217], v[58:61], v[198:201], v[214:217]
    s_waitcnt lgkmcnt(4)
    ds_write_addtid_b32 v244 offset:32768
    v_mfma_f32_16x16x32_bf16 v[210:213], v[64:67], v[186:189], v[210:213]
    ds_read_b64_tr_b16 v[198:199], v1 offset:11264
    ds_read_b64_tr_b16 v[200:201], v1 offset:11776
    v_mfma_f32_16x16x32_bf16 v[214:217], v[62:65], v[186:189], v[214:217]
    s_waitcnt lgkmcnt(5)
    v_add_f32_dpp v243, v240, v207 wave_ror:1 row_mask:0x1 bank_mask:0x1
    v_add_f32_dpp v245, v242, v206 wave_ror:1 row_mask:0x1 bank_mask:0x1
    v_mfma_f32_16x16x32_bf16 v[210:213], v[68:71], v[190:193], v[210:213]
    v_add_f32_dpp v241, v209, v208 wave_shr:1 row_mask:0xf bank_mask:0xf
    v_mfma_f32_16x16x32_bf16 v[214:217], v[66:69], v[190:193], v[214:217]
    s_waitcnt lgkmcnt(3)
    v_add_f32_dpp v243, v241, v207 wave_shr:1 row_mask:0xf bank_mask:0xf
    v_mfma_f32_16x16x32_bf16 v[210:213], v[72:75], v[194:197], v[210:213]
    s_nop 0
    v_add_f32_dpp v245, v243, v206 wave_shr:1 row_mask:0xf bank_mask:0xf
    v_mfma_f32_16x16x32_bf16 v[214:217], v[70:73], v[194:197], v[214:217]
    s_waitcnt lgkmcnt(0)
    ds_write_addtid_b32 v245 offset:33024
    v_mfma_f32_16x16x32_bf16 v[214:217], v[74:77], v[198:201], v[214:217]
    ds_read_b64_tr_b16 v[186:187], v253 offset:3072
    v_mfma_f32_16x16x32_bf16 v[218:221], v[86:89], v[138:141], 0
    ds_read_b64_tr_b16 v[188:189], v253 offset:3200
    v_add_f32_dpp v240, v213, v212 wave_shr:1 row_mask:0xf bank_mask:0xf bound_ctrl:0
    v_mfma_f32_16x16x32_bf16 v[218:221], v[90:93], v[142:145], v[218:221]
    s_nop 0
    v_add_f32_dpp v242, v240, v211 wave_shr:1 row_mask:0xf bank_mask:0xf bound_ctrl:0
    v_mfma_f32_16x16x32_bf16 v[218:221], v[94:97], v[146:149], v[218:221]
    s_nop 0
    v_add_f32_dpp v244, v242, v210 wave_shr:1 row_mask:0xf bank_mask:0xf bound_ctrl:0
    v_add_f32_dpp v241, v213, v216 wave_ror:1 row_mask:0x1 bank_mask:0x1
    v_mfma_f32_16x16x32_bf16 v[218:221], v[98:101], v[150:153], v[218:221]
    ds_write_addtid_b32 v244 offset:34816
    v_add_f32_dpp v243, v240, v215 wave_ror:1 row_mask:0x1 bank_mask:0x1
    v_mfma_f32_16x16x32_bf16 v[218:221], v[102:105], v[154:157], v[218:221]
    v_add_f32_dpp v245, v242, v214 wave_ror:1 row_mask:0x1 bank_mask:0x1
    v_add_f32_dpp v241, v217, v216 wave_shr:1 row_mask:0xf bank_mask:0xf
    v_mfma_f32_16x16x32_bf16 v[218:221], v[106:109], v[158:161], v[218:221]
    s_nop 0
    v_add_f32_dpp v243, v241, v215 wave_shr:1 row_mask:0xf bank_mask:0xf
    v_mfma_f32_16x16x32_bf16 v[218:221], v[110:113], v[162:165], v[218:221]
    s_nop 0
    v_add_f32_dpp v245, v243, v214 wave_shr:1 row_mask:0xf bank_mask:0xf
    v_mfma_f32_16x16x32_bf16 v[218:221], v[114:117], v[166:169], v[218:221]
    ds_write_addtid_b32 v245 offset:35072
    v_mfma_f32_16x16x32_bf16 v[218:221], v[118:121], v[170:173], v[218:221]
    v_mfma_f32_16x16x32_bf16 v[218:221], v[122:125], v[174:177], v[218:221]
    v_mfma_f32_16x16x32_bf16 v[218:221], v[126:129], v[178:181], v[218:221]
    v_mfma_f32_16x16x32_bf16 v[218:221], v[130:133], v[182:185], v[218:221]
    s_waitcnt lgkmcnt(1)
    v_mfma_f32_16x16x32_bf16 v[218:221], v[134:137], v[186:189], v[218:221]
    v_mfma_f32_16x16x32_bf16 v[222:225], v[84:87], v[138:141], 0
    v_mfma_f32_16x16x32_bf16 v[222:225], v[88:91], v[142:145], v[222:225]
    v_mfma_f32_16x16x32_bf16 v[222:225], v[92:95], v[146:149], v[222:225]
    v_mfma_f32_16x16x32_bf16 v[222:225], v[96:99], v[150:153], v[222:225]
    v_mfma_f32_16x16x32_bf16 v[222:225], v[100:103], v[154:157], v[222:225]
    v_mfma_f32_16x16x32_bf16 v[222:225], v[104:107], v[158:161], v[222:225]
    v_mfma_f32_16x16x32_bf16 v[222:225], v[108:111], v[162:165], v[222:225]
    s_nop 0
    v_add_f32_dpp v234, v233, v220 wave_ror:1 row_mask:0x1 bank_mask:0x1
    v_add_f32_dpp v236, v235, v219 wave_ror:1 row_mask:0x1 bank_mask:0x1
    v_mfma_f32_16x16x32_bf16 v[222:225], v[112:115], v[166:169], v[222:225]
    v_add_f32_dpp v238, v237, v218 wave_ror:1 row_mask:0x1 bank_mask:0x1
    v_add_f32_dpp v234, v221, v220 wave_shr:1 row_mask:0xf bank_mask:0xf
    v_mfma_f32_16x16x32_bf16 v[222:225], v[116:119], v[170:173], v[222:225]
    s_nop 0
    v_add_f32_dpp v236, v234, v219 wave_shr:1 row_mask:0xf bank_mask:0xf
    v_mfma_f32_16x16x32_bf16 v[222:225], v[120:123], v[174:177], v[222:225]
    s_nop 0
    v_add_f32_dpp v238, v236, v218 wave_shr:1 row_mask:0xf bank_mask:0xf
    v_mfma_f32_16x16x32_bf16 v[222:225], v[124:127], v[178:181], v[222:225]
    ds_write_addtid_b32 v238 offset:24576
    v_mfma_f32_16x16x32_bf16 v[222:225], v[128:131], v[182:185], v[222:225]
    v_mfma_f32_16x16x32_bf16 v[222:225], v[132:135], v[186:189], v[222:225]
    v_mfma_f32_16x16x32_bf16 v[226:229], v[82:85], v[138:141], 0
    ds_read_b64_tr_b16 v[190:191], v253 offset:3328
    v_mfma_f32_16x16x32_bf16 v[226:229], v[86:89], v[142:145], v[226:229]
    ds_read_b64_tr_b16 v[192:193], v253 offset:3456
    v_mfma_f32_16x16x32_bf16 v[226:229], v[90:93], v[146:149], v[226:229]
    v_mfma_f32_16x16x32_bf16 v[226:229], v[94:97], v[150:153], v[226:229]
    v_mfma_f32_16x16x32_bf16 v[226:229], v[98:101], v[154:157], v[226:229]
    s_nop 0
    v_add_f32_dpp v235, v221, v224 wave_ror:1 row_mask:0x1 bank_mask:0x1
    v_add_f32_dpp v237, v234, v223 wave_ror:1 row_mask:0x1 bank_mask:0x1
    v_mfma_f32_16x16x32_bf16 v[226:229], v[102:105], v[158:161], v[226:229]
    v_add_f32_dpp v239, v236, v222 wave_ror:1 row_mask:0x1 bank_mask:0x1
    v_add_f32_dpp v235, v225, v224 wave_shr:1 row_mask:0xf bank_mask:0xf
    v_mfma_f32_16x16x32_bf16 v[226:229], v[106:109], v[162:165], v[226:229]
    s_nop 0
    v_add_f32_dpp v237, v235, v223 wave_shr:1 row_mask:0xf bank_mask:0xf
    v_mfma_f32_16x16x32_bf16 v[226:229], v[110:113], v[166:169], v[226:229]
    s_nop 0
    v_add_f32_dpp v239, v237, v222 wave_shr:1 row_mask:0xf bank_mask:0xf
    v_mfma_f32_16x16x32_bf16 v[226:229], v[114:117], v[170:173], v[226:229]
    ds_write_addtid_b32 v239 offset:24832
    v_mfma_f32_16x16x32_bf16 v[226:229], v[118:121], v[174:177], v[226:229]
    v_mfma_f32_16x16x32_bf16 v[226:229], v[122:125], v[178:181], v[226:229]
    v_mfma_f32_16x16x32_bf16 v[226:229], v[126:129], v[182:185], v[226:229]
    v_mfma_f32_16x16x32_bf16 v[226:229], v[130:133], v[186:189], v[226:229]
    s_waitcnt lgkmcnt(1)
    v_mfma_f32_16x16x32_bf16 v[226:229], v[134:137], v[190:193], v[226:229]
    v_mfma_f32_16x16x32_bf16 v[230:233], v[80:83], v[138:141], 0
    v_mfma_f32_16x16x32_bf16 v[230:233], v[84:87], v[142:145], v[230:233]
    v_mfma_f32_16x16x32_bf16 v[230:233], v[88:91], v[146:149], v[230:233]
    v_mfma_f32_16x16x32_bf16 v[230:233], v[92:95], v[150:153], v[230:233]
    v_mfma_f32_16x16x32_bf16 v[230:233], v[96:99], v[154:157], v[230:233]
    v_mfma_f32_16x16x32_bf16 v[230:233], v[100:103], v[158:161], v[230:233]
    v_mfma_f32_16x16x32_bf16 v[230:233], v[104:107], v[162:165], v[230:233]
    s_nop 0
    v_add_f32_dpp v234, v225, v228 wave_ror:1 row_mask:0x1 bank_mask:0x1
    v_add_f32_dpp v236, v235, v227 wave_ror:1 row_mask:0x1 bank_mask:0x1
    v_mfma_f32_16x16x32_bf16 v[230:233], v[108:111], v[166:169], v[230:233]
    v_add_f32_dpp v238, v237, v226 wave_ror:1 row_mask:0x1 bank_mask:0x1
    v_add_f32_dpp v234, v229, v228 wave_shr:1 row_mask:0xf bank_mask:0xf
    v_mfma_f32_16x16x32_bf16 v[230:233], v[112:115], v[170:173], v[230:233]
    s_nop 0
    v_add_f32_dpp v236, v234, v227 wave_shr:1 row_mask:0xf bank_mask:0xf
    v_mfma_f32_16x16x32_bf16 v[230:233], v[116:119], v[174:177], v[230:233]
    s_nop 0
    v_add_f32_dpp v238, v236, v226 wave_shr:1 row_mask:0xf bank_mask:0xf
    v_mfma_f32_16x16x32_bf16 v[230:233], v[120:123], v[178:181], v[230:233]
    ds_write_addtid_b32 v238 offset:26624
    v_mfma_f32_16x16x32_bf16 v[230:233], v[124:127], v[182:185], v[230:233]
    v_mfma_f32_16x16x32_bf16 v[230:233], v[128:131], v[186:189], v[230:233]
    v_mfma_f32_16x16x32_bf16 v[230:233], v[132:135], v[190:193], v[230:233]
    v_mfma_f32_16x16x32_bf16 v[202:205], v[78:81], v[138:141], 0
    v_mfma_f32_16x16x32_bf16 v[202:205], v[82:85], v[142:145], v[202:205]
    ds_read_b64_tr_b16 v[194:195], v253 offset:3584
    v_mfma_f32_16x16x32_bf16 v[202:205], v[86:89], v[146:149], v[202:205]
    ds_read_b64_tr_b16 v[196:197], v253 offset:3712
    v_mfma_f32_16x16x32_bf16 v[202:205], v[90:93], v[150:153], v[202:205]
    ds_read_b64_tr_b16 v[76:77], v251 offset:3840
    v_mfma_f32_16x16x32_bf16 v[202:205], v[94:97], v[154:157], v[202:205]
    v_add_f32_dpp v235, v229, v232 wave_ror:1 row_mask:0x1 bank_mask:0x1
    v_add_f32_dpp v237, v234, v231 wave_ror:1 row_mask:0x1 bank_mask:0x1
    v_mfma_f32_16x16x32_bf16 v[202:205], v[98:101], v[158:161], v[202:205]
    v_add_f32_dpp v239, v236, v230 wave_ror:1 row_mask:0x1 bank_mask:0x1
    v_add_f32_dpp v235, v233, v232 wave_shr:1 row_mask:0xf bank_mask:0xf
    v_mfma_f32_16x16x32_bf16 v[202:205], v[102:105], v[162:165], v[202:205]
    s_nop 0
    v_add_f32_dpp v237, v235, v231 wave_shr:1 row_mask:0xf bank_mask:0xf
    v_mfma_f32_16x16x32_bf16 v[202:205], v[106:109], v[166:169], v[202:205]
    s_nop 0
    v_add_f32_dpp v239, v237, v230 wave_shr:1 row_mask:0xf bank_mask:0xf
    v_mfma_f32_16x16x32_bf16 v[202:205], v[110:113], v[170:173], v[202:205]
    ds_write_addtid_b32 v239 offset:26880
    v_mfma_f32_16x16x32_bf16 v[202:205], v[114:117], v[174:177], v[202:205]
    v_mfma_f32_16x16x32_bf16 v[202:205], v[118:121], v[178:181], v[202:205]
    v_mfma_f32_16x16x32_bf16 v[202:205], v[122:125], v[182:185], v[202:205]
    v_mfma_f32_16x16x32_bf16 v[202:205], v[126:129], v[186:189], v[202:205]
    v_mfma_f32_16x16x32_bf16 v[202:205], v[130:133], v[190:193], v[202:205]
    s_waitcnt lgkmcnt(1)
    v_mfma_f32_16x16x32_bf16 v[202:205], v[134:137], v[194:197], v[202:205]
    v_mfma_f32_16x16x32_bf16 v[206:209], v[76:79], v[138:141], 0
    v_mfma_f32_16x16x32_bf16 v[206:209], v[80:83], v[142:145], v[206:209]
    v_mfma_f32_16x16x32_bf16 v[206:209], v[84:87], v[146:149], v[206:209]
    ds_read_b64_tr_b16 v[74:75], v251 offset:3968
    v_mfma_f32_16x16x32_bf16 v[206:209], v[88:91], v[150:153], v[206:209]
    v_mfma_f32_16x16x32_bf16 v[206:209], v[92:95], v[154:157], v[206:209]
    v_mfma_f32_16x16x32_bf16 v[206:209], v[96:99], v[158:161], v[206:209]
    s_nop 0
    v_add_f32_dpp v234, v233, v204 wave_ror:1 row_mask:0x1 bank_mask:0x1
    v_add_f32_dpp v236, v235, v203 wave_ror:1 row_mask:0x1 bank_mask:0x1
    v_mfma_f32_16x16x32_bf16 v[206:209], v[100:103], v[162:165], v[206:209]
    v_add_f32_dpp v238, v237, v202 wave_ror:1 row_mask:0x1 bank_mask:0x1
    v_add_f32_dpp v234, v205, v204 wave_shr:1 row_mask:0xf bank_mask:0xf
    v_mfma_f32_16x16x32_bf16 v[206:209], v[104:107], v[166:169], v[206:209]
    s_nop 0
    v_add_f32_dpp v236, v234, v203 wave_shr:1 row_mask:0xf bank_mask:0xf
    v_mfma_f32_16x16x32_bf16 v[206:209], v[108:111], v[170:173], v[206:209]
    s_nop 0
    v_add_f32_dpp v238, v236, v202 wave_shr:1 row_mask:0xf bank_mask:0xf
    v_mfma_f32_16x16x32_bf16 v[206:209], v[112:115], v[174:177], v[206:209]
    ds_write_addtid_b32 v238 offset:28672
    v_mfma_f32_16x16x32_bf16 v[206:209], v[116:119], v[178:181], v[206:209]
    v_mfma_f32_16x16x32_bf16 v[206:209], v[120:123], v[182:185], v[206:209]
    v_mfma_f32_16x16x32_bf16 v[206:209], v[124:127], v[186:189], v[206:209]
    v_mfma_f32_16x16x32_bf16 v[206:209], v[128:131], v[190:193], v[206:209]
    v_mfma_f32_16x16x32_bf16 v[206:209], v[132:135], v[194:197], v[206:209]
    s_waitcnt lgkmcnt(1)
    v_mfma_f32_16x16x32_bf16 v[210:213], v[74:77], v[138:141], 0
    v_mfma_f32_16x16x32_bf16 v[210:213], v[78:81], v[142:145], v[210:213]
    v_mfma_f32_16x16x32_bf16 v[210:213], v[82:85], v[146:149], v[210:213]
    ds_read_b64_tr_b16 v[198:199], v253 offset:3840
    v_mfma_f32_16x16x32_bf16 v[210:213], v[86:89], v[150:153], v[210:213]
    ds_read_b64_tr_b16 v[200:201], v253 offset:3968
    v_mfma_f32_16x16x32_bf16 v[210:213], v[90:93], v[154:157], v[210:213]
    ds_read_b64_tr_b16 v[72:73], v251 offset:4096
    v_add_f32_dpp v235, v205, v208 wave_ror:1 row_mask:0x1 bank_mask:0x1
    v_mfma_f32_16x16x32_bf16 v[210:213], v[94:97], v[158:161], v[210:213]
    v_add_f32_dpp v237, v234, v207 wave_ror:1 row_mask:0x1 bank_mask:0x1
    v_add_f32_dpp v239, v236, v206 wave_ror:1 row_mask:0x1 bank_mask:0x1
    v_mfma_f32_16x16x32_bf16 v[210:213], v[98:101], v[162:165], v[210:213]
    v_add_f32_dpp v235, v209, v208 wave_shr:1 row_mask:0xf bank_mask:0xf
    v_mfma_f32_16x16x32_bf16 v[210:213], v[102:105], v[166:169], v[210:213]
    s_nop 0
    v_add_f32_dpp v237, v235, v207 wave_shr:1 row_mask:0xf bank_mask:0xf
    v_mfma_f32_16x16x32_bf16 v[210:213], v[106:109], v[170:173], v[210:213]
    s_nop 0
    v_add_f32_dpp v239, v237, v206 wave_shr:1 row_mask:0xf bank_mask:0xf
    v_mfma_f32_16x16x32_bf16 v[210:213], v[110:113], v[174:177], v[210:213]
    ds_write_addtid_b32 v239 offset:28928
    v_mfma_f32_16x16x32_bf16 v[210:213], v[114:117], v[178:181], v[210:213]
    v_mfma_f32_16x16x32_bf16 v[210:213], v[118:121], v[182:185], v[210:213]
    v_mfma_f32_16x16x32_bf16 v[210:213], v[122:125], v[186:189], v[210:213]
    v_mfma_f32_16x16x32_bf16 v[210:213], v[126:129], v[190:193], v[210:213]
    v_mfma_f32_16x16x32_bf16 v[210:213], v[130:133], v[194:197], v[210:213]
    s_waitcnt lgkmcnt(1)
    v_mfma_f32_16x16x32_bf16 v[210:213], v[134:137], v[198:201], v[210:213]
    v_mfma_f32_16x16x32_bf16 v[214:217], v[72:75], v[138:141], 0
    v_mfma_f32_16x16x32_bf16 v[214:217], v[76:79], v[142:145], v[214:217]
    v_mfma_f32_16x16x32_bf16 v[214:217], v[80:83], v[146:149], v[214:217]
    v_mfma_f32_16x16x32_bf16 v[214:217], v[84:87], v[150:153], v[214:217]
    v_mfma_f32_16x16x32_bf16 v[214:217], v[88:91], v[154:157], v[214:217]
    v_mfma_f32_16x16x32_bf16 v[214:217], v[92:95], v[158:161], v[214:217]
    v_mfma_f32_16x16x32_bf16 v[214:217], v[96:99], v[162:165], v[214:217]
    s_nop 0
    v_add_f32_dpp v234, v209, v212 wave_ror:1 row_mask:0x1 bank_mask:0x1
    v_add_f32_dpp v236, v235, v211 wave_ror:1 row_mask:0x1 bank_mask:0x1
    v_mfma_f32_16x16x32_bf16 v[214:217], v[100:103], v[166:169], v[214:217]
    v_add_f32_dpp v238, v237, v210 wave_ror:1 row_mask:0x1 bank_mask:0x1
    v_add_f32_dpp v234, v213, v212 wave_shr:1 row_mask:0xf bank_mask:0xf
    v_mfma_f32_16x16x32_bf16 v[214:217], v[104:107], v[170:173], v[214:217]
    s_nop 0
    v_add_f32_dpp v236, v234, v211 wave_shr:1 row_mask:0xf bank_mask:0xf
    v_mfma_f32_16x16x32_bf16 v[214:217], v[108:111], v[174:177], v[214:217]
    s_nop 0
    v_add_f32_dpp v238, v236, v210 wave_shr:1 row_mask:0xf bank_mask:0xf
    v_mfma_f32_16x16x32_bf16 v[214:217], v[112:115], v[178:181], v[214:217]
    ds_write_addtid_b32 v238 offset:30720
    v_mfma_f32_16x16x32_bf16 v[214:217], v[116:119], v[182:185], v[214:217]
    v_mfma_f32_16x16x32_bf16 v[214:217], v[120:123], v[186:189], v[214:217]
    v_mfma_f32_16x16x32_bf16 v[214:217], v[124:127], v[190:193], v[214:217]
    v_mfma_f32_16x16x32_bf16 v[214:217], v[128:131], v[194:197], v[214:217]
    v_mfma_f32_16x16x32_bf16 v[214:217], v[132:135], v[198:201], v[214:217]
    s_nop 7
    v_add_f32_dpp v235, v213, v216 wave_ror:1 row_mask:0x1 bank_mask:0x1
    v_add_f32_dpp v237, v234, v215 wave_ror:1 row_mask:0x1 bank_mask:0x1
    v_add_f32_dpp v239, v236, v214 wave_ror:1 row_mask:0x1 bank_mask:0x1
    v_add_f32_dpp v235, v217, v216 wave_shr:1 row_mask:0xf bank_mask:0xf
    s_nop 1
    v_add_f32_dpp v237, v235, v215 wave_shr:1 row_mask:0xf bank_mask:0xf
    s_nop 1
    v_add_f32_dpp v239, v237, v214 wave_shr:1 row_mask:0xf bank_mask:0xf
    ds_write_addtid_b32 v239 offset:30976
    s_endpgm
.p2align 12
L_padt6:
    s_cbranch_execz L_rett
L_tail6:
    v_mfma_f32_16x16x32_bf16 v[230:233], v[124:127], v[174:177], v[230:233]
    ds_read_b64_tr_b16 v[190:191], v1 offset:1024
    v_add_f32_dpp v238, v236, v226 wave_shr:1 row_mask:0xf bank_mask:0xf
    v_mfma_f32_16x16x32_bf16 v[230:233], v[128:131], v[178:181], v[230:233]
    ds_read_b64_tr_b16 v[192:193], v1 offset:1536
    ds_write_addtid_b32 v238 offset:22528
    v_mfma_f32_16x16x32_bf16 v[230:233], v[132:135], v[182:185], v[230:233]
    s_waitcnt lgkmcnt(3)
    ds_read_b64_tr_b16 v[194:195], v1 offset:2048
    v_mfma_f32_16x16x32_bf16 v[202:205], v[4:7], v[186:189], 0
    ds_read_b64_tr_b16 v[196:197], v1 offset:2560
    v_mfma_f32_16x16x32_bf16 v[206:209], v[2:5], v[186:189], 0
    ds_read_b64_tr_b16 v[198:199], v1 offset:3072
    v_mfma_f32_16x16x32_bf16 v[210:213], v[36:39], v[186:189], 0
    ds_read_b64_tr_b16 v[200:201], v1 offset:3584
    v_add_f32_dpp v235, v229, v232 wave_ror:1 row_mask:0x1 bank_mask:0x1
    v_mfma_f32_16x16x32_bf16 v[214:217], v[34:37], v[186:189], 0
    s_waitcnt lgkmcnt(5)
    ds_read_b64_tr_b16 v[186:187], v1 offset:4096
    v_mfma_f32_16x16x32_bf16 v[202:205], v[8:11], v[190:193], v[202:205]
    v_add_f32_dpp v237, v234, v231 wave_ror:1 row_mask:0x1 bank_mask:0x1
    v_add_f32_dpp v239, v236, v230 wave_ror:1 row_mask:0x1 bank_mask:0x1
    v_mfma_f32_16x16x32_bf16 v[206:209], v[6:9], v[190:193], v[206:209]
    ds_read_b64_tr_b16 v[188:189], v1 offset:4608
    v_add_f32_dpp v235, v233, v232 wave_shr:1 row_mask:0xf bank_mask:0xf
    v_mfma_f32_16x16x32_bf16 v[210:213], v[40:43], v[190:193], v[210:213]
    s_nop 0
    v_add_f32_dpp v237, v235, v231 wave_shr:1 row_mask:0xf bank_mask:0xf
    v_mfma_f32_16x16x32_bf16 v[214:217], v[38:41], v[190:193], v[214:217]
    s_waitcnt lgkmcnt(4)
    ds_read_b64_tr_b16 v[190:191], v1 offset:5120
    v_mfma_f32_16x16x32_bf16 v[202:205], v[12:15], v[194:197], v[202:205]
    v_add_f32_dpp v239, v237, v230 wave_shr:1 row_mask:0xf bank_mask:0xf
    v_mfma_f32_16x16x32_bf16 v[206:209], v[10:13], v[194:197], v[206:209]
    ds_read_b64_tr_b16 v[192:193], v1 offset:5632
    ds_write_addtid_b32 v239 offset:22784
    v_mfma_f32_16x16x32_bf16 v[210:213], v[44:47], v[194:197], v[210:213]
    v_mfma_f32_16x16x32_bf16 v[214:217], v[42:45], v[194:197], v[214:217]
    s_waitcnt lgkmcnt(4)
    ds_read_b64_tr_b16 v[194:195], v1 offset:6144
    v_mfma_f32_16x16x32_bf16 v[202:205], v[16:19], v[198:201], v[202:205]
    v_mfma_f32_16x16x32_bf16 v[206:209], v[14:17], v[198:201], v[206:209]
    ds_read_b64_tr_b16 v[196:197], v1 offset:6656
    v_mfma_f32_16x16x32_bf16 v[210:213], v[48:51], v[198:201], v[210:213]
    v_mfma_f32_16x16x32_bf16 v[214:217], v[46:49], v[198:201], v[214:217]
    s_waitcnt lgkmcnt(4)
    ds_read_b64_tr_b16 v[198:199], v1 offset:7168
    v_mfma_f32_16x16x32_bf16 v[202:205], v[20:23], v[186:189], v[202:205]
    v_mfma_f32_16x16x32_bf16 v[206:209], v[18:21], v[186:189], v[206:209]
    ds_read_b64_tr_b16 v[200:201], v1 offset:7680
    v_mfma_f32_16x16x32_bf16 v[210:213], v[52:55], v[186:189], v[210:213]
    v_mfma_f32_16x16x32_bf16 v[214:217], v[50:53], v[186:189], v[214:217]
    s_waitcnt lgkmcnt(3)
    ds_read_b64_tr_b16 v[186:187], v1 offset:8192
    v_mfma_f32_16x16x32_bf16 v[202:205], v[24:27], v[190:193], v[202:205]
    v_mfma_f32_16x16x32_bf16 v[206:209], v[22:25], v[190:193], v[206:209]
    ds_read_b64_tr_b16 v[188:189], v1 offset:8704
    v_mfma_f32_16x16x32_bf16 v[210:213], v[56:59], v[190:193], v[210:213]
    v_mfma_f32_16x16x32_bf16 v[214:217], v[54:57], v[190:193], v[214:217]
    s_waitcnt lgkmcnt(3)
    ds_read_b64_tr_b16 v[190:191], v1 offset:9216
    v_mfma_f32_16x16x32_bf16 v[202:205], v[28:31], v[194:197], v[202:205]
    v_mfma_f32_16x16x32_bf16 v[206:209], v[26:29], v[194:197], v[206:209]
    ds_read_b64_tr_b16 v[192:193], v1 offset:9728
    v_mfma_f32_16x16x32_bf16 v[210:213], v[60:63], v[194:197], v[210:213]
    v_mfma_f32_16x16x32_bf16 v[214:217], v[58:61], v[194:197], v[214:217]
    s_waitcnt lgkmcnt(3)
    ds_read_b64_tr_b16 v[194:195], v1 offset:10240
    v_mfma_f32_16x16x32_bf16 v[206:209], v[30:33], v[198:201], v[206:209]
    s_nop 0
    v_add_f32_dpp v240, v205, v204 wave_shr:1 row_mask:0xf bank_mask:0xf bound_ctrl:0
    v_mfma_f32_16x16x32_bf16 v[210:213], v[64:67], v[198:201], v[210:213]
    ds_read_b64_tr_b16 v[196:197], v1 offset:10752
    v_add_f32_dpp v242, v240, v203 wave_shr:1 row_mask:0xf bank_mask:0xf bound_ctrl:0
    v_mfma_f32_16x16x32_bf16 v[214:217], v[62:65], v[198:201], v[214:217]
    s_waitcnt lgkmcnt(3)
    v_add_f32_dpp v244, v242, v202 wave_shr:1 row_mask:0xf bank_mask:0xf bound_ctrl:0
    v_add_f32_dpp v241, v205, v208 wave_ror:1 row_mask:0x1 bank_mask:0x1
    v_mfma_f32_16x16x32_bf16 v[210:213], v[68:71], v[186:189], v[210:213]
    ds_write_addtid_b32 v244 offset:32768
    v_add_f32_dpp v243, v240, v207 wave_ror:1 row_mask:0x1 bank_mask:0x1
    v_mfma_f32_16x16x32_bf16 v[214:217], v[66:69], v[186:189], v[214:217]
    s_waitcnt lgkmcnt(3)
    v_add_f32_dpp v245, v242, v206 wave_ror:1 row_mask:0x1 bank_mask:0x1
    v_add_f32_dpp v241, v209, v208 wave_shr:1 row_mask:0xf bank_mask:0xf
    v_mfma_f32_16x16x32_bf16 v[210:213], v[72:75], v[190:193], v[210:213]
    s_nop 0
    v_add_f32_dpp v243, v241, v207 wave_shr:1 row_mask:0xf bank_mask:0xf
    v_mfma_f32_16x16x32_bf16 v[214:217], v[70:73], v[190:193], v[214:217]
    s_waitcnt lgkmcnt(1)
    v_add_f32_dpp v245, v243, v206 wave_shr:1 row_mask:0xf bank_mask:0xf
    v_mfma_f32_16x16x32_bf16 v[214:217], v[74:77], v[194:197], v[214:217]
    ds_read_b64_tr_b16 v[186:187], v253 offset:3072
    ds_write_addtid_b32 v245 offset:33024
    v_mfma_f32_16x16x32_bf16 v[218:221], v[86:89], v[138:141], 0
    ds_read_b64_tr_b16 v[188:189], v253 offset:3200
    v_add_f32_dpp v240, v213, v212 wave_shr:1 row_mask:0xf bank_mask:0xf bound_ctrl:0
    v_mfma_f32_16x16x32_bf16 v[218:221], v[90:93], v[142:145], v[218:221]
    s_nop 0
    v_add_f32_dpp v242, v240, v211 wave_shr:1 row_mask:0xf bank_mask:0xf bound_ctrl:0
    v_add_f32_dpp v241, v213, v216 wave_ror:1 row_mask:0x1 bank_mask:0x1
    v_mfma_f32_16x16x32_bf16 v[218:221], v[94:97], v[146:149], v[218:221]
    v_add_f32_dpp v244, v242, v210 wave_shr:1 row_mask:0xf bank_mask:0xf bound_ctrl:0
    v_add_f32_dpp v243, v240, v215 wave_ror:1 row_mask:0x1 bank_mask:0x1
    v_mfma_f32_16x16x32_bf16 v[218:221], v[98:101], v[150:153], v[218:221]
    ds_write_addtid_b32 v244 offset:34816
    v_add_f32_dpp v245, v242, v214 wave_ror:1 row_mask:0x1 bank_mask:0x1
    v_mfma_f32_16x16x32_bf16 v[218:221], v[102:105], v[154:157], v[218:221]
    v_add_f32_dpp v241, v217, v216 wave_shr:1 row_mask:0xf bank_mask:0xf
    v_mfma_f32_16x16x32_bf16 v[218:221], v[106:109], v[158:161], v[218:221]
    s_nop 0
    v_add_f32_dpp v243, v241, v215 wave_shr:1 row_mask:0xf bank_mask:0xf
    v_mfma_f32_16x16x32_bf16 v[218:221], v[110:113], v[162:165], v[218:221]
    s_nop 0
    v_add_f32_dpp v245, v243, v214 wave_shr:1 row_mask:0xf bank_mask:0xf
    v_mfma_f32_16x16x32_bf16 v[218:221], v[114:117], v[166:169], v[218:221]
    ds_write_addtid_b32 v245 offset:35072
    v_mfma_f32_16x16x32_bf16 v[218:221], v[118:121], v[170:173], v[218:221]
    v_mfma_f32_16x16x32_bf16 v[218:221], v[122:125], v[174:177], v[218:221]
    v_mfma_f32_16x16x32_bf16 v[218:221], v[126:129], v[178:181], v[218:221]
    v_mfma_f32_16x16x32_bf16 v[218:221], v[130:133], v[182:185], v[218:221]
    s_waitcnt lgkmcnt(1)
    v_mfma_f32_16x16x32_bf16 v[218:221], v[134:137], v[186:189], v[218:221]
    v_mfma_f32_16x16x32_bf16 v[222:225], v[84:87], v[138:141], 0
    v_mfma_f32_16x16x32_bf16 v[222:225], v[88:91], v[142:145], v[222:225]
    v_mfma_f32_16x16x32_bf16 v[222:225], v[92:95], v[146:149], v[222:225]
    v_mfma_f32_16x16x32_bf16 v[222:225], v[96:99], v[150:153], v[222:225]
    v_mfma_f32_16x16x32_bf16 v[222:225], v[100:103], v[154:157], v[222:225]
    v_mfma_f32_16x16x32_bf16 v[222:225], v[104:107], v[158:161], v[222:225]
    v_mfma_f32_16x16x32_bf16 v[222:225], v[108:111], v[162:165], v[222:225]
    s_nop 0
    v_add_f32_dpp v234, v233, v220 wave_ror:1 row_mask:0x1 bank_mask:0x1
    v_add_f32_dpp v236, v235, v219 wave_ror:1 row_mask:0x1 bank_mask:0x1
    v_mfma_f32_16x16x32_bf16 v[222:225], v[112:115], v[166:169], v[222:225]
    v_add_f32_dpp v238, v237, v218 wave_ror:1 row_mask:0x1 bank_mask:0x1
    v_add_f32_dpp v234, v221, v220 wave_shr:1 row_mask:0xf bank_mask:0xf
    v_mfma_f32_16x16x32_bf16 v[222:225], v[116:119], v[170:173], v[222:225]
    s_nop 0
    v_add_f32_dpp v236, v234, v219 wave_shr:1 row_mask:0xf bank_mask:0xf
    v_mfma_f32_16x16x32_bf16 v[222:225], v[120:123], v[174:177], v[222:225]
    s_nop 0
    v_add_f32_dpp v238, v236, v218 wave_shr:1 row_mask:0xf bank_mask:0xf
    v_mfma_f32_16x16x32_bf16 v[222:225], v[124:127], v[178:181], v[222:225]
    ds_write_addtid_b32 v238 offset:24576
    v_mfma_f32_16x16x32_bf16 v[222:225], v[128:131], v[182:185], v[222:225]
    v_mfma_f32_16x16x32_bf16 v[222:225], v[132:135], v[186:189], v[222:225]
    v_mfma_f32_16x16x32_bf16 v[226:229], v[82:85], v[138:141], 0
    ds_read_b64_tr_b16 v[190:191], v253 offset:3328
    v_mfma_f32_16x16x32_bf16 v[226:229], v[86:89], v[142:145], v[226:229]
    ds_read_b64_tr_b16 v[192:193], v253 offset:3456
    v_mfma_f32_16x16x32_bf16 v[226:229], v[90:93], v[146:149], v[226:229]
    v_mfma_f32_16x16x32_bf16 v[226:229], v[94:97], v[150:153], v[226:229]
    v_mfma_f32_16x16x32_bf16 v[226:229], v[98:101], v[154:157], v[226:229]
    s_nop 0
    v_add_f32_dpp v235, v221, v224 wave_ror:1 row_mask:0x1 bank_mask:0x1
    v_add_f32_dpp v237, v234, v223 wave_ror:1 row_mask:0x1 bank_mask:0x1
    v_mfma_f32_16x16x32_bf16 v[226:229], v[102:105], v[158:161], v[226:229]
    v_add_f32_dpp v239, v236, v222 wave_ror:1 row_mask:0x1 bank_mask:0x1
    v_add_f32_dpp v235, v225, v224 wave_shr:1 row_mask:0xf bank_mask:0xf
    v_mfma_f32_16x16x32_bf16 v[226:229], v[106:109], v[162:165], v[226:229]
    s_nop 0
    v_add_f32_dpp v237, v235, v223 wave_shr:1 row_mask:0xf bank_mask:0xf
    v_mfma_f32_16x16x32_bf16 v[226:229], v[110:113], v[166:169], v[226:229]
    s_nop 0
    v_add_f32_dpp v239, v237, v222 wave_shr:1 row_mask:0xf bank_mask:0xf
    v_mfma_f32_16x16x32_bf16 v[226:229], v[114:117], v[170:173], v[226:229]
    ds_write_addtid_b32 v239 offset:24832
    v_mfma_f32_16x16x32_bf16 v[226:229], v[118:121], v[174:177], v[226:229]
    v_mfma_f32_16x16x32_bf16 v[226:229], v[122:125], v[178:181], v[226:229]
    v_mfma_f32_16x16x32_bf16 v[226:229], v[126:129], v[182:185], v[226:229]
    v_mfma_f32_16x16x32_bf16 v[226:229], v[130:133], v[186:189], v[226:229]
    s_waitcnt lgkmcnt(1)
    v_mfma_f32_16x16x32_bf16 v[226:229], v[134:137], v[190:193], v[226:229]
    v_mfma_f32_16x16x32_bf16 v[230:233], v[80:83], v[138:141], 0
    v_mfma_f32_16x16x32_bf16 v[230:233], v[84:87], v[142:145], v[230:233]
    v_mfma_f32_16x16x32_bf16 v[230:233], v[88:91], v[146:149], v[230:233]
    v_mfma_f32_16x16x32_bf16 v[230:233], v[92:95], v[150:153], v[230:233]
    v_mfma_f32_16x16x32_bf16 v[230:233], v[96:99], v[154:157], v[230:233]
    v_mfma_f32_16x16x32_bf16 v[230:233], v[100:103], v[158:161], v[230:233]
    v_mfma_f32_16x16x32_bf16 v[230:233], v[104:107], v[162:165], v[230:233]
    s_nop 0
    v_add_f32_dpp v234, v225, v228 wave_ror:1 row_mask:0x1 bank_mask:0x1
    v_add_f32_dpp v236, v235, v227 wave_ror:1 row_mask:0x1 bank_mask:0x1
    v_mfma_f32_16x16x32_bf16 v[230:233], v[108:111], v[166:169], v[230:233]
    v_add_f32_dpp v238, v237, v226 wave_ror:1 row_mask:0x1 bank_mask:0x1
    v_add_f32_dpp v234, v229, v228 wave_shr:1 row_mask:0xf bank_mask:0xf
    v_mfma_f32_16x16x32_bf16 v[230:233], v[112:115], v[170:173], v[230:233]
    s_nop 0
    v_add_f32_dpp v236, v234, v227 wave_shr:1 row_mask:0xf bank_mask:0xf
    v_mfma_f32_16x16x32_bf16 v[230:233], v[116:119], v[174:177], v[230:233]
    s_nop 0
    v_add_f32_dpp v238, v236, v226 wave_shr:1 row_mask:0xf bank_mask:0xf
    v_mfma_f32_16x16x32_bf16 v[230:233], v[120:123], v[178:181], v[230:233]
    ds_write_addtid_b32 v238 offset:26624
    v_mfma_f32_16x16x32_bf16 v[230:233], v[124:127], v[182:185], v[230:233]
    v_mfma_f32_16x16x32_bf16 v[230:233], v[128:131], v[186:189], v[230:233]
    v_mfma_f32_16x16x32_bf16 v[230:233], v[132:135], v[190:193], v[230:233]
    v_mfma_f32_16x16x32_bf16 v[202:205], v[78:81], v[138:141], 0
    v_mfma_f32_16x16x32_bf16 v[202:205], v[82:85], v[142:145], v[202:205]
    ds_read_b64_tr_b16 v[194:195], v253 offset:3584
    v_mfma_f32_16x16x32_bf16 v[202:205], v[86:89], v[146:149], v[202:205]
    ds_read_b64_tr_b16 v[196:197], v253 offset:3712
    v_mfma_f32_16x16x32_bf16 v[202:205], v[90:93], v[150:153], v[202:205]
    ds_read_b64_tr_b16 v[76:77], v251 offset:3840
    v_mfma_f32_16x16x32_bf16 v[202:205], v[94:97], v[154:157], v[202:205]
    v_add_f32_dpp v235, v229, v232 wave_ror:1 row_mask:0x1 bank_mask:0x1
    v_add_f32_dpp v237, v234, v231 wave_ror:1 row_mask:0x1 bank_mask:0x1
    v_mfma_f32_16x16x32_bf16 v[202:205], v[98:101], v[158:161], v[202:205]
    v_add_f32_dpp v239, v236, v230 wave_ror:1 row_mask:0x1 bank_mask:0x1
    v_add_f32_dpp v235, v233, v232 wave_shr:1 row_mask:0xf bank_mask:0xf
    v_mfma_f32_16x16x32_bf16 v[202:205], v[102:105], v[162:165], v[202:205]
    s_nop 0
    v_add_f32_dpp v237, v235, v231 wave_shr:1 row_mask:0xf bank_mask:0xf
    v_mfma_f32_16x16x32_bf16 v[202:205], v[106:109], v[166:169], v[202:205]
    s_nop 0
    v_add_f32_dpp v239, v237, v230 wave_shr:1 row_mask:0xf bank_mask:0xf
    v_mfma_f32_16x16x32_bf16 v[202:205], v[110:113], v[170:173], v[202:205]
    ds_write_addtid_b32 v239 offset:26880
    v_mfma_f32_16x16x32_bf16 v[202:205], v[114:117], v[174:177], v[202:205]
    v_mfma_f32_16x16x32_bf16 v[202:205], v[118:121], v[178:181], v[202:205]
    v_mfma_f32_16x16x32_bf16 v[202:205], v[122:125], v[182:185], v[202:205]
    v_mfma_f32_16x16x32_bf16 v[202:205], v[126:129], v[186:189], v[202:205]
    v_mfma_f32_16x16x32_bf16 v[202:205], v[130:133], v[190:193], v[202:205]
    s_waitcnt lgkmcnt(1)
    v_mfma_f32_16x16x32_bf16 v[202:205], v[134:137], v[194:197], v[202:205]
    v_mfma_f32_16x16x32_bf16 v[206:209], v[76:79], v[138:141], 0
    v_mfma_f32_16x16x32_bf16 v[206:209], v[80:83], v[142:145], v[206:209]
    v_mfma_f32_16x16x32_bf16 v[206:209], v[84:87], v[146:149], v[206:209]
    ds_read_b64_tr_b16 v[74:75], v251 offset:3968
    v_mfma_f32_16x16x32_bf16 v[206:209], v[88:91], v[150:153], v[206:209]
    v_mfma_f32_16x16x32_bf16 v[206:209], v[92:95], v[154:157], v[206:209]
    v_mfma_f32_16x16x32_bf16 v[206:209], v[96:99], v[158:161], v[206:209]
    s_nop 0
    v_add_f32_dpp v234, v233, v204 wave_ror:1 row_mask:0x1 bank_mask:0x1
    v_add_f32_dpp v236, v235, v203 wave_ror:1 row_mask:0x1 bank_mask:0x1
    v_mfma_f32_16x16x32_bf16 v[206:209], v[100:103], v[162:165], v[206:209]
    v_add_f32_dpp v238, v237, v202 wave_ror:1 row_mask:0x1 bank_mask:0x1
    v_add_f32_dpp v234, v205, v204 wave_shr:1 row_mask:0xf bank_mask:0xf
    v_mfma_f32_16x16x32_bf16 v[206:209], v[104:107], v[166:169], v[206:209]
    s_nop 0
    v_add_f32_dpp v236, v234, v203 wave_shr:1 row_mask:0xf bank_mask:0xf
    v_mfma_f32_16x16x32_bf16 v[206:209], v[108:111], v[170:173], v[206:209]
    s_nop 0
    v_add_f32_dpp v238, v236, v202 wave_shr:1 row_mask:0xf bank_mask:0xf
    v_mfma_f32_16x16x32_bf16 v[206:209], v[112:115], v[174:177], v[206:209]
    ds_write_addtid_b32 v238 offset:28672
    v_mfma_f32_16x16x32_bf16 v[206:209], v[116:119], v[178:181], v[206:209]
    v_mfma_f32_16x16x32_bf16 v[206:209], v[120:123], v[182:185], v[206:209]
    v_mfma_f32_16x16x32_bf16 v[206:209], v[124:127], v[186:189], v[206:209]
    v_mfma_f32_16x16x32_bf16 v[206:209], v[128:131], v[190:193], v[206:209]
    v_mfma_f32_16x16x32_bf16 v[206:209], v[132:135], v[194:197], v[206:209]
    s_waitcnt lgkmcnt(1)
    v_mfma_f32_16x16x32_bf16 v[210:213], v[74:77], v[138:141], 0
    v_mfma_f32_16x16x32_bf16 v[210:213], v[78:81], v[142:145], v[210:213]
    v_mfma_f32_16x16x32_bf16 v[210:213], v[82:85], v[146:149], v[210:213]
    ds_read_b64_tr_b16 v[198:199], v253 offset:3840
    v_mfma_f32_16x16x32_bf16 v[210:213], v[86:89], v[150:153], v[210:213]
    ds_read_b64_tr_b16 v[200:201], v253 offset:3968
    v_mfma_f32_16x16x32_bf16 v[210:213], v[90:93], v[154:157], v[210:213]
    ds_read_b64_tr_b16 v[72:73], v251 offset:4096
    v_add_f32_dpp v235, v205, v208 wave_ror:1 row_mask:0x1 bank_mask:0x1
    v_mfma_f32_16x16x32_bf16 v[210:213], v[94:97], v[158:161], v[210:213]
    v_add_f32_dpp v237, v234, v207 wave_ror:1 row_mask:0x1 bank_mask:0x1
    v_add_f32_dpp v239, v236, v206 wave_ror:1 row_mask:0x1 bank_mask:0x1
    v_mfma_f32_16x16x32_bf16 v[210:213], v[98:101], v[162:165], v[210:213]
    v_add_f32_dpp v235, v209, v208 wave_shr:1 row_mask:0xf bank_mask:0xf
    v_mfma_f32_16x16x32_bf16 v[210:213], v[102:105], v[166:169], v[210:213]
    s_nop 0
    v_add_f32_dpp v237, v235, v207 wave_shr:1 row_mask:0xf bank_mask:0xf
    v_mfma_f32_16x16x32_bf16 v[210:213], v[106:109], v[170:173], v[210:213]
    s_nop 0
    v_add_f32_dpp v239, v237, v206 wave_shr:1 row_mask:0xf bank_mask:0xf
    v_mfma_f32_16x16x32_bf16 v[210:213], v[110:113], v[174:177], v[210:213]
    ds_write_addtid_b32 v239 offset:28928
    v_mfma_f32_16x16x32_bf16 v[210:213], v[114:117], v[178:181], v[210:213]
    v_mfma_f32_16x16x32_bf16 v[210:213], v[118:121], v[182:185], v[210:213]
    v_mfma_f32_16x16x32_bf16 v[210:213], v[122:125], v[186:189], v[210:213]
    v_mfma_f32_16x16x32_bf16 v[210:213], v[126:129], v[190:193], v[210:213]
    v_mfma_f32_16x16x32_bf16 v[210:213], v[130:133], v[194:197], v[210:213]
    s_waitcnt lgkmcnt(1)
    v_mfma_f32_16x16x32_bf16 v[210:213], v[134:137], v[198:201], v[210:213]
    v_mfma_f32_16x16x32_bf16 v[214:217], v[72:75], v[138:141], 0
    v_mfma_f32_16x16x32_bf16 v[214:217], v[76:79], v[142:145], v[214:217]
    v_mfma_f32_16x16x32_bf16 v[214:217], v[80:83], v[146:149], v[214:217]
    v_mfma_f32_16x16x32_bf16 v[214:217], v[84:87], v[150:153], v[214:217]
    v_mfma_f32_16x16x32_bf16 v[214:217], v[88:91], v[154:157], v[214:217]
    v_mfma_f32_16x16x32_bf16 v[214:217], v[92:95], v[158:161], v[214:217]
    v_mfma_f32_16x16x32_bf16 v[214:217], v[96:99], v[162:165], v[214:217]
    s_nop 0
    v_add_f32_dpp v234, v209, v212 wave_ror:1 row_mask:0x1 bank_mask:0x1
    v_add_f32_dpp v236, v235, v211 wave_ror:1 row_mask:0x1 bank_mask:0x1
    v_mfma_f32_16x16x32_bf16 v[214:217], v[100:103], v[166:169], v[214:217]
    v_add_f32_dpp v238, v237, v210 wave_ror:1 row_mask:0x1 bank_mask:0x1
    v_add_f32_dpp v234, v213, v212 wave_shr:1 row_mask:0xf bank_mask:0xf
    v_mfma_f32_16x16x32_bf16 v[214:217], v[104:107], v[170:173], v[214:217]
    s_nop 0
    v_add_f32_dpp v236, v234, v211 wave_shr:1 row_mask:0xf bank_mask:0xf
    v_mfma_f32_16x16x32_bf16 v[214:217], v[108:111], v[174:177], v[214:217]
    s_nop 0
    v_add_f32_dpp v238, v236, v210 wave_shr:1 row_mask:0xf bank_mask:0xf
    v_mfma_f32_16x16x32_bf16 v[214:217], v[112:115], v[178:181], v[214:217]
    ds_write_addtid_b32 v238 offset:30720
    v_mfma_f32_16x16x32_bf16 v[214:217], v[116:119], v[182:185], v[214:217]
    v_mfma_f32_16x16x32_bf16 v[214:217], v[120:123], v[186:189], v[214:217]
    v_mfma_f32_16x16x32_bf16 v[214:217], v[124:127], v[190:193], v[214:217]
    v_mfma_f32_16x16x32_bf16 v[214:217], v[128:131], v[194:197], v[214:217]
    v_mfma_f32_16x16x32_bf16 v[214:217], v[132:135], v[198:201], v[214:217]
    s_nop 7
    v_add_f32_dpp v235, v213, v216 wave_ror:1 row_mask:0x1 bank_mask:0x1
    v_add_f32_dpp v237, v234, v215 wave_ror:1 row_mask:0x1 bank_mask:0x1
    v_add_f32_dpp v239, v236, v214 wave_ror:1 row_mask:0x1 bank_mask:0x1
    v_add_f32_dpp v235, v217, v216 wave_shr:1 row_mask:0xf bank_mask:0xf
    s_nop 1
    v_add_f32_dpp v237, v235, v215 wave_shr:1 row_mask:0xf bank_mask:0xf
    s_nop 1
    v_add_f32_dpp v239, v237, v214 wave_shr:1 row_mask:0xf bank_mask:0xf
    ds_write_addtid_b32 v239 offset:30976
    s_endpgm
.p2align 12
L_padt7:
    s_cbranch_execz L_rett
L_tail7:
    v_mfma_f32_16x16x32_bf16 v[230:233], v[128:131], v[178:181], v[230:233]
    ds_read_b64_tr_b16 v[190:191], v1 offset:1024
    ds_write_addtid_b32 v238 offset:22528
    v_mfma_f32_16x16x32_bf16 v[230:233], v[132:135], v[182:185], v[230:233]
    s_waitcnt lgkmcnt(2)
    ds_read_b64_tr_b16 v[192:193], v1 offset:1536
    v_mfma_f32_16x16x32_bf16 v[202:205], v[4:7], v[186:189], 0
    ds_read_b64_tr_b16 v[194:195], v1 offset:2048
    v_mfma_f32_16x16x32_bf16 v[206:209], v[2:5], v[186:189], 0
    ds_read_b64_tr_b16 v[196:197], v1 offset:2560
    v_mfma_f32_16x16x32_bf16 v[210:213], v[40:43], v[186:189], 0
    ds_read_b64_tr_b16 v[198:199], v1 offset:3072
    v_add_f32_dpp v235, v229, v232 wave_ror:1 row_mask:0x1 bank_mask:0x1
    v_mfma_f32_16x16x32_bf16 v[214:217], v[38:41], v[186:189], 0
    s_waitcnt lgkmcnt(3)
    ds_read_b64_tr_b16 v[200:201], v1 offset:3584
    v_mfma_f32_16x16x32_bf16 v[202:205], v[8:11], v[190:193], v[202:205]
    ds_read_b64_tr_b16 v[186:187], v1 offset:4096
    v_add_f32_dpp v237, v234, v231 wave_ror:1 row_mask:0x1 bank_mask:0x1
    v_mfma_f32_16x16x32_bf16 v[206:209], v[6:9], v[190:193], v[206:209]
    ds_read_b64_tr_b16 v[188:189], v1 offset:4608
    v_add_f32_dpp v239, v236, v230 wave_ror:1 row_mask:0x1 bank_mask:0x1
    v_mfma_f32_16x16x32_bf16 v[210:213], v[44:47], v[190:193], v[210:213]
    v_add_f32_dpp v235, v233, v232 wave_shr:1 row_mask:0xf bank_mask:0xf
    v_mfma_f32_16x16x32_bf16 v[214:217], v[42:45], v[190:193], v[214:217]
    s_waitcnt lgkmcnt(4)
    ds_read_b64_tr_b16 v[190:191], v1 offset:5120
    v_mfma_f32_16x16x32_bf16 v[202:205], v[12:15], v[194:197], v[202:205]
    v_add_f32_dpp v237, v235, v231 wave_shr:1 row_mask:0xf bank_mask:0xf
    v_mfma_f32_16x16x32_bf16 v[206:209], v[10:13], v[194:197], v[206:209]
    ds_read_b64_tr_b16 v[192:193], v1 offset:5632
    v_add_f32_dpp v239, v237, v230 wave_shr:1 row_mask:0xf bank_mask:0xf
    v_mfma_f32_16x16x32_bf16 v[210:213], v[48:51], v[194:197], v[210:213]
    ds_write_addtid_b32 v239 offset:22784
    v_mfma_f32_16x16x32_bf16 v[214:217], v[46:49], v[194:197], v[214:217]
    s_waitcnt lgkmcnt(4)
    ds_read_b64_tr_b16 v[194:195], v1 offset:6144
    v_mfma_f32_16x16x32_bf16 v[202:205], v[16:19], v[198:201], v[202:205]
    v_mfma_f32_16x16x32_bf16 v[206:209], v[14:17], v[198:201], v[206:209]
    ds_read_b64_tr_b16 v[196:197], v1 offset:6656
    v_mfma_f32_16x16x32_bf16 v[210:213], v[52:55], v[198:201], v[210:213]
    v_mfma_f32_16x16x32_bf16 v[214:217], v[50:53], v[198:201], v[214:217]
    s_waitcnt lgkmcnt(4)
    ds_read_b64_tr_b16 v[198:199], v1 offset:7168
    v_mfma_f32_16x16x32_bf16 v[202:205], v[20:23], v[186:189], v[202:205]
    v_mfma_f32_16x16x32_bf16 v[206:209], v[18:21], v[186:189], v[206:209]
    ds_read_b64_tr_b16 v[200:201], v1 offset:7680
    v_mfma_f32_16x16x32_bf16 v[210:213], v[56:59], v[186:189], v[210:213]
    v_mfma_f32_16x16x32_bf16 v[214:217], v[54:57], v[186:189], v[214:217]
    s_waitcnt lgkmcnt(3)
    ds_read_b64_tr_b16 v[186:187], v1 offset:8192
    v_mfma_f32_16x16x32_bf16 v[202:205], v[24:27], v[190:193], v[202:205]
    v_mfma_f32_16x16x32_bf16 v[206:209], v[22:25], v[190:193], v[206:209]
    ds_read_b64_tr_b16 v[188:189], v1 offset:8704
    v_mfma_f32_16x16x32_bf16 v[210:213], v[60:63], v[190:193], v[210:213]
    v_mfma_f32_16x16x32_bf16 v[214:217], v[58:61], v[190:193], v[214:217]
    s_waitcnt lgkmcnt(3)
    ds_read_b64_tr_b16 v[190:191], v1 offset:9216
    v_mfma_f32_16x16x32_bf16 v[202:205], v[28:31], v[194:197], v[202:205]
    v_mfma_f32_16x16x32_bf16 v[206:209], v[26:29], v[194:197], v[206:209]
    ds_read_b64_tr_b16 v[192:193], v1 offset:9728
    v_mfma_f32_16x16x32_bf16 v[210:213], v[64:67], v[194:197], v[210:213]
    v_mfma_f32_16x16x32_bf16 v[214:217], v[62:65], v[194:197], v[214:217]
    s_waitcnt lgkmcnt(3)
    v_mfma_f32_16x16x32_bf16 v[202:205], v[32:35], v[198:201], v[202:205]
    v_mfma_f32_16x16x32_bf16 v[206:209], v[30:33], v[198:201], v[206:209]
    v_mfma_f32_16x16x32_bf16 v[210:213], v[68:71], v[198:201], v[210:213]
    v_mfma_f32_16x16x32_bf16 v[214:217], v[66:69], v[198:201], v[214:217]
    s_waitcnt lgkmcnt(1)
    v_mfma_f32_16x16x32_bf16 v[206:209], v[34:37], v[186:189], v[206:209]
    v_mfma_f32_16x16x32_bf16 v[210:213], v[72:75], v[186:189], v[210:213]
    v_mfma_f32_16x16x32_bf16 v[214:217], v[70:73], v[186:189], v[214:217]
    s_waitcnt lgkmcnt(0)
    v_add_f32_dpp v240, v205, v204 wave_shr:1 row_mask:0xf bank_mask:0xf bound_ctrl:0
    v_mfma_f32_16x16x32_bf16 v[214:217], v[74:77], v[190:193], v[214:217]
    ds_read_b64_tr_b16 v[186:187], v253 offset:3072
    v_add_f32_dpp v242, v240, v203 wave_shr:1 row_mask:0xf bank_mask:0xf bound_ctrl:0
    v_mfma_f32_16x16x32_bf16 v[218:221], v[86:89], v[138:141], 0
    ds_read_b64_tr_b16 v[188:189], v253 offset:3200
    v_add_f32_dpp v244, v242, v202 wave_shr:1 row_mask:0xf bank_mask:0xf bound_ctrl:0
    v_mfma_f32_16x16x32_bf16 v[218:221], v[90:93], v[142:145], v[218:221]
    ds_write_addtid_b32 v244 offset:32768
    v_add_f32_dpp v241, v205, v208 wave_ror:1 row_mask:0x1 bank_mask:0x1
    v_mfma_f32_16x16x32_bf16 v[218:221], v[94:97], v[146:149], v[218:221]
    v_add_f32_dpp v243, v240, v207 wave_ror:1 row_mask:0x1 bank_mask:0x1
    v_add_f32_dpp v245, v242, v206 wave_ror:1 row_mask:0x1 bank_mask:0x1
    v_mfma_f32_16x16x32_bf16 v[218:221], v[98:101], v[150:153], v[218:221]
    v_add_f32_dpp v241, v209, v208 wave_shr:1 row_mask:0xf bank_mask:0xf
    v_add_f32_dpp v240, v213, v212 wave_shr:1 row_mask:0xf bank_mask:0xf bound_ctrl:0
    v_mfma_f32_16x16x32_bf16 v[218:221], v[102:105], v[154:157], v[218:221]
    v_add_f32_dpp v243, v241, v207 wave_shr:1 row_mask:0xf bank_mask:0xf
    v_add_f32_dpp v242, v240, v211 wave_shr:1 row_mask:0xf bank_mask:0xf bound_ctrl:0
    v_mfma_f32_16x16x32_bf16 v[218:221], v[106:109], v[158:161], v[218:221]
    v_add_f32_dpp v245, v243, v206 wave_shr:1 row_mask:0xf bank_mask:0xf
    v_add_f32_dpp v244, v242, v210 wave_shr:1 row_mask:0xf bank_mask:0xf bound_ctrl:0
    v_mfma_f32_16x16x32_bf16 v[218:221], v[110:113], v[162:165], v[218:221]
    ds_write_addtid_b32 v245 offset:33024
    v_add_f32_dpp v241, v213, v216 wave_ror:1 row_mask:0x1 bank_mask:0x1
    v_mfma_f32_16x16x32_bf16 v[218:221], v[114:117], v[166:169], v[218:221]
    ds_write_addtid_b32 v244 offset:34816
    v_add_f32_dpp v243, v240, v215 wave_ror:1 row_mask:0x1 bank_mask:0x1
    v_mfma_f32_16x16x32_bf16 v[218:221], v[118:121], v[170:173], v[218:221]
    v_add_f32_dpp v245, v242, v214 wave_ror:1 row_mask:0x1 bank_mask:0x1
    v_add_f32_dpp v241, v217, v216 wave_shr:1 row_mask:0xf bank_mask:0xf
    v_mfma_f32_16x16x32_bf16 v[218:221], v[122:125], v[174:177], v[218:221]
    s_nop 0
    v_add_f32_dpp v243, v241, v215 wave_shr:1 row_mask:0xf bank_mask:0xf
    v_mfma_f32_16x16x32_bf16 v[218:221], v[126:129], v[178:181], v[218:221]
    s_nop 0
    v_add_f32_dpp v245, v243, v214 wave_shr:1 row_mask:0xf bank_mask:0xf
    v_mfma_f32_16x16x32_bf16 v[218:221], v[130:133], v[182:185], v[218:221]
    s_waitcnt lgkmcnt(2)
    ds_write_addtid_b32 v245 offset:35072
    v_mfma_f32_16x16x32_bf16 v[218:221], v[134:137], v[186:189], v[218:221]
    v_mfma_f32_16x16x32_bf16 v[222:225], v[84:87], v[138:141], 0
    v_mfma_f32_16x16x32_bf16 v[222:225], v[88:91], v[142:145], v[222:225]
    v_mfma_f32_16x16x32_bf16 v[222:225], v[92:95], v[146:149], v[222:225]
    v_mfma_f32_16x16x32_bf16 v[222:225], v[96:99], v[150:153], v[222:225]
    v_mfma_f32_16x16x32_bf16 v[222:225], v[100:103], v[154:157], v[222:225]
    v_mfma_f32_16x16x32_bf16 v[222:225], v[104:107], v[158:161], v[222:225]
    v_mfma_f32_16x16x32_bf16 v[222:225], v[108:111], v[162:165], v[222:225]
    s_nop 0
    v_add_f32_dpp v234, v233, v220 wave_ror:1 row_mask:0x1 bank_mask:0x1
    v_add_f32_dpp v236, v235, v219 wave_ror:1 row_mask:0x1 bank_mask:0x1
    v_mfma_f32_16x16x32_bf16 v[222:225], v[112:115], v[166:169], v[222:225]
    v_add_f32_dpp v238, v237, v218 wave_ror:1 row_mask:0x1 bank_mask:0x1
    v_add_f32_dpp v234, v221, v220 wave_shr:1 row_mask:0xf bank_mask:0xf
    v_mfma_f32_16x16x32_bf16 v[222:225], v[116:119], v[170:173], v[222:225]
    s_nop 0
    v_add_f32_dpp v236, v234, v219 wave_shr:1 row_mask:0xf bank_mask:0xf
    v_mfma_f32_16x16x32_bf16 v[222:225], v[120:123], v[174:177], v[222:225]
    s_nop 0
    v_add_f32_dpp v238, v236, v218 wave_shr:1 row_mask:0xf bank_mask:0xf
    v_mfma_f32_16x16x32_bf16 v[222:225], v[124:127], v[178:181], v[222:225]
    ds_write_addtid_b32 v238 offset:24576
    v_mfma_f32_16x16x32_bf16 v[222:225], v[128:131], v[182:185], v[222:225]
    v_mfma_f32_16x16x32_bf16 v[222:225], v[132:135], v[186:189], v[222:225]
    v_mfma_f32_16x16x32_bf16 v[226:229], v[82:85], v[138:141], 0
    ds_read_b64_tr_b16 v[190:191], v253 offset:3328
    v_mfma_f32_16x16x32_bf16 v[226:229], v[86:89], v[142:145], v[226:229]
    ds_read_b64_tr_b16 v[192:193], v253 offset:3456
    v_mfma_f32_16x16x32_bf16 v[226:229], v[90:93], v[146:149], v[226:229]
    v_mfma_f32_16x16x32_bf16 v[226:229], v[94:97], v[150:153], v[226:229]
    v_mfma_f32_16x16x32_bf16 v[226:229], v[98:101], v[154:157], v[226:229]
    s_nop 0
    v_add_f32_dpp v235, v221, v224 wave_ror:1 row_mask:0x1 bank_mask:0x1
    v_add_f32_dpp v237, v234, v223 wave_ror:1 row_mask:0x1 bank_mask:0x1
    v_mfma_f32_16x16x32_bf16 v[226:229], v[102:105], v[158:161], v[226:229]
    v_add_f32_dpp v239, v236, v222 wave_ror:1 row_mask:0x1 bank_mask:0x1
    v_add_f32_dpp v235, v225, v224 wave_shr:1 row_mask:0xf bank_mask:0xf
    v_mfma_f32_16x16x32_bf16 v[226:229], v[106:109], v[162:165], v[226:229]
    s_nop 0
    v_add_f32_dpp v237, v235, v223 wave_shr:1 row_mask:0xf bank_mask:0xf
    v_mfma_f32_16x16x32_bf16 v[226:229], v[110:113], v[166:169], v[226:229]
    s_nop 0
    v_add_f32_dpp v239, v237, v222 wave_shr:1 row_mask:0xf bank_mask:0xf
    v_mfma_f32_16x16x32_bf16 v[226:229], v[114:117], v[170:173], v[226:229]
    ds_write_addtid_b32 v239 offset:24832
    v_mfma_f32_16x16x32_bf16 v[226:229], v[118:121], v[174:177], v[226:229]
    v_mfma_f32_16x16x32_bf16 v[226:229], v[122:125], v[178:181], v[226:229]
    v_mfma_f32_16x16x32_bf16 v[226:229], v[126:129], v[182:185], v[226:229]
    v_mfma_f32_16x16x32_bf16 v[226:229], v[130:133], v[186:189], v[226:229]
    s_waitcnt lgkmcnt(1)
    v_mfma_f32_16x16x32_bf16 v[226:229], v[134:137], v[190:193], v[226:229]
    v_mfma_f32_16x16x32_bf16 v[230:233], v[80:83], v[138:141], 0
    v_mfma_f32_16x16x32_bf16 v[230:233], v[84:87], v[142:145], v[230:233]
    v_mfma_f32_16x16x32_bf16 v[230:233], v[88:91], v[146:149], v[230:233]
    v_mfma_f32_16x16x32_bf16 v[230:233], v[92:95], v[150:153], v[230:233]
    v_mfma_f32_16x16x32_bf16 v[230:233], v[96:99], v[154:157], v[230:233]
    v_mfma_f32_16x16x32_bf16 v[230:233], v[100:103], v[158:161], v[230:233]
    v_mfma_f32_16x16x32_bf16 v[230:233], v[104:107], v[162:165], v[230:233]
    s_nop 0
    v_add_f32_dpp v234, v225, v228 wave_ror:1 row_mask:0x1 bank_mask:0x1
    v_add_f32_dpp v236, v235, v227 wave_ror:1 row_mask:0x1 bank_mask:0x1
    v_mfma_f32_16x16x32_bf16 v[230:233], v[108:111], v[166:169], v[230:233]
    v_add_f32_dpp v238, v237, v226 wave_ror:1 row_mask:0x1 bank_mask:0x1
    v_add_f32_dpp v234, v229, v228 wave_shr:1 row_mask:0xf bank_mask:0xf
    v_mfma_f32_16x16x32_bf16 v[230:233], v[112:115], v[170:173], v[230:233]
    s_nop 0
    v_add_f32_dpp v236, v234, v227 wave_shr:1 row_mask:0xf bank_mask:0xf
    v_mfma_f32_16x16x32_bf16 v[230:233], v[116:119], v[174:177], v[230:233]
    s_nop 0
    v_add_f32_dpp v238, v236, v226 wave_shr:1 row_mask:0xf bank_mask:0xf
    v_mfma_f32_16x16x32_bf16 v[230:233], v[120:123], v[178:181], v[230:233]
    ds_write_addtid_b32 v238 offset:26624
    v_mfma_f32_16x16x32_bf16 v[230:233], v[124:127], v[182:185], v[230:233]
    v_mfma_f32_16x16x32_bf16 v[230:233], v[128:131], v[186:189], v[230:233]
    v_mfma_f32_16x16x32_bf16 v[230:233], v[132:135], v[190:193], v[230:233]
    v_mfma_f32_16x16x32_bf16 v[202:205], v[78:81], v[138:141], 0
    v_mfma_f32_16x16x32_bf16 v[202:205], v[82:85], v[142:145], v[202:205]
    ds_read_b64_tr_b16 v[194:195], v253 offset:3584
    v_mfma_f32_16x16x32_bf16 v[202:205], v[86:89], v[146:149], v[202:205]
    ds_read_b64_tr_b16 v[196:197], v253 offset:3712
    v_mfma_f32_16x16x32_bf16 v[202:205], v[90:93], v[150:153], v[202:205]
    ds_read_b64_tr_b16 v[76:77], v251 offset:3840
    v_mfma_f32_16x16x32_bf16 v[202:205], v[94:97], v[154:157], v[202:205]
    v_add_f32_dpp v235, v229, v232 wave_ror:1 row_mask:0x1 bank_mask:0x1
    v_add_f32_dpp v237, v234, v231 wave_ror:1 row_mask:0x1 bank_mask:0x1
    v_mfma_f32_16x16x32_bf16 v[202:205], v[98:101], v[158:161], v[202:205]
    v_add_f32_dpp v239, v236, v230 wave_ror:1 row_mask:0x1 bank_mask:0x1
    v_add_f32_dpp v235, v233, v232 wave_shr:1 row_mask:0xf bank_mask:0xf
    v_mfma_f32_16x16x32_bf16 v[202:205], v[102:105], v[162:165], v[202:205]
    s_nop 0
    v_add_f32_dpp v237, v235, v231 wave_shr:1 row_mask:0xf bank_mask:0xf
    v_mfma_f32_16x16x32_bf16 v[202:205], v[106:109], v[166:169], v[202:205]
    s_nop 0
    v_add_f32_dpp v239, v237, v230 wave_shr:1 row_mask:0xf bank_mask:0xf
    v_mfma_f32_16x16x32_bf16 v[202:205], v[110:113], v[170:173], v[202:205]
    ds_write_addtid_b32 v239 offset:26880
    v_mfma_f32_16x16x32_bf16 v[202:205], v[114:117], v[174:177], v[202:205]
    v_mfma_f32_16x16x32_bf16 v[202:205], v[118:121], v[178:181], v[202:205]
    v_mfma_f32_16x16x32_bf16 v[202:205], v[122:125], v[182:185], v[202:205]
    v_mfma_f32_16x16x32_bf16 v[202:205], v[126:129], v[186:189], v[202:205]
    v_mfma_f32_16x16x32_bf16 v[202:205], v[130:133], v[190:193], v[202:205]
    s_waitcnt lgkmcnt(1)
    v_mfma_f32_16x16x32_bf16 v[202:205], v[134:137], v[194:197], v[202:205]
    v_mfma_f32_16x16x32_bf16 v[206:209], v[76:79], v[138:141], 0
    v_mfma_f32_16x16x32_bf16 v[206:209], v[80:83], v[142:145], v[206:209]
    v_mfma_f32_16x16x32_bf16 v[206:209], v[84:87], v[146:149], v[206:209]
    ds_read_b64_tr_b16 v[74:75], v251 offset:3968
    v_mfma_f32_16x16x32_bf16 v[206:209], v[88:91], v[150:153], v[206:209]
    v_mfma_f32_16x16x32_bf16 v[206:209], v[92:95], v[154:157], v[206:209]
    v_mfma_f32_16x16x32_bf16 v[206:209], v[96:99], v[158:161], v[206:209]
    s_nop 0
    v_add_f32_dpp v234, v233, v204 wave_ror:1 row_mask:0x1 bank_mask:0x1
    v_add_f32_dpp v236, v235, v203 wave_ror:1 row_mask:0x1 bank_mask:0x1
    v_mfma_f32_16x16x32_bf16 v[206:209], v[100:103], v[162:165], v[206:209]
    v_add_f32_dpp v238, v237, v202 wave_ror:1 row_mask:0x1 bank_mask:0x1
    v_add_f32_dpp v234, v205, v204 wave_shr:1 row_mask:0xf bank_mask:0xf
    v_mfma_f32_16x16x32_bf16 v[206:209], v[104:107], v[166:169], v[206:209]
    s_nop 0
    v_add_f32_dpp v236, v234, v203 wave_shr:1 row_mask:0xf bank_mask:0xf
    v_mfma_f32_16x16x32_bf16 v[206:209], v[108:111], v[170:173], v[206:209]
    s_nop 0
    v_add_f32_dpp v238, v236, v202 wave_shr:1 row_mask:0xf bank_mask:0xf
    v_mfma_f32_16x16x32_bf16 v[206:209], v[112:115], v[174:177], v[206:209]
    ds_write_addtid_b32 v238 offset:28672
    v_mfma_f32_16x16x32_bf16 v[206:209], v[116:119], v[178:181], v[206:209]
    v_mfma_f32_16x16x32_bf16 v[206:209], v[120:123], v[182:185], v[206:209]
    v_mfma_f32_16x16x32_bf16 v[206:209], v[124:127], v[186:189], v[206:209]
    v_mfma_f32_16x16x32_bf16 v[206:209], v[128:131], v[190:193], v[206:209]
    v_mfma_f32_16x16x32_bf16 v[206:209], v[132:135], v[194:197], v[206:209]
    s_waitcnt lgkmcnt(1)
    v_mfma_f32_16x16x32_bf16 v[210:213], v[74:77], v[138:141], 0
    v_mfma_f32_16x16x32_bf16 v[210:213], v[78:81], v[142:145], v[210:213]
    v_mfma_f32_16x16x32_bf16 v[210:213], v[82:85], v[146:149], v[210:213]
    ds_read_b64_tr_b16 v[198:199], v253 offset:3840
    v_mfma_f32_16x16x32_bf16 v[210:213], v[86:89], v[150:153], v[210:213]
    ds_read_b64_tr_b16 v[200:201], v253 offset:3968
    v_mfma_f32_16x16x32_bf16 v[210:213], v[90:93], v[154:157], v[210:213]
    ds_read_b64_tr_b16 v[72:73], v251 offset:4096
    v_add_f32_dpp v235, v205, v208 wave_ror:1 row_mask:0x1 bank_mask:0x1
    v_mfma_f32_16x16x32_bf16 v[210:213], v[94:97], v[158:161], v[210:213]
    v_add_f32_dpp v237, v234, v207 wave_ror:1 row_mask:0x1 bank_mask:0x1
    v_add_f32_dpp v239, v236, v206 wave_ror:1 row_mask:0x1 bank_mask:0x1
    v_mfma_f32_16x16x32_bf16 v[210:213], v[98:101], v[162:165], v[210:213]
    v_add_f32_dpp v235, v209, v208 wave_shr:1 row_mask:0xf bank_mask:0xf
    v_mfma_f32_16x16x32_bf16 v[210:213], v[102:105], v[166:169], v[210:213]
    s_nop 0
    v_add_f32_dpp v237, v235, v207 wave_shr:1 row_mask:0xf bank_mask:0xf
    v_mfma_f32_16x16x32_bf16 v[210:213], v[106:109], v[170:173], v[210:213]
    s_nop 0
    v_add_f32_dpp v239, v237, v206 wave_shr:1 row_mask:0xf bank_mask:0xf
    v_mfma_f32_16x16x32_bf16 v[210:213], v[110:113], v[174:177], v[210:213]
    ds_write_addtid_b32 v239 offset:28928
    v_mfma_f32_16x16x32_bf16 v[210:213], v[114:117], v[178:181], v[210:213]
    v_mfma_f32_16x16x32_bf16 v[210:213], v[118:121], v[182:185], v[210:213]
    v_mfma_f32_16x16x32_bf16 v[210:213], v[122:125], v[186:189], v[210:213]
    v_mfma_f32_16x16x32_bf16 v[210:213], v[126:129], v[190:193], v[210:213]
    v_mfma_f32_16x16x32_bf16 v[210:213], v[130:133], v[194:197], v[210:213]
    s_waitcnt lgkmcnt(1)
    v_mfma_f32_16x16x32_bf16 v[210:213], v[134:137], v[198:201], v[210:213]
    v_mfma_f32_16x16x32_bf16 v[214:217], v[72:75], v[138:141], 0
    v_mfma_f32_16x16x32_bf16 v[214:217], v[76:79], v[142:145], v[214:217]
    v_mfma_f32_16x16x32_bf16 v[214:217], v[80:83], v[146:149], v[214:217]
    v_mfma_f32_16x16x32_bf16 v[214:217], v[84:87], v[150:153], v[214:217]
    v_mfma_f32_16x16x32_bf16 v[214:217], v[88:91], v[154:157], v[214:217]
    v_mfma_f32_16x16x32_bf16 v[214:217], v[92:95], v[158:161], v[214:217]
    v_mfma_f32_16x16x32_bf16 v[214:217], v[96:99], v[162:165], v[214:217]
    s_nop 0
    v_add_f32_dpp v234, v209, v212 wave_ror:1 row_mask:0x1 bank_mask:0x1
    v_add_f32_dpp v236, v235, v211 wave_ror:1 row_mask:0x1 bank_mask:0x1
    v_mfma_f32_16x16x32_bf16 v[214:217], v[100:103], v[166:169], v[214:217]
    v_add_f32_dpp v238, v237, v210 wave_ror:1 row_mask:0x1 bank_mask:0x1
    v_add_f32_dpp v234, v213, v212 wave_shr:1 row_mask:0xf bank_mask:0xf
    v_mfma_f32_16x16x32_bf16 v[214:217], v[104:107], v[170:173], v[214:217]
    s_nop 0
    v_add_f32_dpp v236, v234, v211 wave_shr:1 row_mask:0xf bank_mask:0xf
    v_mfma_f32_16x16x32_bf16 v[214:217], v[108:111], v[174:177], v[214:217]
    s_nop 0
    v_add_f32_dpp v238, v236, v210 wave_shr:1 row_mask:0xf bank_mask:0xf
    v_mfma_f32_16x16x32_bf16 v[214:217], v[112:115], v[178:181], v[214:217]
    ds_write_addtid_b32 v238 offset:30720
    v_mfma_f32_16x16x32_bf16 v[214:217], v[116:119], v[182:185], v[214:217]
    v_mfma_f32_16x16x32_bf16 v[214:217], v[120:123], v[186:189], v[214:217]
    v_mfma_f32_16x16x32_bf16 v[214:217], v[124:127], v[190:193], v[214:217]
    v_mfma_f32_16x16x32_bf16 v[214:217], v[128:131], v[194:197], v[214:217]
    v_mfma_f32_16x16x32_bf16 v[214:217], v[132:135], v[198:201], v[214:217]
    s_nop 7
    v_add_f32_dpp v235, v213, v216 wave_ror:1 row_mask:0x1 bank_mask:0x1
    v_add_f32_dpp v237, v234, v215 wave_ror:1 row_mask:0x1 bank_mask:0x1
    v_add_f32_dpp v239, v236, v214 wave_ror:1 row_mask:0x1 bank_mask:0x1
    v_add_f32_dpp v235, v217, v216 wave_shr:1 row_mask:0xf bank_mask:0xf
    s_nop 1
    v_add_f32_dpp v237, v235, v215 wave_shr:1 row_mask:0xf bank_mask:0xf
    s_nop 1
    v_add_f32_dpp v239, v237, v214 wave_shr:1 row_mask:0xf bank_mask:0xf
    ds_write_addtid_b32 v239 offset:30976
    s_endpgm
L_end:
    s_endpgm
.section .rodata,"a"
.p2align 6
.amdhsa_kernel gated_mix__ssm_conv_h3__ssm_conv_s4d__prompt_kernel
  .amdhsa_next_free_vgpr 256
  .amdhsa_next_free_sgpr 102
  .amdhsa_accum_offset 256
  .amdhsa_group_segment_fixed_size 0
  .amdhsa_kernarg_size 136
  .amdhsa_user_sgpr_count 2
  .amdhsa_user_sgpr_kernarg_segment_ptr 1
  .amdhsa_system_sgpr_workgroup_id_x 1
.end_amdhsa_kernel
```
